```python
import torch

def _softmax(x, axis=-1):
    return torch.softmax(x, dim=axis)
def _gelu(x):
    return torch.nn.functional.gelu(x, approximate="tanh")
def _silu(x):
    return torch.nn.functional.silu(x)
def _sigmoid(x):
    return torch.sigmoid(x)
def _layernorm(x, axis=-1, eps=1e-5):
    m = x.mean(dim=axis, keepdim=True)
    v = x.var(dim=axis, keepdim=True, unbiased=False)
    return (x - m) / torch.sqrt(v + eps)
def _scatter_add(tgt, idx, src, axis=0):
    return tgt.clone().index_add_(axis, idx, src)
def _segment_sum(src, seg, n):
    out = torch.zeros((n,) + src.shape[1:], dtype=src.dtype)
    return out.index_add_(0, seg, src)
def _pad(x, pw):
    flat = tuple(v for pair in reversed(pw) for v in pair)
    return torch.nn.functional.pad(x, flat)

kernel_name = 'interleave_layers__gqa_block_cached__dense_activation_silu__decode'

def setup_inputs():

    _w = (lambda a: (lambda t: t.to(torch.bfloat16) if t.is_floating_point() else t)(torch.as_tensor(a)))
    def _A_setup():
        B, Sq, D = 2, 1, 640
        Hq, Hkv, Sk, Dh = 32, 32, 8192, 128
        assert Hq % Hkv == 0, (Hq, Hkv)
        return {
            "x": _w((lambda *s: torch.randn(*s, dtype=torch.bfloat16) * 0.1)(B, Sq, D)),
            "k_cache": _w((lambda *s: torch.randn(*s, dtype=torch.bfloat16) * 1.6)(B, Hkv, Sk, Dh)),
            "v_cache": _w((lambda *s: torch.randn(*s, dtype=torch.bfloat16) * 3.2)(B, Hkv, Sk, Dh)),
            "wq": _w((lambda *s: torch.randn(*s, dtype=torch.bfloat16) * 1.6)(D, Hq * Dh) * (D ** -0.5)),
            "wo": _w((lambda *s: torch.randn(*s, dtype=torch.bfloat16) * 3.2)(Hq * Dh, D) * ((Hq * Dh) ** -0.5)),
        }
    _A_in = _A_setup()

    def _B_setup():
        B, S, D, F = 2, 1, 640, 1728
        return {
            "x": _w((lambda *s: torch.randn(*s, dtype=torch.bfloat16) * 0.1)(B, S, D)),
            "w1": _w((lambda *s: torch.randn(*s, dtype=torch.bfloat16) * 3.2)(D, F) * (D ** -0.5)),
            "w2": _w((lambda *s: torch.randn(*s, dtype=torch.bfloat16) * 0.8)(F, D) * (F ** -0.5)),
        }
    _B_in = _B_setup()

    return {
        "A_x": _A_in["x"],
        "A_k_cache": _A_in["k_cache"],
        "A_v_cache": _A_in["v_cache"],
        "A_wq": _A_in["wq"],
        "A_wo": _A_in["wo"],
        "B_x": _B_in["x"],
        "B_w1": _B_in["w1"],
        "B_w2": _B_in["w2"],
    }

def reference(A_x, A_k_cache, A_v_cache, A_wq, A_wo, B_x, B_w1, B_w2):
    def _A_ref(x, k_cache, v_cache, wq, wo):
        B, Sq, D = x.shape
        Hq, Dh = 32, 128
        Hkv = k_cache.shape[1]
        rep = Hq // Hkv
        q = (lambda x, *d: x.permute(*d))((x @ wq).reshape(B, Sq, Hq, Dh), 0, 2, 1, 3)
        k = (lambda x, n, axis: torch.repeat_interleave(x, n, dim=axis))(k_cache, rep, axis=1)
        v = (lambda x, n, axis: torch.repeat_interleave(x, n, dim=axis))(v_cache, rep, axis=1)
        scores = torch.einsum("bhqd,bhkd->bhqk", q, k) * (Dh ** -0.5)
        p = _softmax(scores, axis=-1)
        o = torch.einsum("bhqk,bhkd->bhqd", p, v)
        return (lambda x, *d: x.permute(*d))(o, 0, 2, 1, 3).reshape(B, Sq, Hq * Dh) @ wo

    def _B_ref(x, w1, w2):
        h = torch.einsum("bsd,df->bsf", x, w1)
        h = _silu(h)
        out = torch.einsum("bsf,fd->bsd", h, w2)
        return out

    x = A_x
    x = x + _A_ref(_layernorm(x, axis=-1), A_k_cache, A_v_cache, A_wq, A_wo)
    x = x + _B_ref(_layernorm(x, axis=-1), B_w1, B_w2)
    x = x + _A_ref(_layernorm(x, axis=-1), A_k_cache, A_v_cache, A_wq, A_wo)
    x = x + _B_ref(_layernorm(x, axis=-1), B_w1, B_w2)
    return x
```

```asm
; @launch grid=(256,1,1) block=(256,1,1) lds=163840
.amdgcn_target "amdgcn-amd-amdhsa--gfx950"
.text
.globl interleave_layers__gqa_block_cached__dense_activation_silu__decode_kernel
.p2align 8
.type interleave_layers__gqa_block_cached__dense_activation_silu__decode_kernel,@function
interleave_layers__gqa_block_cached__dense_activation_silu__decode_kernel:
s_cmp_ge_u32 s2, 256
s_cbranch_scc1 L_end
s_load_dwordx4 s[32:35], s[0:1], 0
s_load_dwordx4 s[36:39], s[0:1], 16
s_load_dwordx2 s[40:41], s[0:1], 32
s_load_dwordx4 s[44:47], s[0:1], 48
s_load_dwordx4 s[56:59], s[0:1], 64
s_load_dwordx2 s[16:17], s[0:1], 80
v_lshrrev_b32 v1, 6, v0
v_and_b32 v0, 63, v0
v_readfirstlane_b32 s3, v1
s_and_b32 s24, s2, 31
s_lshr_b32 s25, s2, 5
s_mov_b32 s48, 0x3e0293ee
s_mov_b32 s49, 0x3f803f80
v_lshlrev_b32 v1, 4, v0
s_lshl_b32 s54, s3, 10
v_add_u32 v1, s54, v1
s_lshl_b32 s54, s3, 14
v_and_b32 v58, 3, v0
v_mov_b32 v2, 0
v_mov_b32 v3, 0
v_mov_b32 v59, 0xffff
v_mov_b32 v60, 0xffff0000
v_cmp_eq_u32 vcc, 0, v58
s_nop 1
v_cndmask_b32 v2, v2, v59, vcc
v_cmp_eq_u32 vcc, 1, v58
s_nop 1
v_cndmask_b32 v2, v2, v60, vcc
v_cmp_eq_u32 vcc, 2, v58
s_nop 1
v_cndmask_b32 v3, v3, v59, vcc
v_cmp_eq_u32 vcc, 3, v58
s_nop 1
v_cndmask_b32 v3, v3, v60, vcc
s_waitcnt lgkmcnt(0)
s_mov_b64 s[22:23], s[32:33]
s_mov_b64 s[20:21], s[56:57]
s_mov_b64 s[18:19], s[58:59]
s_lshl_b32 s42, s24, 21
s_lshl_b32 s43, s25, 18
s_add_u32 s42, s42, s43
s_add_u32 s4, s34, s42
s_addc_u32 s5, s35, 0
s_mov_b32 s6, 0x4040000
s_mov_b32 s7, 0x20000
s_add_u32 s8, s36, s42
s_addc_u32 s9, s37, 0
s_mov_b32 s10, 0x4040000
s_mov_b32 s11, 0x20000
s_mov_b64 s[96:97], s[38:39]
s_mov_b32 s98, 5242880
s_mov_b32 s99, 0x20000
s_cmp_lg_u32 s3, 0
s_cbranch_scc1 L_noclear
s_mul_i32 s42, s2, 3072
v_lshlrev_b32 v58, 4, v0
v_add_u32 v58, s42, v58
v_mov_b32 v32, -1
v_mov_b32 v33, -1
v_mov_b32 v34, -1
v_mov_b32 v35, -1
global_store_dwordx4 v58, v[32:35], s[16:17] offset:0 sc1
global_store_dwordx4 v58, v[32:35], s[16:17] offset:1024 sc1
global_store_dwordx4 v58, v[32:35], s[16:17] offset:2048 sc1
s_lshl_b32 s42, s24, 3
s_add_u32 s42, s42, s25
s_lshl_b32 s42, s42, 9
s_add_u32 s42, s42, 851968
v_lshrrev_b32 v58, 5, v0
v_mul_u32_u24 v58, 131072, v58
v_and_b32 v59, 31, v0
v_lshl_add_u32 v58, v59, 4, v58
v_add_u32 v58, s42, v58
global_store_dwordx4 v58, v[32:35], s[16:17] sc1
s_cmp_ge_u32 s2, 64
s_cbranch_scc1 L_noclear
v_lshrrev_b32 v58, 3, v0
v_mul_u32_u24 v58, 8192, v58
v_and_b32 v59, 7, v0
v_lshl_add_u32 v58, v59, 4, v58
s_lshl_b32 s42, s2, 7
s_add_u32 s42, s42, 786432
v_add_u32 v58, s42, v58
s_mov_b32 exec_hi, 0
global_store_dwordx4 v58, v[32:35], s[16:17] sc1
s_mov_b64 exec, -1
L_noclear:
v_lshlrev_b32 v58, 4, v0
v_mov_b32 v20, 0
v_mov_b32 v21, 0
v_mov_b32 v22, 0
v_mov_b32 v23, 0
v_mov_b32 v28, 0
v_mov_b32 v29, 0
v_mov_b32 v30, 0
v_mov_b32 v31, 0
global_load_dwordx4 v[16:19], v58, s[22:23] offset:0
global_load_dwordx4 v[24:27], v58, s[22:23] offset:1280
s_mov_b64 exec, 0xffff
global_load_dwordx4 v[20:23], v58, s[22:23] offset:1024
global_load_dwordx4 v[28:31], v58, s[22:23] offset:2304
s_mov_b64 exec, -1
s_mul_i32 s42, s25, 80
s_mul_i32 s43, s3, 20
s_add_u32 s42, s42, s43
v_lshrrev_b32 v58, 4, v0
v_add_u32 v58, s42, v58
v_lshlrev_b32 v59, 1, v58
global_load_ushort v32, v59, s[22:23] offset:0
global_load_ushort v33, v59, s[22:23] offset:8
global_load_ushort v34, v59, s[22:23] offset:16
global_load_ushort v35, v59, s[22:23] offset:24
global_load_ushort v36, v59, s[22:23] offset:32
global_load_ushort v37, v59, s[22:23] offset:1280
global_load_ushort v38, v59, s[22:23] offset:1288
global_load_ushort v39, v59, s[22:23] offset:1296
global_load_ushort v40, v59, s[22:23] offset:1304
global_load_ushort v41, v59, s[22:23] offset:1312
v_lshlrev_b32 v58, 13, v58
v_and_b32 v59, 15, v0
v_lshl_add_u32 v58, v59, 4, v58
s_lshl_b32 s42, s24, 8
buffer_load_dwordx4 a[0:3], v58, s[96:99], s42 offen
s_add_u32 s42, s42, 32768
buffer_load_dwordx4 a[4:7], v58, s[96:99], s42 offen
s_add_u32 s42, s42, 32768
buffer_load_dwordx4 a[8:11], v58, s[96:99], s42 offen
s_add_u32 s42, s42, 32768
buffer_load_dwordx4 a[12:15], v58, s[96:99], s42 offen
s_add_u32 s42, s42, 32768
buffer_load_dwordx4 a[16:19], v58, s[96:99], s42 offen
s_add_u32 s42, s42, 32768
s_mov_b32 s30, 0
buffer_load_dwordx4 v[64:67], v1, s[4:7], s30 offen nt
s_add_u32 s30, s30, 4096
buffer_load_dwordx4 v[68:71], v1, s[4:7], s30 offen nt
s_add_u32 s30, s30, 4096
buffer_load_dwordx4 v[72:75], v1, s[4:7], s30 offen nt
s_add_u32 s30, s30, 4096
buffer_load_dwordx4 v[76:79], v1, s[4:7], s30 offen nt
s_add_u32 s30, s30, 4096
buffer_load_dwordx4 v[80:83], v1, s[4:7], s30 offen nt
s_add_u32 s30, s30, 4096
buffer_load_dwordx4 v[84:87], v1, s[4:7], s30 offen nt
s_add_u32 s30, s30, 4096
buffer_load_dwordx4 v[88:91], v1, s[4:7], s30 offen nt
s_add_u32 s30, s30, 4096
buffer_load_dwordx4 v[92:95], v1, s[4:7], s30 offen nt
s_add_u32 s30, s30, 4096
buffer_load_dwordx4 v[96:99], v1, s[4:7], s30 offen nt
s_add_u32 s30, s30, 4096
buffer_load_dwordx4 v[100:103], v1, s[4:7], s30 offen nt
s_add_u32 s30, s30, 4096
buffer_load_dwordx4 v[104:107], v1, s[4:7], s30 offen nt
s_add_u32 s30, s30, 4096
buffer_load_dwordx4 v[108:111], v1, s[4:7], s30 offen nt
s_add_u32 s30, s30, 4096
buffer_load_dwordx4 v[112:115], v1, s[4:7], s30 offen nt
s_add_u32 s30, s30, 4096
buffer_load_dwordx4 v[116:119], v1, s[4:7], s30 offen nt
s_add_u32 s30, s30, 4096
buffer_load_dwordx4 v[120:123], v1, s[4:7], s30 offen nt
s_add_u32 s30, s30, 4096
buffer_load_dwordx4 v[124:127], v1, s[4:7], s30 offen nt
s_add_u32 s30, s30, 4096
buffer_load_dwordx4 v[128:131], v1, s[4:7], s30 offen nt
s_add_u32 s30, s30, 4096
buffer_load_dwordx4 v[132:135], v1, s[4:7], s30 offen nt
s_add_u32 s30, s30, 4096
buffer_load_dwordx4 v[136:139], v1, s[4:7], s30 offen nt
s_add_u32 s30, s30, 4096
buffer_load_dwordx4 v[140:143], v1, s[4:7], s30 offen nt
s_add_u32 s30, s30, 4096
buffer_load_dwordx4 v[144:147], v1, s[4:7], s30 offen nt
s_add_u32 s30, s30, 4096
buffer_load_dwordx4 v[148:151], v1, s[4:7], s30 offen nt
s_add_u32 s30, s30, 4096
buffer_load_dwordx4 v[152:155], v1, s[4:7], s30 offen nt
s_add_u32 s30, s30, 4096
buffer_load_dwordx4 v[156:159], v1, s[4:7], s30 offen nt
s_add_u32 s30, s30, 4096
buffer_load_dwordx4 v[160:163], v1, s[4:7], s30 offen nt
s_add_u32 s30, s30, 4096
buffer_load_dwordx4 v[164:167], v1, s[4:7], s30 offen nt
s_add_u32 s30, s30, 4096
buffer_load_dwordx4 v[168:171], v1, s[4:7], s30 offen nt
s_add_u32 s30, s30, 4096
buffer_load_dwordx4 v[172:175], v1, s[4:7], s30 offen nt
s_add_u32 s30, s30, 4096
buffer_load_dwordx4 v[176:179], v1, s[4:7], s30 offen nt
s_add_u32 s30, s30, 4096
buffer_load_dwordx4 v[180:183], v1, s[4:7], s30 offen nt
s_add_u32 s30, s30, 4096
buffer_load_dwordx4 v[184:187], v1, s[4:7], s30 offen nt
s_add_u32 s30, s30, 4096
buffer_load_dwordx4 v[188:191], v1, s[4:7], s30 offen nt
s_add_u32 s30, s30, 4096
s_mov_b32 s28, 0
s_mov_b32 s29, 0
s_mov_b32 s52, 0
s_mov_b32 s53, 0
s_mov_b32 s58, 0
s_mov_b32 s59, 0
s_mov_b32 s62, 0
s_mov_b32 s63, 0
s_mov_b64 s[12:13], s[38:39]
s_mov_b32 s14, 5242880
s_mov_b32 s15, 0x20000
s_mov_b32 s100, 0x31371126
s_mov_b32 s101, 0x00000000
s_sub_u32 s42, s2, 0
s_cmp_lt_u32 s42, 80
s_cbranch_scc0 L_nr1
s_mov_b32 s28, 1
s_mov_b32 s29, s42
s_mov_b64 s[12:13], s[40:41]
s_mov_b32 s14, 5242880
s_and_b32 s52, s29, 7
s_lshr_b32 s53, s29, 3
s_mov_b32 s100, 0x12221102
s_mov_b32 s101, 0x00003231
s_cmp_ge_u32 s2, 64
s_cbranch_scc1 L_roledone
s_mov_b32 s58, 1
s_mov_b32 s100, 0x22111502
s_mov_b32 s101, 0x32313512
s_branch L_roledone
L_nr1:
s_sub_u32 s42, s2, 80
s_cmp_lt_u32 s42, 27
s_cbranch_scc0 L_nr2
s_mov_b32 s28, 2
s_mov_b32 s29, s42
s_mov_b64 s[12:13], s[44:45]
s_mov_b32 s14, 2211840
s_lshl_b32 s53, s29, 7
s_mul_i32 s42, s3, 20480
s_add_u32 s42, s42, 65536
v_lshlrev_b32 v8, 4, v0
v_add_u32 v8, s42, v8
v_lshrrev_b32 v58, 3, v0
v_mul_u32_u24 v9, 80, v58
s_mul_i32 s42, s3, 640
s_add_u32 s42, s42, 151808
v_add_u32 v9, s42, v9
v_and_b32 v10, 7, v0
v_lshlrev_b32 v10, 3, v10
v_lshrrev_b32 v59, 5, v0
v_lshl_add_u32 v10, v59, 2, v10
v_bfe_u32 v59, v0, 4, 1
v_add_u32 v10, v10, v59
v_bfe_u32 v59, v0, 3, 1
v_lshl_add_u32 v10, v59, 1, v10
s_lshl_b32 s42, s3, 8
s_add_u32 s42, s42, 154624
v_lshlrev_b32 v10, 2, v10
v_add_u32 v10, s42, v10
v_min_u32 v58, 39, v0
v_lshlrev_b32 v58, 2, v58
s_mul_i32 s42, s3, 160
v_add_u32 v58, s42, v58
v_lshlrev_b32 v14, 1, v58
v_lshlrev_b32 v11, 2, v58
v_add_u32 v12, 151808, v11
v_mov_b32 v13, 0
v_cmp_gt_u32 vcc, 40, v0
s_nop 1
v_cndmask_b32 v13, v13, 1.0, vcc
s_mov_b32 s100, 0x13231103
s_mov_b32 s101, 0x00003331
s_branch L_roledone
L_nr2:
s_sub_u32 s42, s2, 107
s_cmp_lt_u32 s42, 40
s_cbranch_scc0 L_nr3
s_mov_b32 s100, 0x31241104
s_mov_b32 s101, 0x00003414
s_mov_b32 s28, 3
s_mov_b32 s29, s42
s_and_b32 s43, s42, 7
s_mul_i32 s43, s43, 5
s_lshr_b32 s42, s42, 3
s_add_u32 s29, s43, s42
s_mov_b64 s[12:13], s[46:47]
s_mov_b32 s14, 2211840
s_mul_i32 s42, s3, 14336
s_add_u32 s42, s42, 65536
v_lshlrev_b32 v8, 3, v0
v_add_u32 v8, s42, v8
s_mul_i32 s42, s3, 1792
s_add_u32 s42, s42, 122880
v_lshrrev_b32 v58, 2, v0
v_lshlrev_b32 v9, 4, v58
v_add_u32 v9, s42, v9
v_min_u32 v58, 53, v0
v_lshlrev_b32 v12, 5, v58
v_add_u32 v12, s42, v12
v_lshlrev_b32 v11, 4, v58
s_mul_i32 s43, s3, 864
v_add_u32 v11, s43, v11
v_and_b32 v58, 3, v0
v_lshlrev_b32 v58, 2, v58
v_lshrrev_b32 v59, 4, v0
v_add_u32 v58, v58, v59
v_lshlrev_b32 v10, 2, v58
s_lshl_b32 s43, s3, 6
s_add_u32 s43, s43, 154624
v_add_u32 v10, s43, v10
v_and_b32 v58, 14, v0
v_lshlrev_b32 v14, 1, v58
s_lshl_b32 s43, s29, 5
v_add_u32 v14, s43, v14
v_lshlrev_b32 v58, 2, v0
v_add_u32 v58, s42, v58
v_mov_b32 v59, 0
s_mov_b64 exec, 0xffff
ds_write_b32 v58, v59 offset:1728
s_mov_b64 exec, -1
s_branch L_roledone
L_nr3:
s_mov_b32 s59, 1
s_sub_u32 s42, s2, 147
s_cmp_lt_u32 s42, 0
s_cbranch_scc0 L_roledone
s_mov_b32 s59, 2
s_mov_b32 s29, s42
s_mov_b64 s[12:13], s[40:41]
s_mov_b32 s14, 5242880
s_and_b32 s52, s29, 7
s_lshr_b32 s53, s29, 3
s_mov_b32 s100, 0x37121126
s_mov_b32 s101, 0x00000031
L_roledone:
s_mov_b32 s57, 0
s_mov_b32 s55, 0
s_mov_b32 s26, 0
s_mov_b32 s27, 0
s_mov_b32 s50, 0
s_waitcnt vmcnt(32)
s_cmp_lg_u32 s3, 0
s_cbranch_scc1 L_nosig_1
v_mov_b32 v58, 0
v_mov_b32 v59, 1
s_mov_b64 exec, 1
global_atomic_add v58, v59, s[18:19] sc1
s_mov_b64 exec, -1
L_nosig_1:
v_dot2_f32_bf16 v44, v16, s49, 0
v_dot2_f32_bf16 v45, v16, v16, 0
v_dot2_f32_bf16 v44, v17, s49, v44
v_dot2_f32_bf16 v45, v17, v17, v45
v_dot2_f32_bf16 v44, v18, s49, v44
v_dot2_f32_bf16 v45, v18, v18, v45
v_dot2_f32_bf16 v44, v19, s49, v44
v_dot2_f32_bf16 v45, v19, v19, v45
v_dot2_f32_bf16 v44, v20, s49, v44
v_dot2_f32_bf16 v45, v20, v20, v45
v_dot2_f32_bf16 v44, v21, s49, v44
v_dot2_f32_bf16 v45, v21, v21, v45
v_dot2_f32_bf16 v44, v22, s49, v44
v_dot2_f32_bf16 v45, v22, v22, v45
v_dot2_f32_bf16 v44, v23, s49, v44
v_dot2_f32_bf16 v45, v23, v23, v45
v_dot2_f32_bf16 v46, v24, s49, 0
v_dot2_f32_bf16 v47, v24, v24, 0
v_dot2_f32_bf16 v46, v25, s49, v46
v_dot2_f32_bf16 v47, v25, v25, v47
v_dot2_f32_bf16 v46, v26, s49, v46
v_dot2_f32_bf16 v47, v26, v26, v47
v_dot2_f32_bf16 v46, v27, s49, v46
v_dot2_f32_bf16 v47, v27, v27, v47
v_dot2_f32_bf16 v46, v28, s49, v46
v_dot2_f32_bf16 v47, v28, v28, v47
v_dot2_f32_bf16 v46, v29, s49, v46
v_dot2_f32_bf16 v47, v29, v29, v47
v_dot2_f32_bf16 v46, v30, s49, v46
v_dot2_f32_bf16 v47, v30, v30, v47
v_dot2_f32_bf16 v46, v31, s49, v46
v_dot2_f32_bf16 v47, v31, v31, v47
s_nop 2
v_add_f32_dpp v44, v44, v44 quad_perm:[1,0,3,2] row_mask:0xf bank_mask:0xf
v_add_f32_dpp v45, v45, v45 quad_perm:[1,0,3,2] row_mask:0xf bank_mask:0xf
v_add_f32_dpp v46, v46, v46 quad_perm:[1,0,3,2] row_mask:0xf bank_mask:0xf
v_add_f32_dpp v47, v47, v47 quad_perm:[1,0,3,2] row_mask:0xf bank_mask:0xf
v_add_f32_dpp v44, v44, v44 quad_perm:[2,3,0,1] row_mask:0xf bank_mask:0xf
v_add_f32_dpp v45, v45, v45 quad_perm:[2,3,0,1] row_mask:0xf bank_mask:0xf
v_add_f32_dpp v46, v46, v46 quad_perm:[2,3,0,1] row_mask:0xf bank_mask:0xf
v_add_f32_dpp v47, v47, v47 quad_perm:[2,3,0,1] row_mask:0xf bank_mask:0xf
v_add_f32_dpp v44, v44, v44 row_half_mirror row_mask:0xf bank_mask:0xf
v_add_f32_dpp v45, v45, v45 row_half_mirror row_mask:0xf bank_mask:0xf
v_add_f32_dpp v46, v46, v46 row_half_mirror row_mask:0xf bank_mask:0xf
v_add_f32_dpp v47, v47, v47 row_half_mirror row_mask:0xf bank_mask:0xf
v_add_f32_dpp v44, v44, v44 row_mirror row_mask:0xf bank_mask:0xf
v_add_f32_dpp v45, v45, v45 row_mirror row_mask:0xf bank_mask:0xf
v_add_f32_dpp v46, v46, v46 row_mirror row_mask:0xf bank_mask:0xf
v_add_f32_dpp v47, v47, v47 row_mirror row_mask:0xf bank_mask:0xf
v_mov_b32 v48, v44
v_mov_b32 v49, v45
v_mov_b32 v50, v46
v_mov_b32 v51, v47
s_nop 1
v_permlane16_swap_b32 v44, v48
v_permlane16_swap_b32 v45, v49
v_permlane16_swap_b32 v46, v50
v_permlane16_swap_b32 v47, v51
v_add_f32 v44, v44, v48
v_add_f32 v45, v45, v49
v_add_f32 v46, v46, v50
v_add_f32 v47, v47, v51
v_mov_b32 v48, v44
v_mov_b32 v49, v45
v_mov_b32 v50, v46
v_mov_b32 v51, v47
s_nop 1
v_permlane32_swap_b32 v44, v48
v_permlane32_swap_b32 v45, v49
v_permlane32_swap_b32 v46, v50
v_permlane32_swap_b32 v47, v51
v_add_f32 v44, v44, v48
v_add_f32 v45, v45, v49
v_add_f32 v46, v46, v50
v_add_f32 v47, v47, v51
v_mul_f32 v44, 0x3acccccd, v44
v_mul_f32 v45, 0x3acccccd, v45
v_fma_f32 v45, -v44, v44, v45
v_add_f32 v45, 0x3727c5ac, v45
v_rsq_f32 v45, v45
v_mul_f32 v46, 0x3acccccd, v46
v_mul_f32 v47, 0x3acccccd, v47
v_fma_f32 v47, -v46, v46, v47
v_add_f32 v47, 0x3727c5ac, v47
v_rsq_f32 v47, v47
s_nop 0
v_lshlrev_b32 v32, 16, v32
v_sub_f32 v32, v32, v44
v_mul_f32 v32, v32, v45
v_cvt_pk_bf16_f32 v32, v32, v32
v_lshlrev_b32 v33, 16, v33
v_sub_f32 v33, v33, v44
v_mul_f32 v33, v33, v45
v_cvt_pk_bf16_f32 v33, v33, v33
v_lshlrev_b32 v34, 16, v34
v_sub_f32 v34, v34, v44
v_mul_f32 v34, v34, v45
v_cvt_pk_bf16_f32 v34, v34, v34
v_lshlrev_b32 v35, 16, v35
v_sub_f32 v35, v35, v44
v_mul_f32 v35, v35, v45
v_cvt_pk_bf16_f32 v35, v35, v35
v_lshlrev_b32 v36, 16, v36
v_sub_f32 v36, v36, v44
v_mul_f32 v36, v36, v45
v_cvt_pk_bf16_f32 v36, v36, v36
v_lshlrev_b32 v37, 16, v37
v_sub_f32 v37, v37, v46
v_mul_f32 v37, v37, v47
v_cvt_pk_bf16_f32 v37, v37, v37
v_lshlrev_b32 v38, 16, v38
v_sub_f32 v38, v38, v46
v_mul_f32 v38, v38, v47
v_cvt_pk_bf16_f32 v38, v38, v38
v_lshlrev_b32 v39, 16, v39
v_sub_f32 v39, v39, v46
v_mul_f32 v39, v39, v47
v_cvt_pk_bf16_f32 v39, v39, v39
v_lshlrev_b32 v40, 16, v40
v_sub_f32 v40, v40, v46
v_mul_f32 v40, v40, v47
v_cvt_pk_bf16_f32 v40, v40, v40
v_lshlrev_b32 v41, 16, v41
v_sub_f32 v41, v41, v46
v_mul_f32 v41, v41, v47
v_cvt_pk_bf16_f32 v41, v41, v41
v_mov_b32 v16, 0
v_mov_b32 v17, 0
v_mov_b32 v18, 0
v_mov_b32 v19, 0
v_mov_b32 v20, 0
v_mov_b32 v21, 0
v_mov_b32 v22, 0
v_mov_b32 v23, 0
v_mov_b32 v24, 0
v_mov_b32 v25, 0
v_mov_b32 v26, 0
v_mov_b32 v27, 0
v_mov_b32 v28, 0
v_mov_b32 v29, 0
v_mov_b32 v30, 0
v_mov_b32 v31, 0
v_and_b32 v52, v32, v2
v_and_b32 v53, v32, v3
s_nop 1
v_mfma_f32_4x4x4_16b_bf16 v[16:19], v[52:53], a[0:1], v[16:19]
v_mfma_f32_4x4x4_16b_bf16 v[20:23], v[52:53], a[2:3], v[20:23]
v_and_b32 v54, v37, v2
v_and_b32 v55, v37, v3
s_nop 1
v_mfma_f32_4x4x4_16b_bf16 v[24:27], v[54:55], a[0:1], v[24:27]
v_mfma_f32_4x4x4_16b_bf16 v[28:31], v[54:55], a[2:3], v[28:31]
v_and_b32 v52, v33, v2
v_and_b32 v53, v33, v3
s_nop 1
v_mfma_f32_4x4x4_16b_bf16 v[16:19], v[52:53], a[4:5], v[16:19]
v_mfma_f32_4x4x4_16b_bf16 v[20:23], v[52:53], a[6:7], v[20:23]
v_and_b32 v54, v38, v2
v_and_b32 v55, v38, v3
s_nop 1
v_mfma_f32_4x4x4_16b_bf16 v[24:27], v[54:55], a[4:5], v[24:27]
v_mfma_f32_4x4x4_16b_bf16 v[28:31], v[54:55], a[6:7], v[28:31]
v_and_b32 v52, v34, v2
v_and_b32 v53, v34, v3
s_nop 1
v_mfma_f32_4x4x4_16b_bf16 v[16:19], v[52:53], a[8:9], v[16:19]
v_mfma_f32_4x4x4_16b_bf16 v[20:23], v[52:53], a[10:11], v[20:23]
v_and_b32 v54, v39, v2
v_and_b32 v55, v39, v3
s_nop 1
v_mfma_f32_4x4x4_16b_bf16 v[24:27], v[54:55], a[8:9], v[24:27]
v_mfma_f32_4x4x4_16b_bf16 v[28:31], v[54:55], a[10:11], v[28:31]
v_and_b32 v52, v35, v2
v_and_b32 v53, v35, v3
s_nop 1
v_mfma_f32_4x4x4_16b_bf16 v[16:19], v[52:53], a[12:13], v[16:19]
v_mfma_f32_4x4x4_16b_bf16 v[20:23], v[52:53], a[14:15], v[20:23]
v_and_b32 v54, v40, v2
v_and_b32 v55, v40, v3
s_nop 1
v_mfma_f32_4x4x4_16b_bf16 v[24:27], v[54:55], a[12:13], v[24:27]
v_mfma_f32_4x4x4_16b_bf16 v[28:31], v[54:55], a[14:15], v[28:31]
v_and_b32 v52, v36, v2
v_and_b32 v53, v36, v3
s_nop 1
v_mfma_f32_4x4x4_16b_bf16 v[16:19], v[52:53], a[16:17], v[16:19]
v_mfma_f32_4x4x4_16b_bf16 v[20:23], v[52:53], a[18:19], v[20:23]
v_and_b32 v54, v41, v2
v_and_b32 v55, v41, v3
s_nop 1
v_mfma_f32_4x4x4_16b_bf16 v[24:27], v[54:55], a[16:17], v[24:27]
v_mfma_f32_4x4x4_16b_bf16 v[28:31], v[54:55], a[18:19], v[28:31]
s_nop 4
v_permlane32_swap_b32 v16, v20
v_permlane32_swap_b32 v17, v21
v_permlane32_swap_b32 v18, v22
v_permlane32_swap_b32 v19, v23
v_permlane32_swap_b32 v24, v28
v_permlane32_swap_b32 v25, v29
v_permlane32_swap_b32 v26, v30
v_permlane32_swap_b32 v27, v31
v_add_f32 v16, v16, v20
v_add_f32 v17, v17, v21
v_add_f32 v18, v18, v22
v_add_f32 v19, v19, v23
v_add_f32 v24, v24, v28
v_add_f32 v25, v25, v29
v_add_f32 v26, v26, v30
v_add_f32 v27, v27, v31
s_nop 0
v_permlane16_swap_b32 v16, v17
v_permlane16_swap_b32 v18, v19
v_permlane16_swap_b32 v24, v25
v_permlane16_swap_b32 v26, v27
v_add_f32 v16, v16, v17
v_add_f32 v18, v18, v19
v_add_f32 v24, v24, v25
v_add_f32 v26, v26, v27
s_lshl_b32 s32, s3, 10
s_add_u32 s32, s32, 65536
v_and_b32 v59, 15, v0
v_lshlrev_b32 v59, 5, v59
v_lshrrev_b32 v61, 5, v0
v_lshl_add_u32 v59, v61, 4, v59
v_bfe_u32 v61, v0, 4, 1
v_lshl_add_u32 v59, v61, 2, v59
v_add_u32 v59, s32, v59
ds_write2_b32 v59, v16, v18 offset0:0 offset1:2
ds_write2_b32 v59, v24, v26 offset0:128 offset1:130
s_waitcnt lgkmcnt(0)
s_barrier
s_cmp_lg_u32 s3, 0
s_cbranch_scc1 L_qiw_2
v_lshlrev_b32 v59, 4, v0
v_add_u32 v59, 65536, v59
ds_read_b128 v[16:19], v59 offset:0
ds_read_b128 v[20:23], v59 offset:1024
ds_read_b128 v[24:27], v59 offset:2048
ds_read_b128 v[28:31], v59 offset:3072
s_lshl_b32 s42, s24, 3
s_add_u32 s42, s42, s25
s_lshl_b32 s42, s42, 9
s_add_u32 s42, s42, 851968
v_lshrrev_b32 v60, 5, v0
v_mul_u32_u24 v60, 131072, v60
v_and_b32 v61, 31, v0
v_lshl_add_u32 v60, v61, 4, v60
v_add_u32 v60, s42, v60
s_waitcnt lgkmcnt(0)
v_add_f32 v16, v16, v20
v_add_f32 v24, v24, v28
v_add_f32 v17, v17, v21
v_add_f32 v25, v25, v29
v_add_f32 v18, v18, v22
v_add_f32 v26, v26, v30
v_add_f32 v19, v19, v23
v_add_f32 v27, v27, v31
v_add_f32 v16, v16, v24
v_add_f32 v17, v17, v25
v_add_f32 v18, v18, v26
v_add_f32 v19, v19, v27
global_store_dwordx4 v60, v[16:19], s[16:17] sc1
L_qiw_2:
s_mov_b32 s30, 131072
s_branch L_lka_pre
L_s4:
s_mov_b32 s50, s27
s_mul_i32 s42, s3, 20480
s_add_u32 s42, s42, 65536
v_lshlrev_b32 v8, 4, v0
v_add_u32 v8, s42, v8
v_lshrrev_b32 v58, 3, v0
v_mul_u32_u24 v9, 80, v58
s_mul_i32 s42, s3, 640
s_add_u32 s42, s42, 151808
v_add_u32 v9, s42, v9
v_and_b32 v10, 7, v0
v_lshlrev_b32 v10, 3, v10
v_lshrrev_b32 v59, 5, v0
v_lshl_add_u32 v10, v59, 2, v10
v_bfe_u32 v59, v0, 4, 1
v_add_u32 v10, v10, v59
v_bfe_u32 v59, v0, 3, 1
v_lshl_add_u32 v10, v59, 1, v10
s_lshl_b32 s42, s3, 8
s_add_u32 s42, s42, 154624
v_lshlrev_b32 v10, 2, v10
v_add_u32 v10, s42, v10
v_min_u32 v58, 39, v0
v_lshlrev_b32 v58, 2, v58
s_mul_i32 s42, s3, 160
v_add_u32 v58, s42, v58
v_lshlrev_b32 v14, 1, v58
v_lshlrev_b32 v11, 2, v58
v_add_u32 v12, 151808, v11
v_mov_b32 v13, 0
v_cmp_gt_u32 vcc, 40, v0
s_nop 1
v_cndmask_b32 v13, v13, 1.0, vcc
s_cmp_lg_u32 s50, 1
s_cbranch_scc1 L_s4nc_3
s_waitcnt vmcnt(0)
ds_read_b128 v[48:51], v8 offset:0
ds_read_b128 v[52:55], v8 offset:1024
ds_read_b128 v[56:59], v8 offset:2048
ds_read_b128 v[60:63], v8 offset:3072
v_mov_b32 v36, 0
v_mov_b32 v37, 0
v_mov_b32 v38, 0
v_mov_b32 v39, 0
v_mov_b32 v40, 0
v_mov_b32 v41, 0
v_mov_b32 v42, 0
v_mov_b32 v43, 0
v_and_b32 v44, s49, v2
v_and_b32 v45, s49, v3
v_and_b32 v46, s49, v2
v_and_b32 v47, s49, v3
s_waitcnt lgkmcnt(3)
s_nop 1
v_mfma_f32_4x4x4_16b_bf16 v[36:39], v[44:45], v[48:49], v[36:39]
v_mfma_f32_4x4x4_16b_bf16 v[40:43], v[44:45], v[50:51], v[40:43]
ds_read_b128 v[48:51], v8 offset:4096
s_waitcnt lgkmcnt(3)
s_nop 1
v_mfma_f32_4x4x4_16b_bf16 v[36:39], v[46:47], v[52:53], v[36:39]
v_mfma_f32_4x4x4_16b_bf16 v[40:43], v[46:47], v[54:55], v[40:43]
ds_read_b128 v[52:55], v8 offset:5120
s_waitcnt lgkmcnt(3)
s_nop 1
v_mfma_f32_4x4x4_16b_bf16 v[36:39], v[44:45], v[56:57], v[36:39]
v_mfma_f32_4x4x4_16b_bf16 v[40:43], v[44:45], v[58:59], v[40:43]
ds_read_b128 v[56:59], v8 offset:6144
s_waitcnt lgkmcnt(3)
s_nop 1
v_mfma_f32_4x4x4_16b_bf16 v[36:39], v[46:47], v[60:61], v[36:39]
v_mfma_f32_4x4x4_16b_bf16 v[40:43], v[46:47], v[62:63], v[40:43]
ds_read_b128 v[60:63], v8 offset:7168
s_waitcnt lgkmcnt(3)
s_nop 1
v_mfma_f32_4x4x4_16b_bf16 v[36:39], v[44:45], v[48:49], v[36:39]
v_mfma_f32_4x4x4_16b_bf16 v[40:43], v[44:45], v[50:51], v[40:43]
ds_read_b128 v[48:51], v8 offset:8192
s_waitcnt lgkmcnt(3)
s_nop 1
v_mfma_f32_4x4x4_16b_bf16 v[36:39], v[46:47], v[52:53], v[36:39]
v_mfma_f32_4x4x4_16b_bf16 v[40:43], v[46:47], v[54:55], v[40:43]
ds_read_b128 v[52:55], v8 offset:9216
s_waitcnt lgkmcnt(3)
s_nop 1
v_mfma_f32_4x4x4_16b_bf16 v[36:39], v[44:45], v[56:57], v[36:39]
v_mfma_f32_4x4x4_16b_bf16 v[40:43], v[44:45], v[58:59], v[40:43]
ds_read_b128 v[56:59], v8 offset:10240
s_waitcnt lgkmcnt(3)
s_nop 1
v_mfma_f32_4x4x4_16b_bf16 v[36:39], v[46:47], v[60:61], v[36:39]
v_mfma_f32_4x4x4_16b_bf16 v[40:43], v[46:47], v[62:63], v[40:43]
ds_read_b128 v[60:63], v8 offset:11264
s_waitcnt lgkmcnt(3)
s_nop 1
v_mfma_f32_4x4x4_16b_bf16 v[36:39], v[44:45], v[48:49], v[36:39]
v_mfma_f32_4x4x4_16b_bf16 v[40:43], v[44:45], v[50:51], v[40:43]
ds_read_b128 v[48:51], v8 offset:12288
s_waitcnt lgkmcnt(3)
s_nop 1
v_mfma_f32_4x4x4_16b_bf16 v[36:39], v[46:47], v[52:53], v[36:39]
v_mfma_f32_4x4x4_16b_bf16 v[40:43], v[46:47], v[54:55], v[40:43]
ds_read_b128 v[52:55], v8 offset:13312
s_waitcnt lgkmcnt(3)
s_nop 1
v_mfma_f32_4x4x4_16b_bf16 v[36:39], v[44:45], v[56:57], v[36:39]
v_mfma_f32_4x4x4_16b_bf16 v[40:43], v[44:45], v[58:59], v[40:43]
ds_read_b128 v[56:59], v8 offset:14336
s_waitcnt lgkmcnt(3)
s_nop 1
v_mfma_f32_4x4x4_16b_bf16 v[36:39], v[46:47], v[60:61], v[36:39]
v_mfma_f32_4x4x4_16b_bf16 v[40:43], v[46:47], v[62:63], v[40:43]
ds_read_b128 v[60:63], v8 offset:15360
s_waitcnt lgkmcnt(3)
s_nop 1
v_mfma_f32_4x4x4_16b_bf16 v[36:39], v[44:45], v[48:49], v[36:39]
v_mfma_f32_4x4x4_16b_bf16 v[40:43], v[44:45], v[50:51], v[40:43]
ds_read_b128 v[48:51], v8 offset:16384
s_waitcnt lgkmcnt(3)
s_nop 1
v_mfma_f32_4x4x4_16b_bf16 v[36:39], v[46:47], v[52:53], v[36:39]
v_mfma_f32_4x4x4_16b_bf16 v[40:43], v[46:47], v[54:55], v[40:43]
ds_read_b128 v[52:55], v8 offset:17408
s_waitcnt lgkmcnt(3)
s_nop 1
v_mfma_f32_4x4x4_16b_bf16 v[36:39], v[44:45], v[56:57], v[36:39]
v_mfma_f32_4x4x4_16b_bf16 v[40:43], v[44:45], v[58:59], v[40:43]
ds_read_b128 v[56:59], v8 offset:18432
s_waitcnt lgkmcnt(3)
s_nop 1
v_mfma_f32_4x4x4_16b_bf16 v[36:39], v[46:47], v[60:61], v[36:39]
v_mfma_f32_4x4x4_16b_bf16 v[40:43], v[46:47], v[62:63], v[40:43]
ds_read_b128 v[60:63], v8 offset:19456
s_waitcnt lgkmcnt(3)
s_nop 1
v_mfma_f32_4x4x4_16b_bf16 v[36:39], v[44:45], v[48:49], v[36:39]
v_mfma_f32_4x4x4_16b_bf16 v[40:43], v[44:45], v[50:51], v[40:43]
s_waitcnt lgkmcnt(2)
s_nop 1
v_mfma_f32_4x4x4_16b_bf16 v[36:39], v[46:47], v[52:53], v[36:39]
v_mfma_f32_4x4x4_16b_bf16 v[40:43], v[46:47], v[54:55], v[40:43]
s_waitcnt lgkmcnt(1)
s_nop 1
v_mfma_f32_4x4x4_16b_bf16 v[36:39], v[44:45], v[56:57], v[36:39]
v_mfma_f32_4x4x4_16b_bf16 v[40:43], v[44:45], v[58:59], v[40:43]
s_waitcnt lgkmcnt(0)
s_nop 1
v_mfma_f32_4x4x4_16b_bf16 v[36:39], v[46:47], v[60:61], v[36:39]
v_mfma_f32_4x4x4_16b_bf16 v[40:43], v[46:47], v[62:63], v[40:43]
s_nop 4
v_permlane32_swap_b32 v36, v40
v_permlane32_swap_b32 v37, v41
v_permlane32_swap_b32 v38, v42
v_permlane32_swap_b32 v39, v43
v_add_f32 v36, v36, v40
v_add_f32 v37, v37, v41
v_add_f32 v38, v38, v42
v_add_f32 v39, v39, v43
s_nop 0
v_permlane16_swap_b32 v36, v37
v_permlane16_swap_b32 v38, v39
v_add_f32 v36, v36, v37
v_add_f32 v38, v38, v39
s_nop 1
v_add_f32_dpp v44, v36, v36 row_ror:8 row_mask:0xf bank_mask:0x3
v_add_f32_dpp v44, v38, v38 row_ror:8 row_mask:0xf bank_mask:0xc
ds_write_b32 v10, v44
s_waitcnt lgkmcnt(0)
s_barrier
s_cmp_lg_u32 s3, 0
s_cbranch_scc1 L_cs_4
v_lshlrev_b32 v58, 2, v0
v_add_u32 v59, 154624, v58
ds_read2_b32 v[16:17], v59 offset0:0 offset1:64
ds_read2_b32 v[18:19], v59 offset0:128 offset1:192
s_waitcnt lgkmcnt(0)
v_add_f32 v16, v16, v17
v_add_f32 v18, v18, v19
v_add_f32 v30, v16, v18
v_add_u32 v59, 155904, v58
ds_write_b32 v59, v30
s_waitcnt lgkmcnt(0)
L_cs_4:
s_barrier
L_s4nc_3:
s_sub_u32 s32, s50, 1
s_mul_i32 s32, s32, 2048
s_add_u32 s32, s32, 688128
s_and_b32 s33, s29, 3
s_mul_i32 s33, s33, 8192
s_add_u32 s32, s32, s33
v_add_u32 v50, s32, v14
s_mov_b32 s31, 0
global_load_dwordx2 v[4:5], v50, s[16:17] sc1
s_waitcnt vmcnt(0)
s_branch L_fc_8
L_fp_5:
s_waitcnt vmcnt(5)
global_load_dwordx2 v[4:5], v50, s[16:17] sc1
L_fc_8:
v_max_u32 v58, v4, v5
v_cmp_eq_u32 vcc, -1, v58
s_nop 1
s_cmp_lg_u64 vcc, 0
s_cbranch_scc1 L_fa_6
s_branch L_fd_7
L_fa_6:
s_add_u32 s31, s31, 1
s_cmp_ge_u32 s31, 1600000
s_cbranch_scc1 L_fd_7
s_and_b32 s32, s31, 7
s_cmp_eq_u32 s32, 0
s_cbranch_scc1 L_fp_5
s_branch L_fc_8
L_fd_7:
v_lshlrev_b32 v16, 16, v4
v_and_b32 v17, 0xffff0000, v4
v_lshlrev_b32 v18, 16, v5
v_and_b32 v19, 0xffff0000, v5
v_cvt_pk_bf16_f32 v48, v16, v16
v_cvt_pk_bf16_f32 v49, v17, v17
v_cvt_pk_bf16_f32 v50, v18, v18
v_cvt_pk_bf16_f32 v51, v19, v19
ds_write_b128 v12, v[48:51]
v_add_f32 v58, v16, v17
v_add_f32 v59, v18, v19
v_mul_f32 v60, v16, v16
v_add_f32 v58, v58, v59
v_fmac_f32 v60, v17, v17
v_fmac_f32 v60, v18, v18
v_fmac_f32 v60, v19, v19
v_mul_f32 v58, v58, v13
v_mul_f32 v60, v60, v13
s_nop 0
v_add_f32_dpp v58, v58, v58 quad_perm:[1,0,3,2] row_mask:0xf bank_mask:0xf
v_add_f32_dpp v60, v60, v60 quad_perm:[1,0,3,2] row_mask:0xf bank_mask:0xf
s_nop 0
v_add_f32_dpp v58, v58, v58 quad_perm:[2,3,0,1] row_mask:0xf bank_mask:0xf
v_add_f32_dpp v60, v60, v60 quad_perm:[2,3,0,1] row_mask:0xf bank_mask:0xf
s_nop 0
v_add_f32_dpp v58, v58, v58 row_half_mirror row_mask:0xf bank_mask:0xf
v_add_f32_dpp v60, v60, v60 row_half_mirror row_mask:0xf bank_mask:0xf
s_nop 0
v_add_f32_dpp v58, v58, v58 row_mirror row_mask:0xf bank_mask:0xf
v_add_f32_dpp v60, v60, v60 row_mirror row_mask:0xf bank_mask:0xf
s_nop 1
v_permlane32_swap_b32 v58, v60
v_add_f32 v58, v58, v60
v_mov_b32 v59, v58
s_nop 1
v_permlane16_swap_b32 v58, v59
v_add_f32 v58, v58, v59
v_lshrrev_b32 v59, 5, v0
v_lshlrev_b32 v59, 2, v59
s_lshl_b32 s32, s3, 3
s_add_u32 s32, s32, 155648
v_add_u32 v59, s32, v59
s_mov_b32 exec_lo, 1
s_mov_b32 exec_hi, 1
ds_write_b32 v59, v58
s_mov_b64 exec, -1
s_waitcnt lgkmcnt(0)
ds_read_b128 v[48:51], v8 offset:0
ds_read_b128 v[52:55], v8 offset:1024
ds_read_b128 v[56:59], v8 offset:2048
ds_read_b128 v[60:63], v8 offset:3072
ds_read_b128 v[16:19], v9 offset:0
ds_read_b128 v[20:23], v9 offset:16
ds_read_b128 v[24:27], v9 offset:32
ds_read_b128 v[28:31], v9 offset:48
ds_read_b128 v[32:35], v9 offset:64
v_mov_b32 v36, 0
v_mov_b32 v37, 0
v_mov_b32 v38, 0
v_mov_b32 v39, 0
v_mov_b32 v40, 0
v_mov_b32 v41, 0
v_mov_b32 v42, 0
v_mov_b32 v43, 0
s_waitcnt lgkmcnt(4)
v_and_b32 v44, v16, v2
v_and_b32 v45, v16, v3
v_and_b32 v46, v17, v2
v_and_b32 v47, v17, v3
s_nop 1
v_mfma_f32_4x4x4_16b_bf16 v[36:39], v[44:45], v[48:49], v[36:39]
v_mfma_f32_4x4x4_16b_bf16 v[40:43], v[44:45], v[50:51], v[40:43]
ds_read_b128 v[48:51], v8 offset:4096
v_and_b32 v44, v18, v2
v_and_b32 v45, v18, v3
v_mfma_f32_4x4x4_16b_bf16 v[36:39], v[46:47], v[52:53], v[36:39]
v_mfma_f32_4x4x4_16b_bf16 v[40:43], v[46:47], v[54:55], v[40:43]
ds_read_b128 v[52:55], v8 offset:5120
v_and_b32 v46, v19, v2
v_and_b32 v47, v19, v3
v_mfma_f32_4x4x4_16b_bf16 v[36:39], v[44:45], v[56:57], v[36:39]
v_mfma_f32_4x4x4_16b_bf16 v[40:43], v[44:45], v[58:59], v[40:43]
ds_read_b128 v[56:59], v8 offset:6144
s_waitcnt lgkmcnt(6)
v_and_b32 v44, v20, v2
v_and_b32 v45, v20, v3
v_mfma_f32_4x4x4_16b_bf16 v[36:39], v[46:47], v[60:61], v[36:39]
v_mfma_f32_4x4x4_16b_bf16 v[40:43], v[46:47], v[62:63], v[40:43]
ds_read_b128 v[60:63], v8 offset:7168
v_and_b32 v46, v21, v2
v_and_b32 v47, v21, v3
s_waitcnt lgkmcnt(3)
v_mfma_f32_4x4x4_16b_bf16 v[36:39], v[44:45], v[48:49], v[36:39]
v_mfma_f32_4x4x4_16b_bf16 v[40:43], v[44:45], v[50:51], v[40:43]
ds_read_b128 v[48:51], v8 offset:8192
v_and_b32 v44, v22, v2
v_and_b32 v45, v22, v3
s_waitcnt lgkmcnt(3)
v_mfma_f32_4x4x4_16b_bf16 v[36:39], v[46:47], v[52:53], v[36:39]
v_mfma_f32_4x4x4_16b_bf16 v[40:43], v[46:47], v[54:55], v[40:43]
ds_read_b128 v[52:55], v8 offset:9216
v_and_b32 v46, v23, v2
v_and_b32 v47, v23, v3
s_waitcnt lgkmcnt(3)
v_mfma_f32_4x4x4_16b_bf16 v[36:39], v[44:45], v[56:57], v[36:39]
v_mfma_f32_4x4x4_16b_bf16 v[40:43], v[44:45], v[58:59], v[40:43]
ds_read_b128 v[56:59], v8 offset:10240
v_and_b32 v44, v24, v2
v_and_b32 v45, v24, v3
s_waitcnt lgkmcnt(3)
v_mfma_f32_4x4x4_16b_bf16 v[36:39], v[46:47], v[60:61], v[36:39]
v_mfma_f32_4x4x4_16b_bf16 v[40:43], v[46:47], v[62:63], v[40:43]
ds_read_b128 v[60:63], v8 offset:11264
v_and_b32 v46, v25, v2
v_and_b32 v47, v25, v3
s_waitcnt lgkmcnt(3)
v_mfma_f32_4x4x4_16b_bf16 v[36:39], v[44:45], v[48:49], v[36:39]
v_mfma_f32_4x4x4_16b_bf16 v[40:43], v[44:45], v[50:51], v[40:43]
ds_read_b128 v[48:51], v8 offset:12288
v_and_b32 v44, v26, v2
v_and_b32 v45, v26, v3
s_waitcnt lgkmcnt(3)
v_mfma_f32_4x4x4_16b_bf16 v[36:39], v[46:47], v[52:53], v[36:39]
v_mfma_f32_4x4x4_16b_bf16 v[40:43], v[46:47], v[54:55], v[40:43]
ds_read_b128 v[52:55], v8 offset:13312
v_and_b32 v46, v27, v2
v_and_b32 v47, v27, v3
s_waitcnt lgkmcnt(3)
v_mfma_f32_4x4x4_16b_bf16 v[36:39], v[44:45], v[56:57], v[36:39]
v_mfma_f32_4x4x4_16b_bf16 v[40:43], v[44:45], v[58:59], v[40:43]
ds_read_b128 v[56:59], v8 offset:14336
v_and_b32 v44, v28, v2
v_and_b32 v45, v28, v3
s_waitcnt lgkmcnt(3)
v_mfma_f32_4x4x4_16b_bf16 v[36:39], v[46:47], v[60:61], v[36:39]
v_mfma_f32_4x4x4_16b_bf16 v[40:43], v[46:47], v[62:63], v[40:43]
ds_read_b128 v[60:63], v8 offset:15360
v_and_b32 v46, v29, v2
v_and_b32 v47, v29, v3
s_waitcnt lgkmcnt(3)
v_mfma_f32_4x4x4_16b_bf16 v[36:39], v[44:45], v[48:49], v[36:39]
v_mfma_f32_4x4x4_16b_bf16 v[40:43], v[44:45], v[50:51], v[40:43]
ds_read_b128 v[48:51], v8 offset:16384
v_and_b32 v44, v30, v2
v_and_b32 v45, v30, v3
s_waitcnt lgkmcnt(3)
v_mfma_f32_4x4x4_16b_bf16 v[36:39], v[46:47], v[52:53], v[36:39]
v_mfma_f32_4x4x4_16b_bf16 v[40:43], v[46:47], v[54:55], v[40:43]
ds_read_b128 v[52:55], v8 offset:17408
v_and_b32 v46, v31, v2
v_and_b32 v47, v31, v3
s_waitcnt lgkmcnt(3)
v_mfma_f32_4x4x4_16b_bf16 v[36:39], v[44:45], v[56:57], v[36:39]
v_mfma_f32_4x4x4_16b_bf16 v[40:43], v[44:45], v[58:59], v[40:43]
ds_read_b128 v[56:59], v8 offset:18432
v_and_b32 v44, v32, v2
v_and_b32 v45, v32, v3
s_waitcnt lgkmcnt(3)
v_mfma_f32_4x4x4_16b_bf16 v[36:39], v[46:47], v[60:61], v[36:39]
v_mfma_f32_4x4x4_16b_bf16 v[40:43], v[46:47], v[62:63], v[40:43]
ds_read_b128 v[60:63], v8 offset:19456
v_and_b32 v46, v33, v2
v_and_b32 v47, v33, v3
s_waitcnt lgkmcnt(3)
v_mfma_f32_4x4x4_16b_bf16 v[36:39], v[44:45], v[48:49], v[36:39]
v_mfma_f32_4x4x4_16b_bf16 v[40:43], v[44:45], v[50:51], v[40:43]
v_and_b32 v44, v34, v2
v_and_b32 v45, v34, v3
s_waitcnt lgkmcnt(2)
v_mfma_f32_4x4x4_16b_bf16 v[36:39], v[46:47], v[52:53], v[36:39]
v_mfma_f32_4x4x4_16b_bf16 v[40:43], v[46:47], v[54:55], v[40:43]
v_and_b32 v46, v35, v2
v_and_b32 v47, v35, v3
s_waitcnt lgkmcnt(1)
v_mfma_f32_4x4x4_16b_bf16 v[36:39], v[44:45], v[56:57], v[36:39]
v_mfma_f32_4x4x4_16b_bf16 v[40:43], v[44:45], v[58:59], v[40:43]
s_waitcnt lgkmcnt(0)
v_mfma_f32_4x4x4_16b_bf16 v[36:39], v[46:47], v[60:61], v[36:39]
v_mfma_f32_4x4x4_16b_bf16 v[40:43], v[46:47], v[62:63], v[40:43]
s_nop 4
v_permlane32_swap_b32 v36, v40
v_permlane32_swap_b32 v37, v41
v_permlane32_swap_b32 v38, v42
v_permlane32_swap_b32 v39, v43
v_add_f32 v36, v36, v40
v_add_f32 v37, v37, v41
v_add_f32 v38, v38, v42
v_add_f32 v39, v39, v43
s_nop 0
v_permlane16_swap_b32 v36, v37
v_permlane16_swap_b32 v38, v39
v_add_f32 v36, v36, v37
v_add_f32 v38, v38, v39
s_nop 1
v_add_f32_dpp v44, v36, v36 row_ror:8 row_mask:0xf bank_mask:0x3
v_add_f32_dpp v44, v38, v38 row_ror:8 row_mask:0xf bank_mask:0xc
ds_write_b32 v10, v44
s_waitcnt lgkmcnt(0)
s_barrier
s_cmp_lg_u32 s3, 0
s_cbranch_scc1 L_s4w_9
v_lshlrev_b32 v58, 2, v0
v_add_u32 v59, 154624, v58
ds_read2_b32 v[16:17], v59 offset0:0 offset1:64
ds_read2_b32 v[18:19], v59 offset0:128 offset1:192
v_mov_b32 v60, 155648
ds_read_b128 v[20:23], v60
ds_read_b128 v[24:27], v60 offset:16
v_add_u32 v59, 155904, v58
ds_read_b32 v28, v59
s_waitcnt lgkmcnt(0)
v_add_f32 v16, v16, v17
v_add_f32 v18, v18, v19
v_add_f32 v30, v16, v18
v_add_f32 v20, v20, v22
v_add_f32 v24, v24, v26
v_add_f32 v20, v20, v24
v_add_f32 v21, v21, v23
v_add_f32 v25, v25, v27
v_add_f32 v21, v21, v25
v_mul_f32 v20, 0x3acccccd, v20
v_mul_f32 v21, 0x3acccccd, v21
v_fma_f32 v21, -v20, v20, v21
v_add_f32 v21, 0x3727c5ac, v21
v_rsq_f32 v21, v21
v_fma_f32 v30, -v20, v28, v30
v_mul_f32 v30, v30, v21
s_nop 1
v_mov_b32_dpp v32, v30 quad_perm:[1,0,3,2] row_mask:0xf bank_mask:0xf
v_cvt_pk_bf16_f32 v32, v30, v32
s_nop 1
v_mov_b32_dpp v33, v32 quad_perm:[2,3,0,1] row_mask:0xf bank_mask:0xf
v_mov_b32_dpp v34, v32 row_shl:4 row_mask:0xf bank_mask:0xf
s_nop 0
v_mov_b32_dpp v35, v33 row_shl:4 row_mask:0xf bank_mask:0xf
s_mul_i32 s32, s50, 8192
s_add_u32 s32, s32, 786432
s_lshl_b32 s33, s29, 7
s_add_u32 s32, s32, s33
v_lshlrev_b32 v58, 1, v0
v_add_u32 v58, s32, v58
s_mov_b32 exec_lo, 0x01010101
s_mov_b32 exec_hi, 0x01010101
global_store_dwordx4 v58, v[32:35], s[16:17] sc1
s_mov_b64 exec, -1
L_s4w_9:
s_cmp_eq_u32 s50, 3
s_cselect_b32 s51, 1, 0
s_barrier
s_branch L_disp
L_lka:
s_mov_b32 s30, s55
buffer_load_dwordx4 v[64:67], v1, s[4:7], s30 offen nt
s_add_u32 s30, s30, 4096
buffer_load_dwordx4 v[68:71], v1, s[4:7], s30 offen nt
s_add_u32 s30, s30, 4096
buffer_load_dwordx4 v[72:75], v1, s[4:7], s30 offen nt
s_add_u32 s30, s30, 4096
buffer_load_dwordx4 v[76:79], v1, s[4:7], s30 offen nt
s_add_u32 s30, s30, 4096
buffer_load_dwordx4 v[80:83], v1, s[4:7], s30 offen nt
s_add_u32 s30, s30, 4096
buffer_load_dwordx4 v[84:87], v1, s[4:7], s30 offen nt
s_add_u32 s30, s30, 4096
buffer_load_dwordx4 v[88:91], v1, s[4:7], s30 offen nt
s_add_u32 s30, s30, 4096
buffer_load_dwordx4 v[92:95], v1, s[4:7], s30 offen nt
s_add_u32 s30, s30, 4096
buffer_load_dwordx4 v[96:99], v1, s[4:7], s30 offen nt
s_add_u32 s30, s30, 4096
buffer_load_dwordx4 v[100:103], v1, s[4:7], s30 offen nt
s_add_u32 s30, s30, 4096
buffer_load_dwordx4 v[104:107], v1, s[4:7], s30 offen nt
s_add_u32 s30, s30, 4096
buffer_load_dwordx4 v[108:111], v1, s[4:7], s30 offen nt
s_add_u32 s30, s30, 4096
buffer_load_dwordx4 v[112:115], v1, s[4:7], s30 offen nt
s_add_u32 s30, s30, 4096
buffer_load_dwordx4 v[116:119], v1, s[4:7], s30 offen nt
s_add_u32 s30, s30, 4096
buffer_load_dwordx4 v[120:123], v1, s[4:7], s30 offen nt
s_add_u32 s30, s30, 4096
buffer_load_dwordx4 v[124:127], v1, s[4:7], s30 offen nt
s_add_u32 s30, s30, 4096
buffer_load_dwordx4 v[128:131], v1, s[4:7], s30 offen nt
s_add_u32 s30, s30, 4096
buffer_load_dwordx4 v[132:135], v1, s[4:7], s30 offen nt
s_add_u32 s30, s30, 4096
buffer_load_dwordx4 v[136:139], v1, s[4:7], s30 offen nt
s_add_u32 s30, s30, 4096
buffer_load_dwordx4 v[140:143], v1, s[4:7], s30 offen nt
s_add_u32 s30, s30, 4096
buffer_load_dwordx4 v[144:147], v1, s[4:7], s30 offen nt
s_add_u32 s30, s30, 4096
buffer_load_dwordx4 v[148:151], v1, s[4:7], s30 offen nt
s_add_u32 s30, s30, 4096
buffer_load_dwordx4 v[152:155], v1, s[4:7], s30 offen nt
s_add_u32 s30, s30, 4096
buffer_load_dwordx4 v[156:159], v1, s[4:7], s30 offen nt
s_add_u32 s30, s30, 4096
buffer_load_dwordx4 v[160:163], v1, s[4:7], s30 offen nt
s_add_u32 s30, s30, 4096
buffer_load_dwordx4 v[164:167], v1, s[4:7], s30 offen nt
s_add_u32 s30, s30, 4096
buffer_load_dwordx4 v[168:171], v1, s[4:7], s30 offen nt
s_add_u32 s30, s30, 4096
buffer_load_dwordx4 v[172:175], v1, s[4:7], s30 offen nt
s_add_u32 s30, s30, 4096
buffer_load_dwordx4 v[176:179], v1, s[4:7], s30 offen nt
s_add_u32 s30, s30, 4096
buffer_load_dwordx4 v[180:183], v1, s[4:7], s30 offen nt
s_add_u32 s30, s30, 4096
buffer_load_dwordx4 v[184:187], v1, s[4:7], s30 offen nt
s_add_u32 s30, s30, 4096
buffer_load_dwordx4 v[188:191], v1, s[4:7], s30 offen nt
s_add_u32 s30, s30, 4096
L_lka_pre:
s_waitcnt vmcnt(58)
buffer_load_dwordx4 v[192:195], v1, s[4:7], s30 offen nt
s_add_u32 s30, s30, 4096
s_waitcnt vmcnt(58)
buffer_load_dwordx4 v[196:199], v1, s[4:7], s30 offen nt
s_add_u32 s30, s30, 4096
s_waitcnt vmcnt(58)
buffer_load_dwordx4 v[200:203], v1, s[4:7], s30 offen nt
s_add_u32 s30, s30, 4096
s_waitcnt vmcnt(58)
buffer_load_dwordx4 v[204:207], v1, s[4:7], s30 offen nt
s_add_u32 s30, s30, 4096
s_waitcnt vmcnt(58)
buffer_load_dwordx4 v[208:211], v1, s[4:7], s30 offen nt
s_add_u32 s30, s30, 4096
s_waitcnt vmcnt(58)
buffer_load_dwordx4 v[212:215], v1, s[4:7], s30 offen nt
s_add_u32 s30, s30, 4096
s_waitcnt vmcnt(58)
buffer_load_dwordx4 v[216:219], v1, s[4:7], s30 offen nt
s_add_u32 s30, s30, 4096
s_waitcnt vmcnt(58)
buffer_load_dwordx4 v[220:223], v1, s[4:7], s30 offen nt
s_add_u32 s30, s30, 4096
s_waitcnt vmcnt(58)
buffer_load_dwordx4 v[224:227], v1, s[4:7], s30 offen nt
s_add_u32 s30, s30, 4096
s_waitcnt vmcnt(58)
buffer_load_dwordx4 v[228:231], v1, s[4:7], s30 offen nt
s_add_u32 s30, s30, 4096
s_waitcnt vmcnt(58)
buffer_load_dwordx4 v[232:235], v1, s[4:7], s30 offen nt
s_add_u32 s30, s30, 4096
s_waitcnt vmcnt(58)
buffer_load_dwordx4 v[236:239], v1, s[4:7], s30 offen nt
s_add_u32 s30, s30, 4096
s_waitcnt vmcnt(58)
buffer_load_dwordx4 v[240:243], v1, s[4:7], s30 offen nt
s_add_u32 s30, s30, 4096
s_waitcnt vmcnt(58)
buffer_load_dwordx4 v[244:247], v1, s[4:7], s30 offen nt
s_add_u32 s30, s30, 4096
s_waitcnt vmcnt(58)
buffer_load_dwordx4 v[248:251], v1, s[4:7], s30 offen nt
s_add_u32 s30, s30, 4096
s_waitcnt vmcnt(58)
buffer_load_dwordx4 v[252:255], v1, s[4:7], s30 offen nt
s_add_u32 s30, s30, 4096
s_waitcnt vmcnt(58)
s_add_u32 m0, s54, 0
s_nop 0
buffer_load_dwordx4 v1, s[4:7], s30 offen nt lds
s_add_u32 s30, s30, 4096
s_waitcnt vmcnt(58)
s_add_u32 m0, s54, 1024
s_nop 0
buffer_load_dwordx4 v1, s[4:7], s30 offen nt lds
s_add_u32 s30, s30, 4096
s_waitcnt vmcnt(58)
s_add_u32 m0, s54, 2048
s_nop 0
buffer_load_dwordx4 v1, s[4:7], s30 offen nt lds
s_add_u32 s30, s30, 4096
s_waitcnt vmcnt(58)
s_add_u32 m0, s54, 3072
s_nop 0
buffer_load_dwordx4 v1, s[4:7], s30 offen nt lds
s_add_u32 s30, s30, 4096
s_waitcnt vmcnt(58)
s_add_u32 m0, s54, 4096
s_nop 0
buffer_load_dwordx4 v1, s[4:7], s30 offen nt lds
s_add_u32 s30, s30, 4096
s_waitcnt vmcnt(58)
s_add_u32 m0, s54, 5120
s_nop 0
buffer_load_dwordx4 v1, s[4:7], s30 offen nt lds
s_add_u32 s30, s30, 4096
s_waitcnt vmcnt(58)
s_add_u32 m0, s54, 6144
s_nop 0
buffer_load_dwordx4 v1, s[4:7], s30 offen nt lds
s_add_u32 s30, s30, 4096
s_waitcnt vmcnt(58)
s_add_u32 m0, s54, 7168
s_nop 0
buffer_load_dwordx4 v1, s[4:7], s30 offen nt lds
s_add_u32 s30, s30, 4096
s_cmp_eq_u32 s57, 1
s_cbranch_scc1 L_softmax
L_lkbv:
s_add_u32 s30, s55, 229376
s_waitcnt vmcnt(58)
s_add_u32 m0, s54, 8192
s_nop 0
buffer_load_dwordx4 v1, s[4:7], s30 offen nt lds
s_add_u32 s30, s30, 4096
s_waitcnt vmcnt(58)
s_add_u32 m0, s54, 9216
s_nop 0
buffer_load_dwordx4 v1, s[4:7], s30 offen nt lds
s_add_u32 s30, s30, 4096
s_waitcnt vmcnt(58)
s_add_u32 m0, s54, 10240
s_nop 0
buffer_load_dwordx4 v1, s[4:7], s30 offen nt lds
s_add_u32 s30, s30, 4096
s_waitcnt vmcnt(58)
s_add_u32 m0, s54, 11264
s_nop 0
buffer_load_dwordx4 v1, s[4:7], s30 offen nt lds
s_add_u32 s30, s30, 4096
s_waitcnt vmcnt(58)
s_add_u32 m0, s54, 12288
s_nop 0
buffer_load_dwordx4 v1, s[4:7], s30 offen nt lds
s_add_u32 s30, s30, 4096
s_waitcnt vmcnt(58)
s_add_u32 m0, s54, 13312
s_nop 0
buffer_load_dwordx4 v1, s[4:7], s30 offen nt lds
s_add_u32 s30, s30, 4096
s_waitcnt vmcnt(58)
s_add_u32 m0, s54, 14336
s_nop 0
buffer_load_dwordx4 v1, s[4:7], s30 offen nt lds
s_add_u32 s30, s30, 4096
s_waitcnt vmcnt(58)
s_add_u32 m0, s54, 15360
s_nop 0
buffer_load_dwordx4 v1, s[4:7], s30 offen nt lds
s_add_u32 s30, s30, 4096
v_mov_b32 v58, 0
global_load_dword v59, v58, s[18:19] sc1
s_mov_b32 s30, s55
s_waitcnt vmcnt(58)
buffer_load_dwordx4 a[0:3], v1, s[8:11], s30 offen nt
s_add_u32 s30, s30, 4096
s_waitcnt vmcnt(58)
buffer_load_dwordx4 a[4:7], v1, s[8:11], s30 offen nt
s_add_u32 s30, s30, 4096
s_waitcnt vmcnt(58)
buffer_load_dwordx4 a[8:11], v1, s[8:11], s30 offen nt
s_add_u32 s30, s30, 4096
s_waitcnt vmcnt(58)
buffer_load_dwordx4 a[12:15], v1, s[8:11], s30 offen nt
s_add_u32 s30, s30, 4096
s_waitcnt vmcnt(58)
buffer_load_dwordx4 a[16:19], v1, s[8:11], s30 offen nt
s_add_u32 s30, s30, 4096
s_waitcnt vmcnt(58)
buffer_load_dwordx4 a[20:23], v1, s[8:11], s30 offen nt
s_add_u32 s30, s30, 4096
s_waitcnt vmcnt(58)
buffer_load_dwordx4 a[24:27], v1, s[8:11], s30 offen nt
s_add_u32 s30, s30, 4096
s_waitcnt vmcnt(58)
buffer_load_dwordx4 a[28:31], v1, s[8:11], s30 offen nt
s_add_u32 s30, s30, 4096
s_waitcnt vmcnt(58)
buffer_load_dwordx4 a[32:35], v1, s[8:11], s30 offen nt
s_add_u32 s30, s30, 4096
s_waitcnt vmcnt(58)
buffer_load_dwordx4 a[36:39], v1, s[8:11], s30 offen nt
s_add_u32 s30, s30, 4096
s_waitcnt vmcnt(58)
buffer_load_dwordx4 a[40:43], v1, s[8:11], s30 offen nt
s_add_u32 s30, s30, 4096
s_waitcnt vmcnt(58)
buffer_load_dwordx4 a[44:47], v1, s[8:11], s30 offen nt
s_add_u32 s30, s30, 4096
s_waitcnt vmcnt(58)
buffer_load_dwordx4 a[48:51], v1, s[8:11], s30 offen nt
s_add_u32 s30, s30, 4096
s_waitcnt vmcnt(58)
buffer_load_dwordx4 a[52:55], v1, s[8:11], s30 offen nt
s_add_u32 s30, s30, 4096
s_waitcnt vmcnt(58)
buffer_load_dwordx4 a[56:59], v1, s[8:11], s30 offen nt
s_add_u32 s30, s30, 4096
s_waitcnt vmcnt(58)
buffer_load_dwordx4 a[60:63], v1, s[8:11], s30 offen nt
s_add_u32 s30, s30, 4096
s_waitcnt vmcnt(58)
buffer_load_dwordx4 a[64:67], v1, s[8:11], s30 offen nt
s_add_u32 s30, s30, 4096
s_waitcnt vmcnt(58)
buffer_load_dwordx4 a[68:71], v1, s[8:11], s30 offen nt
s_add_u32 s30, s30, 4096
s_waitcnt vmcnt(58)
buffer_load_dwordx4 a[72:75], v1, s[8:11], s30 offen nt
s_add_u32 s30, s30, 4096
s_waitcnt vmcnt(58)
buffer_load_dwordx4 a[76:79], v1, s[8:11], s30 offen nt
s_add_u32 s30, s30, 4096
s_waitcnt vmcnt(58)
buffer_load_dwordx4 a[80:83], v1, s[8:11], s30 offen nt
s_add_u32 s30, s30, 4096
s_waitcnt vmcnt(58)
buffer_load_dwordx4 a[84:87], v1, s[8:11], s30 offen nt
s_add_u32 s30, s30, 4096
s_waitcnt vmcnt(58)
buffer_load_dwordx4 a[88:91], v1, s[8:11], s30 offen nt
s_add_u32 s30, s30, 4096
s_waitcnt vmcnt(58)
buffer_load_dwordx4 a[92:95], v1, s[8:11], s30 offen nt
s_add_u32 s30, s30, 4096
s_waitcnt vmcnt(58)
buffer_load_dwordx4 a[96:99], v1, s[8:11], s30 offen nt
s_add_u32 s30, s30, 4096
s_waitcnt vmcnt(58)
buffer_load_dwordx4 a[100:103], v1, s[8:11], s30 offen nt
s_add_u32 s30, s30, 4096
s_waitcnt vmcnt(58)
buffer_load_dwordx4 a[104:107], v1, s[8:11], s30 offen nt
s_add_u32 s30, s30, 4096
s_waitcnt vmcnt(58)
buffer_load_dwordx4 a[108:111], v1, s[8:11], s30 offen nt
s_add_u32 s30, s30, 4096
s_waitcnt vmcnt(58)
buffer_load_dwordx4 a[112:115], v1, s[8:11], s30 offen nt
s_add_u32 s30, s30, 4096
s_waitcnt vmcnt(58)
buffer_load_dwordx4 a[116:119], v1, s[8:11], s30 offen nt
s_add_u32 s30, s30, 4096
s_waitcnt vmcnt(58)
buffer_load_dwordx4 a[120:123], v1, s[8:11], s30 offen nt
s_add_u32 s30, s30, 4096
s_waitcnt vmcnt(58)
buffer_load_dwordx4 a[124:127], v1, s[8:11], s30 offen nt
s_add_u32 s30, s30, 4096
s_waitcnt vmcnt(32)
v_readfirstlane_b32 s32, v59
s_cmp_ge_u32 s32, 256
s_cbranch_scc1 L_cok_10
s_mov_b32 s31, 0
v_mov_b32 v58, 0
L_cnt_11:
global_load_dword v59, v58, s[18:19] sc1
s_waitcnt vmcnt(0)
v_readfirstlane_b32 s32, v59
s_add_u32 s31, s31, 1
s_cmp_ge_u32 s31, 200000
s_cbranch_scc1 L_cdone_12
s_cmp_lt_u32 s32, 256
s_cbranch_scc1 L_cnt_11
L_cdone_12:
L_cok_10:
s_lshl_b32 s27, s57, 1
s_min_u32 s27, s27, 3
s_cmp_eq_u32 s57, 2
s_cbranch_scc1 L_noq_13
s_mov_b32 s32, 851968
s_lshl_b32 s33, s24, 12
s_add_u32 s32, s32, s33
v_lshrrev_b32 v60, 4, v0
v_lshlrev_b32 v60, 10, v60
v_and_b32 v61, 15, v0
v_lshl_add_u32 v60, v61, 5, v60
v_add_u32 v60, s32, v60
v_add_u32 v61, 131072, v60
global_load_dwordx4 v[16:19], v60, s[16:17] offset:0 sc1
global_load_dwordx4 v[20:23], v60, s[16:17] offset:16 sc1
global_load_dwordx4 v[24:27], v60, s[16:17] offset:512 sc1
global_load_dwordx4 v[28:31], v60, s[16:17] offset:528 sc1
global_load_dwordx4 v[32:35], v61, s[16:17] offset:0 sc1
global_load_dwordx4 v[36:39], v61, s[16:17] offset:16 sc1
global_load_dwordx4 v[40:43], v61, s[16:17] offset:512 sc1
global_load_dwordx4 v[44:47], v61, s[16:17] offset:528 sc1
L_noq_13:
s_cmp_eq_u32 s57, 2
s_cbranch_scc0 L_keepv_14
s_waitcnt vmcnt(58)
buffer_load_dwordx4 a[128:131], v1, s[8:11], s30 offen nt
s_add_u32 s30, s30, 4096
s_waitcnt vmcnt(58)
buffer_load_dwordx4 a[132:135], v1, s[8:11], s30 offen nt
s_add_u32 s30, s30, 4096
s_waitcnt vmcnt(58)
buffer_load_dwordx4 a[136:139], v1, s[8:11], s30 offen nt
s_add_u32 s30, s30, 4096
s_waitcnt vmcnt(58)
buffer_load_dwordx4 a[140:143], v1, s[8:11], s30 offen nt
s_add_u32 s30, s30, 4096
s_waitcnt vmcnt(58)
buffer_load_dwordx4 a[144:147], v1, s[8:11], s30 offen nt
s_add_u32 s30, s30, 4096
s_waitcnt vmcnt(58)
buffer_load_dwordx4 a[148:151], v1, s[8:11], s30 offen nt
s_add_u32 s30, s30, 4096
s_waitcnt vmcnt(58)
buffer_load_dwordx4 a[152:155], v1, s[8:11], s30 offen nt
s_add_u32 s30, s30, 4096
s_waitcnt vmcnt(58)
buffer_load_dwordx4 a[156:159], v1, s[8:11], s30 offen nt
s_add_u32 s30, s30, 4096
s_waitcnt vmcnt(58)
buffer_load_dwordx4 a[160:163], v1, s[8:11], s30 offen nt
s_add_u32 s30, s30, 4096
s_waitcnt vmcnt(58)
buffer_load_dwordx4 a[164:167], v1, s[8:11], s30 offen nt
s_add_u32 s30, s30, 4096
s_waitcnt vmcnt(58)
buffer_load_dwordx4 a[168:171], v1, s[8:11], s30 offen nt
s_add_u32 s30, s30, 4096
s_waitcnt vmcnt(58)
buffer_load_dwordx4 a[172:175], v1, s[8:11], s30 offen nt
s_add_u32 s30, s30, 4096
s_branch L_disp
L_keepv_14:
s_waitcnt vmcnt(50)
buffer_load_dwordx4 a[128:131], v1, s[8:11], s30 offen nt
s_add_u32 s30, s30, 4096
s_waitcnt vmcnt(50)
buffer_load_dwordx4 a[132:135], v1, s[8:11], s30 offen nt
s_add_u32 s30, s30, 4096
s_waitcnt vmcnt(50)
buffer_load_dwordx4 a[136:139], v1, s[8:11], s30 offen nt
s_add_u32 s30, s30, 4096
s_waitcnt vmcnt(50)
buffer_load_dwordx4 a[140:143], v1, s[8:11], s30 offen nt
s_add_u32 s30, s30, 4096
s_waitcnt vmcnt(50)
buffer_load_dwordx4 a[144:147], v1, s[8:11], s30 offen nt
s_add_u32 s30, s30, 4096
s_waitcnt vmcnt(50)
buffer_load_dwordx4 a[148:151], v1, s[8:11], s30 offen nt
s_add_u32 s30, s30, 4096
s_waitcnt vmcnt(50)
buffer_load_dwordx4 a[152:155], v1, s[8:11], s30 offen nt
s_add_u32 s30, s30, 4096
s_waitcnt vmcnt(50)
buffer_load_dwordx4 a[156:159], v1, s[8:11], s30 offen nt
s_add_u32 s30, s30, 4096
s_waitcnt vmcnt(50)
buffer_load_dwordx4 a[160:163], v1, s[8:11], s30 offen nt
s_add_u32 s30, s30, 4096
s_waitcnt vmcnt(50)
buffer_load_dwordx4 a[164:167], v1, s[8:11], s30 offen nt
s_add_u32 s30, s30, 4096
s_waitcnt vmcnt(50)
buffer_load_dwordx4 a[168:171], v1, s[8:11], s30 offen nt
s_add_u32 s30, s30, 4096
s_waitcnt vmcnt(50)
buffer_load_dwordx4 a[172:175], v1, s[8:11], s30 offen nt
s_add_u32 s30, s30, 4096
s_waitcnt vmcnt(58)
buffer_load_dwordx4 a[176:179], v1, s[8:11], s30 offen nt
s_add_u32 s30, s30, 4096
s_waitcnt vmcnt(58)
buffer_load_dwordx4 a[180:183], v1, s[8:11], s30 offen nt
s_add_u32 s30, s30, 4096
s_waitcnt vmcnt(58)
buffer_load_dwordx4 a[184:187], v1, s[8:11], s30 offen nt
s_add_u32 s30, s30, 4096
s_waitcnt vmcnt(58)
buffer_load_dwordx4 a[188:191], v1, s[8:11], s30 offen nt
s_add_u32 s30, s30, 4096
s_waitcnt vmcnt(58)
buffer_load_dwordx4 a[192:195], v1, s[8:11], s30 offen nt
s_add_u32 s30, s30, 4096
s_waitcnt vmcnt(58)
buffer_load_dwordx4 a[196:199], v1, s[8:11], s30 offen nt
s_add_u32 s30, s30, 4096
s_waitcnt vmcnt(58)
buffer_load_dwordx4 a[200:203], v1, s[8:11], s30 offen nt
s_add_u32 s30, s30, 4096
s_waitcnt vmcnt(58)
buffer_load_dwordx4 a[204:207], v1, s[8:11], s30 offen nt
s_add_u32 s30, s30, 4096
s_waitcnt vmcnt(58)
buffer_load_dwordx4 a[208:211], v1, s[8:11], s30 offen nt
s_add_u32 s30, s30, 4096
s_waitcnt vmcnt(58)
buffer_load_dwordx4 a[212:215], v1, s[8:11], s30 offen nt
s_add_u32 s30, s30, 4096
s_waitcnt vmcnt(58)
buffer_load_dwordx4 a[216:219], v1, s[8:11], s30 offen nt
s_add_u32 s30, s30, 4096
s_waitcnt vmcnt(58)
buffer_load_dwordx4 a[220:223], v1, s[8:11], s30 offen nt
s_add_u32 s30, s30, 4096
s_waitcnt vmcnt(58)
buffer_load_dwordx4 a[224:227], v1, s[8:11], s30 offen nt
s_add_u32 s30, s30, 4096
s_waitcnt vmcnt(58)
buffer_load_dwordx4 a[228:231], v1, s[8:11], s30 offen nt
s_add_u32 s30, s30, 4096
s_waitcnt vmcnt(58)
buffer_load_dwordx4 a[232:235], v1, s[8:11], s30 offen nt
s_add_u32 s30, s30, 4096
s_waitcnt vmcnt(58)
buffer_load_dwordx4 a[236:239], v1, s[8:11], s30 offen nt
s_add_u32 s30, s30, 4096
s_waitcnt vmcnt(58)
buffer_load_dwordx4 a[240:243], v1, s[8:11], s30 offen nt
s_add_u32 s30, s30, 4096
s_waitcnt vmcnt(58)
buffer_load_dwordx4 a[244:247], v1, s[8:11], s30 offen nt
s_add_u32 s30, s30, 4096
s_waitcnt vmcnt(58)
buffer_load_dwordx4 a[248:251], v1, s[8:11], s30 offen nt
s_add_u32 s30, s30, 4096
s_waitcnt vmcnt(58)
buffer_load_dwordx4 a[252:255], v1, s[8:11], s30 offen nt
s_add_u32 s30, s30, 4096
s_cmp_eq_u32 s57, 2
s_cbranch_scc1 L_disp
s_waitcnt vmcnt(32)
v_max_u32 v58, v16, v17
v_max3_u32 v58, v58, v18, v19
v_max3_u32 v58, v58, v20, v21
v_max3_u32 v58, v58, v22, v23
v_max3_u32 v58, v58, v24, v25
v_max3_u32 v58, v58, v26, v27
v_max3_u32 v58, v58, v28, v29
v_max3_u32 v58, v58, v30, v31
v_max3_u32 v58, v58, v32, v33
v_max3_u32 v58, v58, v34, v35
v_max3_u32 v58, v58, v36, v37
v_max3_u32 v58, v58, v38, v39
v_max3_u32 v58, v58, v40, v41
v_max3_u32 v58, v58, v42, v43
v_max3_u32 v58, v58, v44, v45
v_max3_u32 v58, v58, v46, v47
v_cmp_eq_u32 vcc, -1, v58
s_nop 1
s_cmp_lg_u64 vcc, 0
s_cbranch_scc1 L_qbad_15
s_branch L_qgood_16
L_qbad_15:
s_mov_b32 s31, 0
L_poll_17:
global_load_dwordx4 v[16:19], v60, s[16:17] offset:0 sc1
global_load_dwordx4 v[20:23], v60, s[16:17] offset:16 sc1
global_load_dwordx4 v[24:27], v60, s[16:17] offset:512 sc1
global_load_dwordx4 v[28:31], v60, s[16:17] offset:528 sc1
global_load_dwordx4 v[32:35], v61, s[16:17] offset:0 sc1
global_load_dwordx4 v[36:39], v61, s[16:17] offset:16 sc1
global_load_dwordx4 v[40:43], v61, s[16:17] offset:512 sc1
global_load_dwordx4 v[44:47], v61, s[16:17] offset:528 sc1
s_waitcnt vmcnt(0)
v_max_u32 v58, v16, v17
v_max3_u32 v58, v58, v18, v19
v_max3_u32 v58, v58, v20, v21
v_max3_u32 v58, v58, v22, v23
v_max3_u32 v58, v58, v24, v25
v_max3_u32 v58, v58, v26, v27
v_max3_u32 v58, v58, v28, v29
v_max3_u32 v58, v58, v30, v31
v_max3_u32 v58, v58, v32, v33
v_max3_u32 v58, v58, v34, v35
v_max3_u32 v58, v58, v36, v37
v_max3_u32 v58, v58, v38, v39
v_max3_u32 v58, v58, v40, v41
v_max3_u32 v58, v58, v42, v43
v_max3_u32 v58, v58, v44, v45
v_max3_u32 v58, v58, v46, v47
v_cmp_eq_u32 vcc, -1, v58
s_nop 1
s_cmp_lg_u64 vcc, 0
s_cbranch_scc1 L_again_18
s_branch L_pdone_19
L_again_18:
s_add_u32 s31, s31, 1
s_cmp_lt_u32 s31, 200000
s_cbranch_scc1 L_poll_17
L_pdone_19:
L_qgood_16:
v_add_f32 v16, v16, v24
v_add_f32 v17, v17, v25
v_add_f32 v18, v18, v26
v_add_f32 v19, v19, v27
v_add_f32 v20, v20, v28
v_add_f32 v21, v21, v29
v_add_f32 v22, v22, v30
v_add_f32 v23, v23, v31
v_add_f32 v32, v32, v40
v_add_f32 v33, v33, v41
v_add_f32 v34, v34, v42
v_add_f32 v35, v35, v43
v_add_f32 v36, v36, v44
v_add_f32 v37, v37, v45
v_add_f32 v38, v38, v46
v_add_f32 v39, v39, v47
v_mov_b32 v24, v16
v_mov_b32 v25, v17
v_mov_b32 v26, v18
v_mov_b32 v27, v19
v_mov_b32 v28, v20
v_mov_b32 v29, v21
v_mov_b32 v30, v22
v_mov_b32 v31, v23
v_mov_b32 v40, v32
v_mov_b32 v41, v33
v_mov_b32 v42, v34
v_mov_b32 v43, v35
v_mov_b32 v44, v36
v_mov_b32 v45, v37
v_mov_b32 v46, v38
v_mov_b32 v47, v39
s_nop 1
v_permlane16_swap_b32 v16, v24
v_permlane16_swap_b32 v17, v25
v_permlane16_swap_b32 v18, v26
v_permlane16_swap_b32 v19, v27
v_permlane16_swap_b32 v20, v28
v_permlane16_swap_b32 v21, v29
v_permlane16_swap_b32 v22, v30
v_permlane16_swap_b32 v23, v31
v_permlane16_swap_b32 v32, v40
v_permlane16_swap_b32 v33, v41
v_permlane16_swap_b32 v34, v42
v_permlane16_swap_b32 v35, v43
v_permlane16_swap_b32 v36, v44
v_permlane16_swap_b32 v37, v45
v_permlane16_swap_b32 v38, v46
v_permlane16_swap_b32 v39, v47
v_add_f32 v16, v16, v24
v_add_f32 v17, v17, v25
v_add_f32 v18, v18, v26
v_add_f32 v19, v19, v27
v_add_f32 v20, v20, v28
v_add_f32 v21, v21, v29
v_add_f32 v22, v22, v30
v_add_f32 v23, v23, v31
v_add_f32 v32, v32, v40
v_add_f32 v33, v33, v41
v_add_f32 v34, v34, v42
v_add_f32 v35, v35, v43
v_add_f32 v36, v36, v44
v_add_f32 v37, v37, v45
v_add_f32 v38, v38, v46
v_add_f32 v39, v39, v47
v_mov_b32 v24, v16
v_mov_b32 v25, v17
v_mov_b32 v26, v18
v_mov_b32 v27, v19
v_mov_b32 v28, v20
v_mov_b32 v29, v21
v_mov_b32 v30, v22
v_mov_b32 v31, v23
v_mov_b32 v40, v32
v_mov_b32 v41, v33
v_mov_b32 v42, v34
v_mov_b32 v43, v35
v_mov_b32 v44, v36
v_mov_b32 v45, v37
v_mov_b32 v46, v38
v_mov_b32 v47, v39
s_nop 1
v_permlane32_swap_b32 v16, v24
v_permlane32_swap_b32 v17, v25
v_permlane32_swap_b32 v18, v26
v_permlane32_swap_b32 v19, v27
v_permlane32_swap_b32 v20, v28
v_permlane32_swap_b32 v21, v29
v_permlane32_swap_b32 v22, v30
v_permlane32_swap_b32 v23, v31
v_permlane32_swap_b32 v32, v40
v_permlane32_swap_b32 v33, v41
v_permlane32_swap_b32 v34, v42
v_permlane32_swap_b32 v35, v43
v_permlane32_swap_b32 v36, v44
v_permlane32_swap_b32 v37, v45
v_permlane32_swap_b32 v38, v46
v_permlane32_swap_b32 v39, v47
v_add_f32 v16, v16, v24
v_add_f32 v17, v17, v25
v_add_f32 v18, v18, v26
v_add_f32 v19, v19, v27
v_add_f32 v20, v20, v28
v_add_f32 v21, v21, v29
v_add_f32 v22, v22, v30
v_add_f32 v23, v23, v31
v_add_f32 v32, v32, v40
v_add_f32 v33, v33, v41
v_add_f32 v34, v34, v42
v_add_f32 v35, v35, v43
v_add_f32 v36, v36, v44
v_add_f32 v37, v37, v45
v_add_f32 v38, v38, v46
v_add_f32 v39, v39, v47
v_cvt_pk_bf16_f32 v4, v16, v17
v_cvt_pk_bf16_f32 v5, v18, v19
v_cvt_pk_bf16_f32 v6, v20, v21
v_cvt_pk_bf16_f32 v7, v22, v23
v_cvt_pk_bf16_f32 v48, v32, v33
v_cvt_pk_bf16_f32 v49, v34, v35
v_cvt_pk_bf16_f32 v50, v36, v37
v_cvt_pk_bf16_f32 v51, v38, v39
s_lshl_b32 s32, s3, 8
s_add_u32 s32, s32, 156672
v_and_b32 v58, 15, v0
v_lshlrev_b32 v58, 4, v58
v_add_u32 v58, s32, v58
s_mov_b64 exec, 0xffff
ds_write_b128 v58, v[48:51]
s_mov_b64 exec, -1
s_cmp_eq_u32 s28, 1
s_cselect_b32 s51, 1, 0
s_branch L_qk
L_mid2:
s_mov_b32 s27, 2
s_mov_b32 s51, s58
s_lshl_b32 s32, s3, 8
s_add_u32 s32, s32, 156672
v_and_b32 v58, 15, v0
v_lshlrev_b32 v58, 4, v58
v_add_u32 v58, s32, v58
ds_read_b128 v[4:7], v58
s_waitcnt vmcnt(58) lgkmcnt(0)
s_branch L_qk
L_pvc:
s_mov_b32 s56, s55
v_mov_b32 v32, 0
v_mov_b32 v33, 0
v_mov_b32 v34, 0
v_mov_b32 v35, 0
v_mov_b32 v36, 0
v_mov_b32 v37, 0
v_mov_b32 v38, 0
v_mov_b32 v39, 0
v_and_b32_dpp v40, v16, v2 row_newbcast:0 row_mask:0xf bank_mask:0xf
v_and_b32_dpp v41, v16, v3 row_newbcast:0 row_mask:0xf bank_mask:0xf
v_and_b32_dpp v42, v16, v2 row_newbcast:4 row_mask:0xf bank_mask:0xf
v_and_b32_dpp v43, v16, v3 row_newbcast:4 row_mask:0xf bank_mask:0xf
v_mfma_f32_4x4x4_16b_bf16 v[32:35], v[40:41], a[0:1], v[32:35]
v_mfma_f32_4x4x4_16b_bf16 v[36:39], v[40:41], a[2:3], v[36:39]
v_and_b32_dpp v44, v16, v2 row_newbcast:8 row_mask:0xf bank_mask:0xf
v_and_b32_dpp v45, v16, v3 row_newbcast:8 row_mask:0xf bank_mask:0xf
v_mfma_f32_4x4x4_16b_bf16 v[32:35], v[42:43], a[4:5], v[32:35]
v_mfma_f32_4x4x4_16b_bf16 v[36:39], v[42:43], a[6:7], v[36:39]
v_and_b32_dpp v40, v16, v2 row_newbcast:12 row_mask:0xf bank_mask:0xf
v_and_b32_dpp v41, v16, v3 row_newbcast:12 row_mask:0xf bank_mask:0xf
v_mfma_f32_4x4x4_16b_bf16 v[32:35], v[44:45], a[8:9], v[32:35]
v_mfma_f32_4x4x4_16b_bf16 v[36:39], v[44:45], a[10:11], v[36:39]
s_waitcnt vmcnt(58)
buffer_load_dwordx4 a[0:3], v1, s[8:11], s56 offen nt
s_add_u32 s56, s56, 4096
v_and_b32_dpp v42, v17, v2 row_newbcast:0 row_mask:0xf bank_mask:0xf
v_and_b32_dpp v43, v17, v3 row_newbcast:0 row_mask:0xf bank_mask:0xf
v_mfma_f32_4x4x4_16b_bf16 v[32:35], v[40:41], a[12:13], v[32:35]
v_mfma_f32_4x4x4_16b_bf16 v[36:39], v[40:41], a[14:15], v[36:39]
s_waitcnt vmcnt(58)
buffer_load_dwordx4 a[4:7], v1, s[8:11], s56 offen nt
s_add_u32 s56, s56, 4096
v_and_b32_dpp v44, v17, v2 row_newbcast:4 row_mask:0xf bank_mask:0xf
v_and_b32_dpp v45, v17, v3 row_newbcast:4 row_mask:0xf bank_mask:0xf
v_mfma_f32_4x4x4_16b_bf16 v[32:35], v[42:43], a[16:17], v[32:35]
v_mfma_f32_4x4x4_16b_bf16 v[36:39], v[42:43], a[18:19], v[36:39]
s_waitcnt vmcnt(58)
buffer_load_dwordx4 a[8:11], v1, s[8:11], s56 offen nt
s_add_u32 s56, s56, 4096
v_and_b32_dpp v40, v17, v2 row_newbcast:8 row_mask:0xf bank_mask:0xf
v_and_b32_dpp v41, v17, v3 row_newbcast:8 row_mask:0xf bank_mask:0xf
v_mfma_f32_4x4x4_16b_bf16 v[32:35], v[44:45], a[20:21], v[32:35]
v_mfma_f32_4x4x4_16b_bf16 v[36:39], v[44:45], a[22:23], v[36:39]
s_waitcnt vmcnt(58)
buffer_load_dwordx4 a[12:15], v1, s[8:11], s56 offen nt
s_add_u32 s56, s56, 4096
v_and_b32_dpp v42, v17, v2 row_newbcast:12 row_mask:0xf bank_mask:0xf
v_and_b32_dpp v43, v17, v3 row_newbcast:12 row_mask:0xf bank_mask:0xf
v_mfma_f32_4x4x4_16b_bf16 v[32:35], v[40:41], a[24:25], v[32:35]
v_mfma_f32_4x4x4_16b_bf16 v[36:39], v[40:41], a[26:27], v[36:39]
s_waitcnt vmcnt(58)
buffer_load_dwordx4 a[16:19], v1, s[8:11], s56 offen nt
s_add_u32 s56, s56, 4096
v_and_b32_dpp v44, v18, v2 row_newbcast:0 row_mask:0xf bank_mask:0xf
v_and_b32_dpp v45, v18, v3 row_newbcast:0 row_mask:0xf bank_mask:0xf
v_mfma_f32_4x4x4_16b_bf16 v[32:35], v[42:43], a[28:29], v[32:35]
v_mfma_f32_4x4x4_16b_bf16 v[36:39], v[42:43], a[30:31], v[36:39]
s_waitcnt vmcnt(58)
buffer_load_dwordx4 a[20:23], v1, s[8:11], s56 offen nt
s_add_u32 s56, s56, 4096
v_and_b32_dpp v40, v18, v2 row_newbcast:4 row_mask:0xf bank_mask:0xf
v_and_b32_dpp v41, v18, v3 row_newbcast:4 row_mask:0xf bank_mask:0xf
v_mfma_f32_4x4x4_16b_bf16 v[32:35], v[44:45], a[32:33], v[32:35]
v_mfma_f32_4x4x4_16b_bf16 v[36:39], v[44:45], a[34:35], v[36:39]
s_waitcnt vmcnt(58)
buffer_load_dwordx4 a[24:27], v1, s[8:11], s56 offen nt
s_add_u32 s56, s56, 4096
v_and_b32_dpp v42, v18, v2 row_newbcast:8 row_mask:0xf bank_mask:0xf
v_and_b32_dpp v43, v18, v3 row_newbcast:8 row_mask:0xf bank_mask:0xf
v_mfma_f32_4x4x4_16b_bf16 v[32:35], v[40:41], a[36:37], v[32:35]
v_mfma_f32_4x4x4_16b_bf16 v[36:39], v[40:41], a[38:39], v[36:39]
s_waitcnt vmcnt(58)
buffer_load_dwordx4 a[28:31], v1, s[8:11], s56 offen nt
s_add_u32 s56, s56, 4096
v_and_b32_dpp v44, v18, v2 row_newbcast:12 row_mask:0xf bank_mask:0xf
v_and_b32_dpp v45, v18, v3 row_newbcast:12 row_mask:0xf bank_mask:0xf
v_mfma_f32_4x4x4_16b_bf16 v[32:35], v[42:43], a[40:41], v[32:35]
v_mfma_f32_4x4x4_16b_bf16 v[36:39], v[42:43], a[42:43], v[36:39]
s_waitcnt vmcnt(58)
buffer_load_dwordx4 a[32:35], v1, s[8:11], s56 offen nt
s_add_u32 s56, s56, 4096
v_and_b32_dpp v40, v19, v2 row_newbcast:0 row_mask:0xf bank_mask:0xf
v_and_b32_dpp v41, v19, v3 row_newbcast:0 row_mask:0xf bank_mask:0xf
v_mfma_f32_4x4x4_16b_bf16 v[32:35], v[44:45], a[44:45], v[32:35]
v_mfma_f32_4x4x4_16b_bf16 v[36:39], v[44:45], a[46:47], v[36:39]
s_waitcnt vmcnt(58)
buffer_load_dwordx4 a[36:39], v1, s[8:11], s56 offen nt
s_add_u32 s56, s56, 4096
v_and_b32_dpp v42, v19, v2 row_newbcast:4 row_mask:0xf bank_mask:0xf
v_and_b32_dpp v43, v19, v3 row_newbcast:4 row_mask:0xf bank_mask:0xf
v_mfma_f32_4x4x4_16b_bf16 v[32:35], v[40:41], a[48:49], v[32:35]
v_mfma_f32_4x4x4_16b_bf16 v[36:39], v[40:41], a[50:51], v[36:39]
s_waitcnt vmcnt(58)
buffer_load_dwordx4 a[40:43], v1, s[8:11], s56 offen nt
s_add_u32 s56, s56, 4096
v_and_b32_dpp v44, v19, v2 row_newbcast:8 row_mask:0xf bank_mask:0xf
v_and_b32_dpp v45, v19, v3 row_newbcast:8 row_mask:0xf bank_mask:0xf
v_mfma_f32_4x4x4_16b_bf16 v[32:35], v[42:43], a[52:53], v[32:35]
v_mfma_f32_4x4x4_16b_bf16 v[36:39], v[42:43], a[54:55], v[36:39]
s_waitcnt vmcnt(58)
buffer_load_dwordx4 a[44:47], v1, s[8:11], s56 offen nt
s_add_u32 s56, s56, 4096
v_and_b32_dpp v40, v19, v2 row_newbcast:12 row_mask:0xf bank_mask:0xf
v_and_b32_dpp v41, v19, v3 row_newbcast:12 row_mask:0xf bank_mask:0xf
v_mfma_f32_4x4x4_16b_bf16 v[32:35], v[44:45], a[56:57], v[32:35]
v_mfma_f32_4x4x4_16b_bf16 v[36:39], v[44:45], a[58:59], v[36:39]
s_waitcnt vmcnt(58)
buffer_load_dwordx4 a[48:51], v1, s[8:11], s56 offen nt
s_add_u32 s56, s56, 4096
v_and_b32_dpp v42, v20, v2 row_newbcast:0 row_mask:0xf bank_mask:0xf
v_and_b32_dpp v43, v20, v3 row_newbcast:0 row_mask:0xf bank_mask:0xf
v_mfma_f32_4x4x4_16b_bf16 v[32:35], v[40:41], a[60:61], v[32:35]
v_mfma_f32_4x4x4_16b_bf16 v[36:39], v[40:41], a[62:63], v[36:39]
s_waitcnt vmcnt(58)
buffer_load_dwordx4 a[52:55], v1, s[8:11], s56 offen nt
s_add_u32 s56, s56, 4096
v_and_b32_dpp v44, v20, v2 row_newbcast:4 row_mask:0xf bank_mask:0xf
v_and_b32_dpp v45, v20, v3 row_newbcast:4 row_mask:0xf bank_mask:0xf
v_mfma_f32_4x4x4_16b_bf16 v[32:35], v[42:43], a[64:65], v[32:35]
v_mfma_f32_4x4x4_16b_bf16 v[36:39], v[42:43], a[66:67], v[36:39]
s_waitcnt vmcnt(58)
buffer_load_dwordx4 a[56:59], v1, s[8:11], s56 offen nt
s_add_u32 s56, s56, 4096
v_and_b32_dpp v40, v20, v2 row_newbcast:8 row_mask:0xf bank_mask:0xf
v_and_b32_dpp v41, v20, v3 row_newbcast:8 row_mask:0xf bank_mask:0xf
v_mfma_f32_4x4x4_16b_bf16 v[32:35], v[44:45], a[68:69], v[32:35]
v_mfma_f32_4x4x4_16b_bf16 v[36:39], v[44:45], a[70:71], v[36:39]
s_waitcnt vmcnt(58)
buffer_load_dwordx4 a[60:63], v1, s[8:11], s56 offen nt
s_add_u32 s56, s56, 4096
v_and_b32_dpp v42, v20, v2 row_newbcast:12 row_mask:0xf bank_mask:0xf
v_and_b32_dpp v43, v20, v3 row_newbcast:12 row_mask:0xf bank_mask:0xf
v_mfma_f32_4x4x4_16b_bf16 v[32:35], v[40:41], a[72:73], v[32:35]
v_mfma_f32_4x4x4_16b_bf16 v[36:39], v[40:41], a[74:75], v[36:39]
s_waitcnt vmcnt(58)
buffer_load_dwordx4 a[64:67], v1, s[8:11], s56 offen nt
s_add_u32 s56, s56, 4096
v_and_b32_dpp v44, v21, v2 row_newbcast:0 row_mask:0xf bank_mask:0xf
v_and_b32_dpp v45, v21, v3 row_newbcast:0 row_mask:0xf bank_mask:0xf
v_mfma_f32_4x4x4_16b_bf16 v[32:35], v[42:43], a[76:77], v[32:35]
v_mfma_f32_4x4x4_16b_bf16 v[36:39], v[42:43], a[78:79], v[36:39]
s_waitcnt vmcnt(58)
buffer_load_dwordx4 a[68:71], v1, s[8:11], s56 offen nt
s_add_u32 s56, s56, 4096
v_and_b32_dpp v40, v21, v2 row_newbcast:4 row_mask:0xf bank_mask:0xf
v_and_b32_dpp v41, v21, v3 row_newbcast:4 row_mask:0xf bank_mask:0xf
v_mfma_f32_4x4x4_16b_bf16 v[32:35], v[44:45], a[80:81], v[32:35]
v_mfma_f32_4x4x4_16b_bf16 v[36:39], v[44:45], a[82:83], v[36:39]
s_waitcnt vmcnt(58)
buffer_load_dwordx4 a[72:75], v1, s[8:11], s56 offen nt
s_add_u32 s56, s56, 4096
v_and_b32_dpp v42, v21, v2 row_newbcast:8 row_mask:0xf bank_mask:0xf
v_and_b32_dpp v43, v21, v3 row_newbcast:8 row_mask:0xf bank_mask:0xf
v_mfma_f32_4x4x4_16b_bf16 v[32:35], v[40:41], a[84:85], v[32:35]
v_mfma_f32_4x4x4_16b_bf16 v[36:39], v[40:41], a[86:87], v[36:39]
s_waitcnt vmcnt(58)
buffer_load_dwordx4 a[76:79], v1, s[8:11], s56 offen nt
s_add_u32 s56, s56, 4096
v_and_b32_dpp v44, v21, v2 row_newbcast:12 row_mask:0xf bank_mask:0xf
v_and_b32_dpp v45, v21, v3 row_newbcast:12 row_mask:0xf bank_mask:0xf
v_mfma_f32_4x4x4_16b_bf16 v[32:35], v[42:43], a[88:89], v[32:35]
v_mfma_f32_4x4x4_16b_bf16 v[36:39], v[42:43], a[90:91], v[36:39]
s_waitcnt vmcnt(58)
buffer_load_dwordx4 a[80:83], v1, s[8:11], s56 offen nt
s_add_u32 s56, s56, 4096
v_and_b32_dpp v40, v22, v2 row_newbcast:0 row_mask:0xf bank_mask:0xf
v_and_b32_dpp v41, v22, v3 row_newbcast:0 row_mask:0xf bank_mask:0xf
v_mfma_f32_4x4x4_16b_bf16 v[32:35], v[44:45], a[92:93], v[32:35]
v_mfma_f32_4x4x4_16b_bf16 v[36:39], v[44:45], a[94:95], v[36:39]
s_waitcnt vmcnt(58)
buffer_load_dwordx4 a[84:87], v1, s[8:11], s56 offen nt
s_add_u32 s56, s56, 4096
v_and_b32_dpp v42, v22, v2 row_newbcast:4 row_mask:0xf bank_mask:0xf
v_and_b32_dpp v43, v22, v3 row_newbcast:4 row_mask:0xf bank_mask:0xf
v_mfma_f32_4x4x4_16b_bf16 v[32:35], v[40:41], a[96:97], v[32:35]
v_mfma_f32_4x4x4_16b_bf16 v[36:39], v[40:41], a[98:99], v[36:39]
s_waitcnt vmcnt(58)
buffer_load_dwordx4 a[88:91], v1, s[8:11], s56 offen nt
s_add_u32 s56, s56, 4096
v_and_b32_dpp v44, v22, v2 row_newbcast:8 row_mask:0xf bank_mask:0xf
v_and_b32_dpp v45, v22, v3 row_newbcast:8 row_mask:0xf bank_mask:0xf
v_mfma_f32_4x4x4_16b_bf16 v[32:35], v[42:43], a[100:101], v[32:35]
v_mfma_f32_4x4x4_16b_bf16 v[36:39], v[42:43], a[102:103], v[36:39]
s_waitcnt vmcnt(58)
buffer_load_dwordx4 a[92:95], v1, s[8:11], s56 offen nt
s_add_u32 s56, s56, 4096
v_and_b32_dpp v40, v22, v2 row_newbcast:12 row_mask:0xf bank_mask:0xf
v_and_b32_dpp v41, v22, v3 row_newbcast:12 row_mask:0xf bank_mask:0xf
v_mfma_f32_4x4x4_16b_bf16 v[32:35], v[44:45], a[104:105], v[32:35]
v_mfma_f32_4x4x4_16b_bf16 v[36:39], v[44:45], a[106:107], v[36:39]
s_waitcnt vmcnt(58)
buffer_load_dwordx4 a[96:99], v1, s[8:11], s56 offen nt
s_add_u32 s56, s56, 4096
v_and_b32_dpp v42, v23, v2 row_newbcast:0 row_mask:0xf bank_mask:0xf
v_and_b32_dpp v43, v23, v3 row_newbcast:0 row_mask:0xf bank_mask:0xf
v_mfma_f32_4x4x4_16b_bf16 v[32:35], v[40:41], a[108:109], v[32:35]
v_mfma_f32_4x4x4_16b_bf16 v[36:39], v[40:41], a[110:111], v[36:39]
s_waitcnt vmcnt(58)
buffer_load_dwordx4 a[100:103], v1, s[8:11], s56 offen nt
s_add_u32 s56, s56, 4096
v_and_b32_dpp v44, v23, v2 row_newbcast:4 row_mask:0xf bank_mask:0xf
v_and_b32_dpp v45, v23, v3 row_newbcast:4 row_mask:0xf bank_mask:0xf
v_mfma_f32_4x4x4_16b_bf16 v[32:35], v[42:43], a[112:113], v[32:35]
v_mfma_f32_4x4x4_16b_bf16 v[36:39], v[42:43], a[114:115], v[36:39]
s_waitcnt vmcnt(58)
buffer_load_dwordx4 a[104:107], v1, s[8:11], s56 offen nt
s_add_u32 s56, s56, 4096
v_and_b32_dpp v40, v23, v2 row_newbcast:8 row_mask:0xf bank_mask:0xf
v_and_b32_dpp v41, v23, v3 row_newbcast:8 row_mask:0xf bank_mask:0xf
v_mfma_f32_4x4x4_16b_bf16 v[32:35], v[44:45], a[116:117], v[32:35]
v_mfma_f32_4x4x4_16b_bf16 v[36:39], v[44:45], a[118:119], v[36:39]
s_waitcnt vmcnt(58)
buffer_load_dwordx4 a[108:111], v1, s[8:11], s56 offen nt
s_add_u32 s56, s56, 4096
v_and_b32_dpp v42, v23, v2 row_newbcast:12 row_mask:0xf bank_mask:0xf
v_and_b32_dpp v43, v23, v3 row_newbcast:12 row_mask:0xf bank_mask:0xf
v_mfma_f32_4x4x4_16b_bf16 v[32:35], v[40:41], a[120:121], v[32:35]
v_mfma_f32_4x4x4_16b_bf16 v[36:39], v[40:41], a[122:123], v[36:39]
s_waitcnt vmcnt(58)
buffer_load_dwordx4 a[112:115], v1, s[8:11], s56 offen nt
s_add_u32 s56, s56, 4096
v_and_b32_dpp v44, v24, v2 row_newbcast:0 row_mask:0xf bank_mask:0xf
v_and_b32_dpp v45, v24, v3 row_newbcast:0 row_mask:0xf bank_mask:0xf
v_mfma_f32_4x4x4_16b_bf16 v[32:35], v[42:43], a[124:125], v[32:35]
v_mfma_f32_4x4x4_16b_bf16 v[36:39], v[42:43], a[126:127], v[36:39]
s_waitcnt vmcnt(58)
buffer_load_dwordx4 a[116:119], v1, s[8:11], s56 offen nt
s_add_u32 s56, s56, 4096
v_and_b32_dpp v40, v24, v2 row_newbcast:4 row_mask:0xf bank_mask:0xf
v_and_b32_dpp v41, v24, v3 row_newbcast:4 row_mask:0xf bank_mask:0xf
v_mfma_f32_4x4x4_16b_bf16 v[32:35], v[44:45], a[128:129], v[32:35]
v_mfma_f32_4x4x4_16b_bf16 v[36:39], v[44:45], a[130:131], v[36:39]
s_waitcnt vmcnt(58)
buffer_load_dwordx4 a[120:123], v1, s[8:11], s56 offen nt
s_add_u32 s56, s56, 4096
v_and_b32_dpp v42, v24, v2 row_newbcast:8 row_mask:0xf bank_mask:0xf
v_and_b32_dpp v43, v24, v3 row_newbcast:8 row_mask:0xf bank_mask:0xf
v_mfma_f32_4x4x4_16b_bf16 v[32:35], v[40:41], a[132:133], v[32:35]
v_mfma_f32_4x4x4_16b_bf16 v[36:39], v[40:41], a[134:135], v[36:39]
s_waitcnt vmcnt(58)
buffer_load_dwordx4 a[124:127], v1, s[8:11], s56 offen nt
s_add_u32 s56, s56, 4096
v_and_b32_dpp v44, v24, v2 row_newbcast:12 row_mask:0xf bank_mask:0xf
v_and_b32_dpp v45, v24, v3 row_newbcast:12 row_mask:0xf bank_mask:0xf
v_mfma_f32_4x4x4_16b_bf16 v[32:35], v[42:43], a[136:137], v[32:35]
v_mfma_f32_4x4x4_16b_bf16 v[36:39], v[42:43], a[138:139], v[36:39]
s_waitcnt vmcnt(58)
buffer_load_dwordx4 a[128:131], v1, s[8:11], s56 offen nt
s_add_u32 s56, s56, 4096
v_and_b32_dpp v40, v25, v2 row_newbcast:0 row_mask:0xf bank_mask:0xf
v_and_b32_dpp v41, v25, v3 row_newbcast:0 row_mask:0xf bank_mask:0xf
v_mfma_f32_4x4x4_16b_bf16 v[32:35], v[44:45], a[140:141], v[32:35]
v_mfma_f32_4x4x4_16b_bf16 v[36:39], v[44:45], a[142:143], v[36:39]
s_waitcnt vmcnt(58)
buffer_load_dwordx4 a[132:135], v1, s[8:11], s56 offen nt
s_add_u32 s56, s56, 4096
v_and_b32_dpp v42, v25, v2 row_newbcast:4 row_mask:0xf bank_mask:0xf
v_and_b32_dpp v43, v25, v3 row_newbcast:4 row_mask:0xf bank_mask:0xf
v_mfma_f32_4x4x4_16b_bf16 v[32:35], v[40:41], a[144:145], v[32:35]
v_mfma_f32_4x4x4_16b_bf16 v[36:39], v[40:41], a[146:147], v[36:39]
s_waitcnt vmcnt(58)
buffer_load_dwordx4 a[136:139], v1, s[8:11], s56 offen nt
s_add_u32 s56, s56, 4096
v_and_b32_dpp v44, v25, v2 row_newbcast:8 row_mask:0xf bank_mask:0xf
v_and_b32_dpp v45, v25, v3 row_newbcast:8 row_mask:0xf bank_mask:0xf
v_mfma_f32_4x4x4_16b_bf16 v[32:35], v[42:43], a[148:149], v[32:35]
v_mfma_f32_4x4x4_16b_bf16 v[36:39], v[42:43], a[150:151], v[36:39]
s_waitcnt vmcnt(58)
buffer_load_dwordx4 a[140:143], v1, s[8:11], s56 offen nt
s_add_u32 s56, s56, 4096
v_and_b32_dpp v40, v25, v2 row_newbcast:12 row_mask:0xf bank_mask:0xf
v_and_b32_dpp v41, v25, v3 row_newbcast:12 row_mask:0xf bank_mask:0xf
v_mfma_f32_4x4x4_16b_bf16 v[32:35], v[44:45], a[152:153], v[32:35]
v_mfma_f32_4x4x4_16b_bf16 v[36:39], v[44:45], a[154:155], v[36:39]
s_waitcnt vmcnt(58)
buffer_load_dwordx4 a[144:147], v1, s[8:11], s56 offen nt
s_add_u32 s56, s56, 4096
v_and_b32_dpp v42, v26, v2 row_newbcast:0 row_mask:0xf bank_mask:0xf
v_and_b32_dpp v43, v26, v3 row_newbcast:0 row_mask:0xf bank_mask:0xf
v_mfma_f32_4x4x4_16b_bf16 v[32:35], v[40:41], a[156:157], v[32:35]
v_mfma_f32_4x4x4_16b_bf16 v[36:39], v[40:41], a[158:159], v[36:39]
s_waitcnt vmcnt(58)
buffer_load_dwordx4 a[148:151], v1, s[8:11], s56 offen nt
s_add_u32 s56, s56, 4096
v_and_b32_dpp v44, v26, v2 row_newbcast:4 row_mask:0xf bank_mask:0xf
v_and_b32_dpp v45, v26, v3 row_newbcast:4 row_mask:0xf bank_mask:0xf
v_mfma_f32_4x4x4_16b_bf16 v[32:35], v[42:43], a[160:161], v[32:35]
v_mfma_f32_4x4x4_16b_bf16 v[36:39], v[42:43], a[162:163], v[36:39]
s_waitcnt vmcnt(58)
buffer_load_dwordx4 a[152:155], v1, s[8:11], s56 offen nt
s_add_u32 s56, s56, 4096
v_and_b32_dpp v40, v26, v2 row_newbcast:8 row_mask:0xf bank_mask:0xf
v_and_b32_dpp v41, v26, v3 row_newbcast:8 row_mask:0xf bank_mask:0xf
v_mfma_f32_4x4x4_16b_bf16 v[32:35], v[44:45], a[164:165], v[32:35]
v_mfma_f32_4x4x4_16b_bf16 v[36:39], v[44:45], a[166:167], v[36:39]
s_waitcnt vmcnt(58)
buffer_load_dwordx4 a[156:159], v1, s[8:11], s56 offen nt
s_add_u32 s56, s56, 4096
v_and_b32_dpp v42, v26, v2 row_newbcast:12 row_mask:0xf bank_mask:0xf
v_and_b32_dpp v43, v26, v3 row_newbcast:12 row_mask:0xf bank_mask:0xf
v_mfma_f32_4x4x4_16b_bf16 v[32:35], v[40:41], a[168:169], v[32:35]
v_mfma_f32_4x4x4_16b_bf16 v[36:39], v[40:41], a[170:171], v[36:39]
s_waitcnt vmcnt(58)
buffer_load_dwordx4 a[160:163], v1, s[8:11], s56 offen nt
s_add_u32 s56, s56, 4096
v_and_b32_dpp v44, v27, v2 row_newbcast:0 row_mask:0xf bank_mask:0xf
v_and_b32_dpp v45, v27, v3 row_newbcast:0 row_mask:0xf bank_mask:0xf
v_mfma_f32_4x4x4_16b_bf16 v[32:35], v[42:43], a[172:173], v[32:35]
v_mfma_f32_4x4x4_16b_bf16 v[36:39], v[42:43], a[174:175], v[36:39]
s_waitcnt vmcnt(58)
buffer_load_dwordx4 a[164:167], v1, s[8:11], s56 offen nt
s_add_u32 s56, s56, 4096
v_and_b32_dpp v40, v27, v2 row_newbcast:4 row_mask:0xf bank_mask:0xf
v_and_b32_dpp v41, v27, v3 row_newbcast:4 row_mask:0xf bank_mask:0xf
v_mfma_f32_4x4x4_16b_bf16 v[32:35], v[44:45], a[176:177], v[32:35]
v_mfma_f32_4x4x4_16b_bf16 v[36:39], v[44:45], a[178:179], v[36:39]
s_waitcnt vmcnt(58)
buffer_load_dwordx4 a[168:171], v1, s[8:11], s56 offen nt
s_add_u32 s56, s56, 4096
v_and_b32_dpp v42, v27, v2 row_newbcast:8 row_mask:0xf bank_mask:0xf
v_and_b32_dpp v43, v27, v3 row_newbcast:8 row_mask:0xf bank_mask:0xf
v_mfma_f32_4x4x4_16b_bf16 v[32:35], v[40:41], a[180:181], v[32:35]
v_mfma_f32_4x4x4_16b_bf16 v[36:39], v[40:41], a[182:183], v[36:39]
s_waitcnt vmcnt(58)
buffer_load_dwordx4 a[172:175], v1, s[8:11], s56 offen nt
s_add_u32 s56, s56, 4096
v_and_b32_dpp v44, v27, v2 row_newbcast:12 row_mask:0xf bank_mask:0xf
v_and_b32_dpp v45, v27, v3 row_newbcast:12 row_mask:0xf bank_mask:0xf
v_mfma_f32_4x4x4_16b_bf16 v[32:35], v[42:43], a[184:185], v[32:35]
v_mfma_f32_4x4x4_16b_bf16 v[36:39], v[42:43], a[186:187], v[36:39]
s_waitcnt vmcnt(58)
buffer_load_dwordx4 a[176:179], v1, s[8:11], s56 offen nt
s_add_u32 s56, s56, 4096
v_and_b32_dpp v40, v28, v2 row_newbcast:0 row_mask:0xf bank_mask:0xf
v_and_b32_dpp v41, v28, v3 row_newbcast:0 row_mask:0xf bank_mask:0xf
v_mfma_f32_4x4x4_16b_bf16 v[32:35], v[44:45], a[188:189], v[32:35]
v_mfma_f32_4x4x4_16b_bf16 v[36:39], v[44:45], a[190:191], v[36:39]
s_waitcnt vmcnt(58)
buffer_load_dwordx4 a[180:183], v1, s[8:11], s56 offen nt
s_add_u32 s56, s56, 4096
v_and_b32_dpp v42, v28, v2 row_newbcast:4 row_mask:0xf bank_mask:0xf
v_and_b32_dpp v43, v28, v3 row_newbcast:4 row_mask:0xf bank_mask:0xf
v_mfma_f32_4x4x4_16b_bf16 v[32:35], v[40:41], a[192:193], v[32:35]
v_mfma_f32_4x4x4_16b_bf16 v[36:39], v[40:41], a[194:195], v[36:39]
s_waitcnt vmcnt(58)
buffer_load_dwordx4 a[184:187], v1, s[8:11], s56 offen nt
s_add_u32 s56, s56, 4096
v_and_b32_dpp v44, v28, v2 row_newbcast:8 row_mask:0xf bank_mask:0xf
v_and_b32_dpp v45, v28, v3 row_newbcast:8 row_mask:0xf bank_mask:0xf
v_mfma_f32_4x4x4_16b_bf16 v[32:35], v[42:43], a[196:197], v[32:35]
v_mfma_f32_4x4x4_16b_bf16 v[36:39], v[42:43], a[198:199], v[36:39]
s_waitcnt vmcnt(58)
buffer_load_dwordx4 a[188:191], v1, s[8:11], s56 offen nt
s_add_u32 s56, s56, 4096
v_and_b32_dpp v40, v28, v2 row_newbcast:12 row_mask:0xf bank_mask:0xf
v_and_b32_dpp v41, v28, v3 row_newbcast:12 row_mask:0xf bank_mask:0xf
v_mfma_f32_4x4x4_16b_bf16 v[32:35], v[44:45], a[200:201], v[32:35]
v_mfma_f32_4x4x4_16b_bf16 v[36:39], v[44:45], a[202:203], v[36:39]
s_waitcnt vmcnt(58)
buffer_load_dwordx4 a[192:195], v1, s[8:11], s56 offen nt
s_add_u32 s56, s56, 4096
s_cmp_eq_u32 s3, 0
s_cbranch_scc0 L_nofl_20
s_lshl_b32 s32, s24, 7
s_lshl_b32 s33, s25, 4
s_add_u32 s32, s32, s33
s_add_u32 s32, s32, 655360
v_mov_b32 v48, s32
v_mov_b32 v52, 0
v_mov_b32 v53, 0
v_mov_b32 v54, 0
v_mov_b32 v55, 0
s_mov_b64 exec, 1
global_store_dwordx4 v48, v[52:55], s[16:17] sc1
s_mov_b64 exec, -1
L_nofl_20:
v_and_b32_dpp v42, v29, v2 row_newbcast:0 row_mask:0xf bank_mask:0xf
v_and_b32_dpp v43, v29, v3 row_newbcast:0 row_mask:0xf bank_mask:0xf
v_mfma_f32_4x4x4_16b_bf16 v[32:35], v[40:41], a[204:205], v[32:35]
v_mfma_f32_4x4x4_16b_bf16 v[36:39], v[40:41], a[206:207], v[36:39]
s_waitcnt vmcnt(58)
buffer_load_dwordx4 a[196:199], v1, s[8:11], s56 offen nt
s_add_u32 s56, s56, 4096
v_and_b32_dpp v44, v29, v2 row_newbcast:4 row_mask:0xf bank_mask:0xf
v_and_b32_dpp v45, v29, v3 row_newbcast:4 row_mask:0xf bank_mask:0xf
v_mfma_f32_4x4x4_16b_bf16 v[32:35], v[42:43], a[208:209], v[32:35]
v_mfma_f32_4x4x4_16b_bf16 v[36:39], v[42:43], a[210:211], v[36:39]
s_waitcnt vmcnt(58)
buffer_load_dwordx4 a[200:203], v1, s[8:11], s56 offen nt
s_add_u32 s56, s56, 4096
v_and_b32_dpp v40, v29, v2 row_newbcast:8 row_mask:0xf bank_mask:0xf
v_and_b32_dpp v41, v29, v3 row_newbcast:8 row_mask:0xf bank_mask:0xf
v_mfma_f32_4x4x4_16b_bf16 v[32:35], v[44:45], a[212:213], v[32:35]
v_mfma_f32_4x4x4_16b_bf16 v[36:39], v[44:45], a[214:215], v[36:39]
s_waitcnt vmcnt(58)
buffer_load_dwordx4 a[204:207], v1, s[8:11], s56 offen nt
s_add_u32 s56, s56, 4096
v_and_b32_dpp v42, v29, v2 row_newbcast:12 row_mask:0xf bank_mask:0xf
v_and_b32_dpp v43, v29, v3 row_newbcast:12 row_mask:0xf bank_mask:0xf
v_mfma_f32_4x4x4_16b_bf16 v[32:35], v[40:41], a[216:217], v[32:35]
v_mfma_f32_4x4x4_16b_bf16 v[36:39], v[40:41], a[218:219], v[36:39]
s_waitcnt vmcnt(58)
buffer_load_dwordx4 a[208:211], v1, s[8:11], s56 offen nt
s_add_u32 s56, s56, 4096
v_and_b32_dpp v44, v30, v2 row_newbcast:0 row_mask:0xf bank_mask:0xf
v_and_b32_dpp v45, v30, v3 row_newbcast:0 row_mask:0xf bank_mask:0xf
v_mfma_f32_4x4x4_16b_bf16 v[32:35], v[42:43], a[220:221], v[32:35]
v_mfma_f32_4x4x4_16b_bf16 v[36:39], v[42:43], a[222:223], v[36:39]
s_waitcnt vmcnt(58)
buffer_load_dwordx4 a[212:215], v1, s[8:11], s56 offen nt
s_add_u32 s56, s56, 4096
v_and_b32_dpp v40, v30, v2 row_newbcast:4 row_mask:0xf bank_mask:0xf
v_and_b32_dpp v41, v30, v3 row_newbcast:4 row_mask:0xf bank_mask:0xf
v_mfma_f32_4x4x4_16b_bf16 v[32:35], v[44:45], a[224:225], v[32:35]
v_mfma_f32_4x4x4_16b_bf16 v[36:39], v[44:45], a[226:227], v[36:39]
s_waitcnt vmcnt(58)
buffer_load_dwordx4 a[216:219], v1, s[8:11], s56 offen nt
s_add_u32 s56, s56, 4096
v_and_b32_dpp v42, v30, v2 row_newbcast:8 row_mask:0xf bank_mask:0xf
v_and_b32_dpp v43, v30, v3 row_newbcast:8 row_mask:0xf bank_mask:0xf
v_mfma_f32_4x4x4_16b_bf16 v[32:35], v[40:41], a[228:229], v[32:35]
v_mfma_f32_4x4x4_16b_bf16 v[36:39], v[40:41], a[230:231], v[36:39]
s_waitcnt vmcnt(58)
buffer_load_dwordx4 a[220:223], v1, s[8:11], s56 offen nt
s_add_u32 s56, s56, 4096
v_and_b32_dpp v44, v30, v2 row_newbcast:12 row_mask:0xf bank_mask:0xf
v_and_b32_dpp v45, v30, v3 row_newbcast:12 row_mask:0xf bank_mask:0xf
v_mfma_f32_4x4x4_16b_bf16 v[32:35], v[42:43], a[232:233], v[32:35]
v_mfma_f32_4x4x4_16b_bf16 v[36:39], v[42:43], a[234:235], v[36:39]
s_waitcnt vmcnt(58)
buffer_load_dwordx4 a[224:227], v1, s[8:11], s56 offen nt
s_add_u32 s56, s56, 4096
v_and_b32_dpp v40, v31, v2 row_newbcast:0 row_mask:0xf bank_mask:0xf
v_and_b32_dpp v41, v31, v3 row_newbcast:0 row_mask:0xf bank_mask:0xf
v_mfma_f32_4x4x4_16b_bf16 v[32:35], v[44:45], a[236:237], v[32:35]
v_mfma_f32_4x4x4_16b_bf16 v[36:39], v[44:45], a[238:239], v[36:39]
s_waitcnt vmcnt(58)
buffer_load_dwordx4 a[228:231], v1, s[8:11], s56 offen nt
s_add_u32 s56, s56, 4096
v_and_b32_dpp v42, v31, v2 row_newbcast:4 row_mask:0xf bank_mask:0xf
v_and_b32_dpp v43, v31, v3 row_newbcast:4 row_mask:0xf bank_mask:0xf
v_mfma_f32_4x4x4_16b_bf16 v[32:35], v[40:41], a[240:241], v[32:35]
v_mfma_f32_4x4x4_16b_bf16 v[36:39], v[40:41], a[242:243], v[36:39]
s_waitcnt vmcnt(58)
buffer_load_dwordx4 a[232:235], v1, s[8:11], s56 offen nt
s_add_u32 s56, s56, 4096
v_and_b32_dpp v44, v31, v2 row_newbcast:8 row_mask:0xf bank_mask:0xf
v_and_b32_dpp v45, v31, v3 row_newbcast:8 row_mask:0xf bank_mask:0xf
v_mfma_f32_4x4x4_16b_bf16 v[32:35], v[42:43], a[244:245], v[32:35]
v_mfma_f32_4x4x4_16b_bf16 v[36:39], v[42:43], a[246:247], v[36:39]
s_waitcnt vmcnt(58)
buffer_load_dwordx4 a[236:239], v1, s[8:11], s56 offen nt
s_add_u32 s56, s56, 4096
v_and_b32_dpp v40, v31, v2 row_newbcast:12 row_mask:0xf bank_mask:0xf
v_and_b32_dpp v41, v31, v3 row_newbcast:12 row_mask:0xf bank_mask:0xf
v_mfma_f32_4x4x4_16b_bf16 v[32:35], v[44:45], a[248:249], v[32:35]
v_mfma_f32_4x4x4_16b_bf16 v[36:39], v[44:45], a[250:251], v[36:39]
s_waitcnt vmcnt(58)
buffer_load_dwordx4 a[240:243], v1, s[8:11], s56 offen nt
s_add_u32 s56, s56, 4096
s_nop 1
v_mfma_f32_4x4x4_16b_bf16 v[32:35], v[40:41], a[252:253], v[32:35]
v_mfma_f32_4x4x4_16b_bf16 v[36:39], v[40:41], a[254:255], v[36:39]
s_waitcnt vmcnt(58)
buffer_load_dwordx4 a[244:247], v1, s[8:11], s56 offen nt
s_add_u32 s56, s56, 4096
s_waitcnt vmcnt(58)
buffer_load_dwordx4 a[248:251], v1, s[8:11], s56 offen nt
s_add_u32 s56, s56, 4096
s_waitcnt vmcnt(58)
buffer_load_dwordx4 a[252:255], v1, s[8:11], s56 offen nt
s_add_u32 s56, s56, 4096
s_branch L_pvdone
L_pvw:
s_mov_b32 s51, 0
v_lshrrev_b32 v48, 3, v0
v_mul_u32_u24 v48, 20480, v48
v_and_b32 v49, 7, v0
v_lshl_add_u32 v48, v49, 4, v48
s_mul_i32 s42, s3, 128
s_lshl_b32 s44, s52, 9
s_add_u32 s42, s42, s44
s_mul_i32 s42, s42, 1280
s_lshl_b32 s45, s53, 7
s_add_u32 s42, s42, s45
s_mul_i32 s43, s3, 16384
s_add_u32 s43, s43, 65536
v_mov_b32 v32, 0
v_mov_b32 v33, 0
v_mov_b32 v34, 0
v_mov_b32 v35, 0
v_mov_b32 v36, 0
v_mov_b32 v37, 0
v_mov_b32 v38, 0
v_mov_b32 v39, 0
v_and_b32_dpp v40, v16, v2 row_newbcast:0 row_mask:0xf bank_mask:0xf
v_and_b32_dpp v41, v16, v3 row_newbcast:0 row_mask:0xf bank_mask:0xf
v_and_b32_dpp v42, v16, v2 row_newbcast:4 row_mask:0xf bank_mask:0xf
v_and_b32_dpp v43, v16, v3 row_newbcast:4 row_mask:0xf bank_mask:0xf
s_waitcnt vmcnt(60)
v_mfma_f32_4x4x4_16b_bf16 v[32:35], v[40:41], a[0:1], v[32:35]
v_mfma_f32_4x4x4_16b_bf16 v[36:39], v[40:41], a[2:3], v[36:39]
v_and_b32_dpp v44, v16, v2 row_newbcast:8 row_mask:0xf bank_mask:0xf
v_and_b32_dpp v45, v16, v3 row_newbcast:8 row_mask:0xf bank_mask:0xf
v_mfma_f32_4x4x4_16b_bf16 v[32:35], v[42:43], a[4:5], v[32:35]
v_mfma_f32_4x4x4_16b_bf16 v[36:39], v[42:43], a[6:7], v[36:39]
s_mov_b32 m0, s43
s_add_u32 s43, s43, 1024
buffer_load_dwordx4 v48, s[12:15], s42 offen lds
s_add_u32 s42, s42, 1280
v_and_b32_dpp v40, v16, v2 row_newbcast:12 row_mask:0xf bank_mask:0xf
v_and_b32_dpp v41, v16, v3 row_newbcast:12 row_mask:0xf bank_mask:0xf
v_mfma_f32_4x4x4_16b_bf16 v[32:35], v[44:45], a[8:9], v[32:35]
v_mfma_f32_4x4x4_16b_bf16 v[36:39], v[44:45], a[10:11], v[36:39]
v_and_b32_dpp v42, v17, v2 row_newbcast:0 row_mask:0xf bank_mask:0xf
v_and_b32_dpp v43, v17, v3 row_newbcast:0 row_mask:0xf bank_mask:0xf
v_mfma_f32_4x4x4_16b_bf16 v[32:35], v[40:41], a[12:13], v[32:35]
v_mfma_f32_4x4x4_16b_bf16 v[36:39], v[40:41], a[14:15], v[36:39]
v_and_b32_dpp v44, v17, v2 row_newbcast:4 row_mask:0xf bank_mask:0xf
v_and_b32_dpp v45, v17, v3 row_newbcast:4 row_mask:0xf bank_mask:0xf
s_waitcnt vmcnt(57)
v_mfma_f32_4x4x4_16b_bf16 v[32:35], v[42:43], a[16:17], v[32:35]
v_mfma_f32_4x4x4_16b_bf16 v[36:39], v[42:43], a[18:19], v[36:39]
v_and_b32_dpp v40, v17, v2 row_newbcast:8 row_mask:0xf bank_mask:0xf
v_and_b32_dpp v41, v17, v3 row_newbcast:8 row_mask:0xf bank_mask:0xf
v_mfma_f32_4x4x4_16b_bf16 v[32:35], v[44:45], a[20:21], v[32:35]
v_mfma_f32_4x4x4_16b_bf16 v[36:39], v[44:45], a[22:23], v[36:39]
s_mov_b32 m0, s43
s_add_u32 s43, s43, 1024
buffer_load_dwordx4 v48, s[12:15], s42 offen lds
s_add_u32 s42, s42, 1280
v_and_b32_dpp v42, v17, v2 row_newbcast:12 row_mask:0xf bank_mask:0xf
v_and_b32_dpp v43, v17, v3 row_newbcast:12 row_mask:0xf bank_mask:0xf
v_mfma_f32_4x4x4_16b_bf16 v[32:35], v[40:41], a[24:25], v[32:35]
v_mfma_f32_4x4x4_16b_bf16 v[36:39], v[40:41], a[26:27], v[36:39]
v_and_b32_dpp v44, v18, v2 row_newbcast:0 row_mask:0xf bank_mask:0xf
v_and_b32_dpp v45, v18, v3 row_newbcast:0 row_mask:0xf bank_mask:0xf
v_mfma_f32_4x4x4_16b_bf16 v[32:35], v[42:43], a[28:29], v[32:35]
v_mfma_f32_4x4x4_16b_bf16 v[36:39], v[42:43], a[30:31], v[36:39]
v_and_b32_dpp v40, v18, v2 row_newbcast:4 row_mask:0xf bank_mask:0xf
v_and_b32_dpp v41, v18, v3 row_newbcast:4 row_mask:0xf bank_mask:0xf
s_waitcnt vmcnt(54)
v_mfma_f32_4x4x4_16b_bf16 v[32:35], v[44:45], a[32:33], v[32:35]
v_mfma_f32_4x4x4_16b_bf16 v[36:39], v[44:45], a[34:35], v[36:39]
v_and_b32_dpp v42, v18, v2 row_newbcast:8 row_mask:0xf bank_mask:0xf
v_and_b32_dpp v43, v18, v3 row_newbcast:8 row_mask:0xf bank_mask:0xf
v_mfma_f32_4x4x4_16b_bf16 v[32:35], v[40:41], a[36:37], v[32:35]
v_mfma_f32_4x4x4_16b_bf16 v[36:39], v[40:41], a[38:39], v[36:39]
s_mov_b32 m0, s43
s_add_u32 s43, s43, 1024
buffer_load_dwordx4 v48, s[12:15], s42 offen lds
s_add_u32 s42, s42, 1280
v_and_b32_dpp v44, v18, v2 row_newbcast:12 row_mask:0xf bank_mask:0xf
v_and_b32_dpp v45, v18, v3 row_newbcast:12 row_mask:0xf bank_mask:0xf
v_mfma_f32_4x4x4_16b_bf16 v[32:35], v[42:43], a[40:41], v[32:35]
v_mfma_f32_4x4x4_16b_bf16 v[36:39], v[42:43], a[42:43], v[36:39]
v_and_b32_dpp v40, v19, v2 row_newbcast:0 row_mask:0xf bank_mask:0xf
v_and_b32_dpp v41, v19, v3 row_newbcast:0 row_mask:0xf bank_mask:0xf
v_mfma_f32_4x4x4_16b_bf16 v[32:35], v[44:45], a[44:45], v[32:35]
v_mfma_f32_4x4x4_16b_bf16 v[36:39], v[44:45], a[46:47], v[36:39]
v_and_b32_dpp v42, v19, v2 row_newbcast:4 row_mask:0xf bank_mask:0xf
v_and_b32_dpp v43, v19, v3 row_newbcast:4 row_mask:0xf bank_mask:0xf
s_waitcnt vmcnt(51)
v_mfma_f32_4x4x4_16b_bf16 v[32:35], v[40:41], a[48:49], v[32:35]
v_mfma_f32_4x4x4_16b_bf16 v[36:39], v[40:41], a[50:51], v[36:39]
v_and_b32_dpp v44, v19, v2 row_newbcast:8 row_mask:0xf bank_mask:0xf
v_and_b32_dpp v45, v19, v3 row_newbcast:8 row_mask:0xf bank_mask:0xf
v_mfma_f32_4x4x4_16b_bf16 v[32:35], v[42:43], a[52:53], v[32:35]
v_mfma_f32_4x4x4_16b_bf16 v[36:39], v[42:43], a[54:55], v[36:39]
s_mov_b32 m0, s43
s_add_u32 s43, s43, 1024
buffer_load_dwordx4 v48, s[12:15], s42 offen lds
s_add_u32 s42, s42, 1280
v_and_b32_dpp v40, v19, v2 row_newbcast:12 row_mask:0xf bank_mask:0xf
v_and_b32_dpp v41, v19, v3 row_newbcast:12 row_mask:0xf bank_mask:0xf
v_mfma_f32_4x4x4_16b_bf16 v[32:35], v[44:45], a[56:57], v[32:35]
v_mfma_f32_4x4x4_16b_bf16 v[36:39], v[44:45], a[58:59], v[36:39]
v_and_b32_dpp v42, v20, v2 row_newbcast:0 row_mask:0xf bank_mask:0xf
v_and_b32_dpp v43, v20, v3 row_newbcast:0 row_mask:0xf bank_mask:0xf
v_mfma_f32_4x4x4_16b_bf16 v[32:35], v[40:41], a[60:61], v[32:35]
v_mfma_f32_4x4x4_16b_bf16 v[36:39], v[40:41], a[62:63], v[36:39]
v_and_b32_dpp v44, v20, v2 row_newbcast:4 row_mask:0xf bank_mask:0xf
v_and_b32_dpp v45, v20, v3 row_newbcast:4 row_mask:0xf bank_mask:0xf
s_waitcnt vmcnt(48)
v_mfma_f32_4x4x4_16b_bf16 v[32:35], v[42:43], a[64:65], v[32:35]
v_mfma_f32_4x4x4_16b_bf16 v[36:39], v[42:43], a[66:67], v[36:39]
v_and_b32_dpp v40, v20, v2 row_newbcast:8 row_mask:0xf bank_mask:0xf
v_and_b32_dpp v41, v20, v3 row_newbcast:8 row_mask:0xf bank_mask:0xf
v_mfma_f32_4x4x4_16b_bf16 v[32:35], v[44:45], a[68:69], v[32:35]
v_mfma_f32_4x4x4_16b_bf16 v[36:39], v[44:45], a[70:71], v[36:39]
s_mov_b32 m0, s43
s_add_u32 s43, s43, 1024
buffer_load_dwordx4 v48, s[12:15], s42 offen lds
s_add_u32 s42, s42, 1280
v_and_b32_dpp v42, v20, v2 row_newbcast:12 row_mask:0xf bank_mask:0xf
v_and_b32_dpp v43, v20, v3 row_newbcast:12 row_mask:0xf bank_mask:0xf
v_mfma_f32_4x4x4_16b_bf16 v[32:35], v[40:41], a[72:73], v[32:35]
v_mfma_f32_4x4x4_16b_bf16 v[36:39], v[40:41], a[74:75], v[36:39]
v_and_b32_dpp v44, v21, v2 row_newbcast:0 row_mask:0xf bank_mask:0xf
v_and_b32_dpp v45, v21, v3 row_newbcast:0 row_mask:0xf bank_mask:0xf
v_mfma_f32_4x4x4_16b_bf16 v[32:35], v[42:43], a[76:77], v[32:35]
v_mfma_f32_4x4x4_16b_bf16 v[36:39], v[42:43], a[78:79], v[36:39]
v_and_b32_dpp v40, v21, v2 row_newbcast:4 row_mask:0xf bank_mask:0xf
v_and_b32_dpp v41, v21, v3 row_newbcast:4 row_mask:0xf bank_mask:0xf
s_waitcnt vmcnt(45)
v_mfma_f32_4x4x4_16b_bf16 v[32:35], v[44:45], a[80:81], v[32:35]
v_mfma_f32_4x4x4_16b_bf16 v[36:39], v[44:45], a[82:83], v[36:39]
v_and_b32_dpp v42, v21, v2 row_newbcast:8 row_mask:0xf bank_mask:0xf
v_and_b32_dpp v43, v21, v3 row_newbcast:8 row_mask:0xf bank_mask:0xf
v_mfma_f32_4x4x4_16b_bf16 v[32:35], v[40:41], a[84:85], v[32:35]
v_mfma_f32_4x4x4_16b_bf16 v[36:39], v[40:41], a[86:87], v[36:39]
s_mov_b32 m0, s43
s_add_u32 s43, s43, 1024
buffer_load_dwordx4 v48, s[12:15], s42 offen lds
s_add_u32 s42, s42, 1280
v_and_b32_dpp v44, v21, v2 row_newbcast:12 row_mask:0xf bank_mask:0xf
v_and_b32_dpp v45, v21, v3 row_newbcast:12 row_mask:0xf bank_mask:0xf
v_mfma_f32_4x4x4_16b_bf16 v[32:35], v[42:43], a[88:89], v[32:35]
v_mfma_f32_4x4x4_16b_bf16 v[36:39], v[42:43], a[90:91], v[36:39]
v_and_b32_dpp v40, v22, v2 row_newbcast:0 row_mask:0xf bank_mask:0xf
v_and_b32_dpp v41, v22, v3 row_newbcast:0 row_mask:0xf bank_mask:0xf
v_mfma_f32_4x4x4_16b_bf16 v[32:35], v[44:45], a[92:93], v[32:35]
v_mfma_f32_4x4x4_16b_bf16 v[36:39], v[44:45], a[94:95], v[36:39]
v_and_b32_dpp v42, v22, v2 row_newbcast:4 row_mask:0xf bank_mask:0xf
v_and_b32_dpp v43, v22, v3 row_newbcast:4 row_mask:0xf bank_mask:0xf
s_waitcnt vmcnt(42)
v_mfma_f32_4x4x4_16b_bf16 v[32:35], v[40:41], a[96:97], v[32:35]
v_mfma_f32_4x4x4_16b_bf16 v[36:39], v[40:41], a[98:99], v[36:39]
v_and_b32_dpp v44, v22, v2 row_newbcast:8 row_mask:0xf bank_mask:0xf
v_and_b32_dpp v45, v22, v3 row_newbcast:8 row_mask:0xf bank_mask:0xf
v_mfma_f32_4x4x4_16b_bf16 v[32:35], v[42:43], a[100:101], v[32:35]
v_mfma_f32_4x4x4_16b_bf16 v[36:39], v[42:43], a[102:103], v[36:39]
s_mov_b32 m0, s43
s_add_u32 s43, s43, 1024
buffer_load_dwordx4 v48, s[12:15], s42 offen lds
s_add_u32 s42, s42, 1280
v_and_b32_dpp v40, v22, v2 row_newbcast:12 row_mask:0xf bank_mask:0xf
v_and_b32_dpp v41, v22, v3 row_newbcast:12 row_mask:0xf bank_mask:0xf
v_mfma_f32_4x4x4_16b_bf16 v[32:35], v[44:45], a[104:105], v[32:35]
v_mfma_f32_4x4x4_16b_bf16 v[36:39], v[44:45], a[106:107], v[36:39]
v_and_b32_dpp v42, v23, v2 row_newbcast:0 row_mask:0xf bank_mask:0xf
v_and_b32_dpp v43, v23, v3 row_newbcast:0 row_mask:0xf bank_mask:0xf
v_mfma_f32_4x4x4_16b_bf16 v[32:35], v[40:41], a[108:109], v[32:35]
v_mfma_f32_4x4x4_16b_bf16 v[36:39], v[40:41], a[110:111], v[36:39]
v_and_b32_dpp v44, v23, v2 row_newbcast:4 row_mask:0xf bank_mask:0xf
v_and_b32_dpp v45, v23, v3 row_newbcast:4 row_mask:0xf bank_mask:0xf
s_waitcnt vmcnt(39)
v_mfma_f32_4x4x4_16b_bf16 v[32:35], v[42:43], a[112:113], v[32:35]
v_mfma_f32_4x4x4_16b_bf16 v[36:39], v[42:43], a[114:115], v[36:39]
v_and_b32_dpp v40, v23, v2 row_newbcast:8 row_mask:0xf bank_mask:0xf
v_and_b32_dpp v41, v23, v3 row_newbcast:8 row_mask:0xf bank_mask:0xf
v_mfma_f32_4x4x4_16b_bf16 v[32:35], v[44:45], a[116:117], v[32:35]
v_mfma_f32_4x4x4_16b_bf16 v[36:39], v[44:45], a[118:119], v[36:39]
s_mov_b32 m0, s43
s_add_u32 s43, s43, 1024
buffer_load_dwordx4 v48, s[12:15], s42 offen lds
s_add_u32 s42, s42, 1280
v_and_b32_dpp v42, v23, v2 row_newbcast:12 row_mask:0xf bank_mask:0xf
v_and_b32_dpp v43, v23, v3 row_newbcast:12 row_mask:0xf bank_mask:0xf
v_mfma_f32_4x4x4_16b_bf16 v[32:35], v[40:41], a[120:121], v[32:35]
v_mfma_f32_4x4x4_16b_bf16 v[36:39], v[40:41], a[122:123], v[36:39]
v_and_b32_dpp v44, v24, v2 row_newbcast:0 row_mask:0xf bank_mask:0xf
v_and_b32_dpp v45, v24, v3 row_newbcast:0 row_mask:0xf bank_mask:0xf
v_mfma_f32_4x4x4_16b_bf16 v[32:35], v[42:43], a[124:125], v[32:35]
v_mfma_f32_4x4x4_16b_bf16 v[36:39], v[42:43], a[126:127], v[36:39]
v_and_b32_dpp v40, v24, v2 row_newbcast:4 row_mask:0xf bank_mask:0xf
v_and_b32_dpp v41, v24, v3 row_newbcast:4 row_mask:0xf bank_mask:0xf
s_waitcnt vmcnt(36)
v_mfma_f32_4x4x4_16b_bf16 v[32:35], v[44:45], a[128:129], v[32:35]
v_mfma_f32_4x4x4_16b_bf16 v[36:39], v[44:45], a[130:131], v[36:39]
v_and_b32_dpp v42, v24, v2 row_newbcast:8 row_mask:0xf bank_mask:0xf
v_and_b32_dpp v43, v24, v3 row_newbcast:8 row_mask:0xf bank_mask:0xf
v_mfma_f32_4x4x4_16b_bf16 v[32:35], v[40:41], a[132:133], v[32:35]
v_mfma_f32_4x4x4_16b_bf16 v[36:39], v[40:41], a[134:135], v[36:39]
s_mov_b32 m0, s43
s_add_u32 s43, s43, 1024
buffer_load_dwordx4 v48, s[12:15], s42 offen lds
s_add_u32 s42, s42, 1280
v_and_b32_dpp v44, v24, v2 row_newbcast:12 row_mask:0xf bank_mask:0xf
v_and_b32_dpp v45, v24, v3 row_newbcast:12 row_mask:0xf bank_mask:0xf
v_mfma_f32_4x4x4_16b_bf16 v[32:35], v[42:43], a[136:137], v[32:35]
v_mfma_f32_4x4x4_16b_bf16 v[36:39], v[42:43], a[138:139], v[36:39]
v_and_b32_dpp v40, v25, v2 row_newbcast:0 row_mask:0xf bank_mask:0xf
v_and_b32_dpp v41, v25, v3 row_newbcast:0 row_mask:0xf bank_mask:0xf
v_mfma_f32_4x4x4_16b_bf16 v[32:35], v[44:45], a[140:141], v[32:35]
v_mfma_f32_4x4x4_16b_bf16 v[36:39], v[44:45], a[142:143], v[36:39]
v_and_b32_dpp v42, v25, v2 row_newbcast:4 row_mask:0xf bank_mask:0xf
v_and_b32_dpp v43, v25, v3 row_newbcast:4 row_mask:0xf bank_mask:0xf
s_waitcnt vmcnt(33)
v_mfma_f32_4x4x4_16b_bf16 v[32:35], v[40:41], a[144:145], v[32:35]
v_mfma_f32_4x4x4_16b_bf16 v[36:39], v[40:41], a[146:147], v[36:39]
v_and_b32_dpp v44, v25, v2 row_newbcast:8 row_mask:0xf bank_mask:0xf
v_and_b32_dpp v45, v25, v3 row_newbcast:8 row_mask:0xf bank_mask:0xf
v_mfma_f32_4x4x4_16b_bf16 v[32:35], v[42:43], a[148:149], v[32:35]
v_mfma_f32_4x4x4_16b_bf16 v[36:39], v[42:43], a[150:151], v[36:39]
s_mov_b32 m0, s43
s_add_u32 s43, s43, 1024
buffer_load_dwordx4 v48, s[12:15], s42 offen lds
s_add_u32 s42, s42, 1280
v_and_b32_dpp v40, v25, v2 row_newbcast:12 row_mask:0xf bank_mask:0xf
v_and_b32_dpp v41, v25, v3 row_newbcast:12 row_mask:0xf bank_mask:0xf
v_mfma_f32_4x4x4_16b_bf16 v[32:35], v[44:45], a[152:153], v[32:35]
v_mfma_f32_4x4x4_16b_bf16 v[36:39], v[44:45], a[154:155], v[36:39]
v_and_b32_dpp v42, v26, v2 row_newbcast:0 row_mask:0xf bank_mask:0xf
v_and_b32_dpp v43, v26, v3 row_newbcast:0 row_mask:0xf bank_mask:0xf
v_mfma_f32_4x4x4_16b_bf16 v[32:35], v[40:41], a[156:157], v[32:35]
v_mfma_f32_4x4x4_16b_bf16 v[36:39], v[40:41], a[158:159], v[36:39]
v_and_b32_dpp v44, v26, v2 row_newbcast:4 row_mask:0xf bank_mask:0xf
v_and_b32_dpp v45, v26, v3 row_newbcast:4 row_mask:0xf bank_mask:0xf
s_waitcnt vmcnt(30)
v_mfma_f32_4x4x4_16b_bf16 v[32:35], v[42:43], a[160:161], v[32:35]
v_mfma_f32_4x4x4_16b_bf16 v[36:39], v[42:43], a[162:163], v[36:39]
v_and_b32_dpp v40, v26, v2 row_newbcast:8 row_mask:0xf bank_mask:0xf
v_and_b32_dpp v41, v26, v3 row_newbcast:8 row_mask:0xf bank_mask:0xf
v_mfma_f32_4x4x4_16b_bf16 v[32:35], v[44:45], a[164:165], v[32:35]
v_mfma_f32_4x4x4_16b_bf16 v[36:39], v[44:45], a[166:167], v[36:39]
s_mov_b32 m0, s43
s_add_u32 s43, s43, 1024
buffer_load_dwordx4 v48, s[12:15], s42 offen lds
s_add_u32 s42, s42, 1280
v_and_b32_dpp v42, v26, v2 row_newbcast:12 row_mask:0xf bank_mask:0xf
v_and_b32_dpp v43, v26, v3 row_newbcast:12 row_mask:0xf bank_mask:0xf
v_mfma_f32_4x4x4_16b_bf16 v[32:35], v[40:41], a[168:169], v[32:35]
v_mfma_f32_4x4x4_16b_bf16 v[36:39], v[40:41], a[170:171], v[36:39]
v_and_b32_dpp v44, v27, v2 row_newbcast:0 row_mask:0xf bank_mask:0xf
v_and_b32_dpp v45, v27, v3 row_newbcast:0 row_mask:0xf bank_mask:0xf
v_mfma_f32_4x4x4_16b_bf16 v[32:35], v[42:43], a[172:173], v[32:35]
v_mfma_f32_4x4x4_16b_bf16 v[36:39], v[42:43], a[174:175], v[36:39]
v_and_b32_dpp v40, v27, v2 row_newbcast:4 row_mask:0xf bank_mask:0xf
v_and_b32_dpp v41, v27, v3 row_newbcast:4 row_mask:0xf bank_mask:0xf
s_waitcnt vmcnt(27)
v_mfma_f32_4x4x4_16b_bf16 v[32:35], v[44:45], a[176:177], v[32:35]
v_mfma_f32_4x4x4_16b_bf16 v[36:39], v[44:45], a[178:179], v[36:39]
v_and_b32_dpp v42, v27, v2 row_newbcast:8 row_mask:0xf bank_mask:0xf
v_and_b32_dpp v43, v27, v3 row_newbcast:8 row_mask:0xf bank_mask:0xf
v_mfma_f32_4x4x4_16b_bf16 v[32:35], v[40:41], a[180:181], v[32:35]
v_mfma_f32_4x4x4_16b_bf16 v[36:39], v[40:41], a[182:183], v[36:39]
s_mov_b32 m0, s43
s_add_u32 s43, s43, 1024
buffer_load_dwordx4 v48, s[12:15], s42 offen lds
s_add_u32 s42, s42, 1280
v_and_b32_dpp v44, v27, v2 row_newbcast:12 row_mask:0xf bank_mask:0xf
v_and_b32_dpp v45, v27, v3 row_newbcast:12 row_mask:0xf bank_mask:0xf
v_mfma_f32_4x4x4_16b_bf16 v[32:35], v[42:43], a[184:185], v[32:35]
v_mfma_f32_4x4x4_16b_bf16 v[36:39], v[42:43], a[186:187], v[36:39]
v_and_b32_dpp v40, v28, v2 row_newbcast:0 row_mask:0xf bank_mask:0xf
v_and_b32_dpp v41, v28, v3 row_newbcast:0 row_mask:0xf bank_mask:0xf
v_mfma_f32_4x4x4_16b_bf16 v[32:35], v[44:45], a[188:189], v[32:35]
v_mfma_f32_4x4x4_16b_bf16 v[36:39], v[44:45], a[190:191], v[36:39]
v_and_b32_dpp v42, v28, v2 row_newbcast:4 row_mask:0xf bank_mask:0xf
v_and_b32_dpp v43, v28, v3 row_newbcast:4 row_mask:0xf bank_mask:0xf
s_waitcnt vmcnt(24)
v_mfma_f32_4x4x4_16b_bf16 v[32:35], v[40:41], a[192:193], v[32:35]
v_mfma_f32_4x4x4_16b_bf16 v[36:39], v[40:41], a[194:195], v[36:39]
v_and_b32_dpp v44, v28, v2 row_newbcast:8 row_mask:0xf bank_mask:0xf
v_and_b32_dpp v45, v28, v3 row_newbcast:8 row_mask:0xf bank_mask:0xf
v_mfma_f32_4x4x4_16b_bf16 v[32:35], v[42:43], a[196:197], v[32:35]
v_mfma_f32_4x4x4_16b_bf16 v[36:39], v[42:43], a[198:199], v[36:39]
s_mov_b32 m0, s43
s_add_u32 s43, s43, 1024
buffer_load_dwordx4 v48, s[12:15], s42 offen lds
s_add_u32 s42, s42, 1280
v_and_b32_dpp v40, v28, v2 row_newbcast:12 row_mask:0xf bank_mask:0xf
v_and_b32_dpp v41, v28, v3 row_newbcast:12 row_mask:0xf bank_mask:0xf
v_mfma_f32_4x4x4_16b_bf16 v[32:35], v[44:45], a[200:201], v[32:35]
v_mfma_f32_4x4x4_16b_bf16 v[36:39], v[44:45], a[202:203], v[36:39]
v_and_b32_dpp v42, v29, v2 row_newbcast:0 row_mask:0xf bank_mask:0xf
v_and_b32_dpp v43, v29, v3 row_newbcast:0 row_mask:0xf bank_mask:0xf
v_mfma_f32_4x4x4_16b_bf16 v[32:35], v[40:41], a[204:205], v[32:35]
v_mfma_f32_4x4x4_16b_bf16 v[36:39], v[40:41], a[206:207], v[36:39]
v_and_b32_dpp v44, v29, v2 row_newbcast:4 row_mask:0xf bank_mask:0xf
v_and_b32_dpp v45, v29, v3 row_newbcast:4 row_mask:0xf bank_mask:0xf
s_waitcnt vmcnt(21)
v_mfma_f32_4x4x4_16b_bf16 v[32:35], v[42:43], a[208:209], v[32:35]
v_mfma_f32_4x4x4_16b_bf16 v[36:39], v[42:43], a[210:211], v[36:39]
v_and_b32_dpp v40, v29, v2 row_newbcast:8 row_mask:0xf bank_mask:0xf
v_and_b32_dpp v41, v29, v3 row_newbcast:8 row_mask:0xf bank_mask:0xf
v_mfma_f32_4x4x4_16b_bf16 v[32:35], v[44:45], a[212:213], v[32:35]
v_mfma_f32_4x4x4_16b_bf16 v[36:39], v[44:45], a[214:215], v[36:39]
s_mov_b32 m0, s43
s_add_u32 s43, s43, 1024
buffer_load_dwordx4 v48, s[12:15], s42 offen lds
s_add_u32 s42, s42, 1280
v_and_b32_dpp v42, v29, v2 row_newbcast:12 row_mask:0xf bank_mask:0xf
v_and_b32_dpp v43, v29, v3 row_newbcast:12 row_mask:0xf bank_mask:0xf
v_mfma_f32_4x4x4_16b_bf16 v[32:35], v[40:41], a[216:217], v[32:35]
v_mfma_f32_4x4x4_16b_bf16 v[36:39], v[40:41], a[218:219], v[36:39]
v_and_b32_dpp v44, v30, v2 row_newbcast:0 row_mask:0xf bank_mask:0xf
v_and_b32_dpp v45, v30, v3 row_newbcast:0 row_mask:0xf bank_mask:0xf
v_mfma_f32_4x4x4_16b_bf16 v[32:35], v[42:43], a[220:221], v[32:35]
v_mfma_f32_4x4x4_16b_bf16 v[36:39], v[42:43], a[222:223], v[36:39]
v_and_b32_dpp v40, v30, v2 row_newbcast:4 row_mask:0xf bank_mask:0xf
v_and_b32_dpp v41, v30, v3 row_newbcast:4 row_mask:0xf bank_mask:0xf
s_waitcnt vmcnt(18)
v_mfma_f32_4x4x4_16b_bf16 v[32:35], v[44:45], a[224:225], v[32:35]
v_mfma_f32_4x4x4_16b_bf16 v[36:39], v[44:45], a[226:227], v[36:39]
v_and_b32_dpp v42, v30, v2 row_newbcast:8 row_mask:0xf bank_mask:0xf
v_and_b32_dpp v43, v30, v3 row_newbcast:8 row_mask:0xf bank_mask:0xf
v_mfma_f32_4x4x4_16b_bf16 v[32:35], v[40:41], a[228:229], v[32:35]
v_mfma_f32_4x4x4_16b_bf16 v[36:39], v[40:41], a[230:231], v[36:39]
s_mov_b32 m0, s43
s_add_u32 s43, s43, 1024
buffer_load_dwordx4 v48, s[12:15], s42 offen lds
s_add_u32 s42, s42, 1280
v_and_b32_dpp v44, v30, v2 row_newbcast:12 row_mask:0xf bank_mask:0xf
v_and_b32_dpp v45, v30, v3 row_newbcast:12 row_mask:0xf bank_mask:0xf
v_mfma_f32_4x4x4_16b_bf16 v[32:35], v[42:43], a[232:233], v[32:35]
v_mfma_f32_4x4x4_16b_bf16 v[36:39], v[42:43], a[234:235], v[36:39]
v_and_b32_dpp v40, v31, v2 row_newbcast:0 row_mask:0xf bank_mask:0xf
v_and_b32_dpp v41, v31, v3 row_newbcast:0 row_mask:0xf bank_mask:0xf
v_mfma_f32_4x4x4_16b_bf16 v[32:35], v[44:45], a[236:237], v[32:35]
v_mfma_f32_4x4x4_16b_bf16 v[36:39], v[44:45], a[238:239], v[36:39]
v_and_b32_dpp v42, v31, v2 row_newbcast:4 row_mask:0xf bank_mask:0xf
v_and_b32_dpp v43, v31, v3 row_newbcast:4 row_mask:0xf bank_mask:0xf
s_waitcnt vmcnt(15)
v_mfma_f32_4x4x4_16b_bf16 v[32:35], v[40:41], a[240:241], v[32:35]
v_mfma_f32_4x4x4_16b_bf16 v[36:39], v[40:41], a[242:243], v[36:39]
v_and_b32_dpp v44, v31, v2 row_newbcast:8 row_mask:0xf bank_mask:0xf
v_and_b32_dpp v45, v31, v3 row_newbcast:8 row_mask:0xf bank_mask:0xf
v_mfma_f32_4x4x4_16b_bf16 v[32:35], v[42:43], a[244:245], v[32:35]
v_mfma_f32_4x4x4_16b_bf16 v[36:39], v[42:43], a[246:247], v[36:39]
s_mov_b32 m0, s43
s_add_u32 s43, s43, 1024
buffer_load_dwordx4 v48, s[12:15], s42 offen lds
s_add_u32 s42, s42, 1280
v_and_b32_dpp v40, v31, v2 row_newbcast:12 row_mask:0xf bank_mask:0xf
v_and_b32_dpp v41, v31, v3 row_newbcast:12 row_mask:0xf bank_mask:0xf
v_mfma_f32_4x4x4_16b_bf16 v[32:35], v[44:45], a[248:249], v[32:35]
v_mfma_f32_4x4x4_16b_bf16 v[36:39], v[44:45], a[250:251], v[36:39]
s_nop 1
v_mfma_f32_4x4x4_16b_bf16 v[32:35], v[40:41], a[252:253], v[32:35]
v_mfma_f32_4x4x4_16b_bf16 v[36:39], v[40:41], a[254:255], v[36:39]
s_branch L_pvdone
L_pvn:
v_mov_b32 v32, 0
v_mov_b32 v33, 0
v_mov_b32 v34, 0
v_mov_b32 v35, 0
v_mov_b32 v36, 0
v_mov_b32 v37, 0
v_mov_b32 v38, 0
v_mov_b32 v39, 0
s_waitcnt lgkmcnt(0)
v_and_b32_dpp v40, v16, v2 row_newbcast:0 row_mask:0xf bank_mask:0xf
v_and_b32_dpp v41, v16, v3 row_newbcast:0 row_mask:0xf bank_mask:0xf
v_and_b32_dpp v42, v16, v2 row_newbcast:4 row_mask:0xf bank_mask:0xf
v_and_b32_dpp v43, v16, v3 row_newbcast:4 row_mask:0xf bank_mask:0xf
v_mfma_f32_4x4x4_16b_bf16 v[32:35], v[40:41], a[0:1], v[32:35]
v_mfma_f32_4x4x4_16b_bf16 v[36:39], v[40:41], a[2:3], v[36:39]
v_and_b32_dpp v44, v16, v2 row_newbcast:8 row_mask:0xf bank_mask:0xf
v_and_b32_dpp v45, v16, v3 row_newbcast:8 row_mask:0xf bank_mask:0xf
v_mfma_f32_4x4x4_16b_bf16 v[32:35], v[42:43], a[4:5], v[32:35]
v_mfma_f32_4x4x4_16b_bf16 v[36:39], v[42:43], a[6:7], v[36:39]
v_and_b32_dpp v40, v16, v2 row_newbcast:12 row_mask:0xf bank_mask:0xf
v_and_b32_dpp v41, v16, v3 row_newbcast:12 row_mask:0xf bank_mask:0xf
v_mfma_f32_4x4x4_16b_bf16 v[32:35], v[44:45], a[8:9], v[32:35]
v_mfma_f32_4x4x4_16b_bf16 v[36:39], v[44:45], a[10:11], v[36:39]
v_and_b32_dpp v42, v17, v2 row_newbcast:0 row_mask:0xf bank_mask:0xf
v_and_b32_dpp v43, v17, v3 row_newbcast:0 row_mask:0xf bank_mask:0xf
v_mfma_f32_4x4x4_16b_bf16 v[32:35], v[40:41], a[12:13], v[32:35]
v_mfma_f32_4x4x4_16b_bf16 v[36:39], v[40:41], a[14:15], v[36:39]
v_and_b32_dpp v44, v17, v2 row_newbcast:4 row_mask:0xf bank_mask:0xf
v_and_b32_dpp v45, v17, v3 row_newbcast:4 row_mask:0xf bank_mask:0xf
v_mfma_f32_4x4x4_16b_bf16 v[32:35], v[42:43], a[16:17], v[32:35]
v_mfma_f32_4x4x4_16b_bf16 v[36:39], v[42:43], a[18:19], v[36:39]
v_and_b32_dpp v40, v17, v2 row_newbcast:8 row_mask:0xf bank_mask:0xf
v_and_b32_dpp v41, v17, v3 row_newbcast:8 row_mask:0xf bank_mask:0xf
v_mfma_f32_4x4x4_16b_bf16 v[32:35], v[44:45], a[20:21], v[32:35]
v_mfma_f32_4x4x4_16b_bf16 v[36:39], v[44:45], a[22:23], v[36:39]
v_and_b32_dpp v42, v17, v2 row_newbcast:12 row_mask:0xf bank_mask:0xf
v_and_b32_dpp v43, v17, v3 row_newbcast:12 row_mask:0xf bank_mask:0xf
v_mfma_f32_4x4x4_16b_bf16 v[32:35], v[40:41], a[24:25], v[32:35]
v_mfma_f32_4x4x4_16b_bf16 v[36:39], v[40:41], a[26:27], v[36:39]
v_and_b32_dpp v44, v18, v2 row_newbcast:0 row_mask:0xf bank_mask:0xf
v_and_b32_dpp v45, v18, v3 row_newbcast:0 row_mask:0xf bank_mask:0xf
v_mfma_f32_4x4x4_16b_bf16 v[32:35], v[42:43], a[28:29], v[32:35]
v_mfma_f32_4x4x4_16b_bf16 v[36:39], v[42:43], a[30:31], v[36:39]
v_and_b32_dpp v40, v18, v2 row_newbcast:4 row_mask:0xf bank_mask:0xf
v_and_b32_dpp v41, v18, v3 row_newbcast:4 row_mask:0xf bank_mask:0xf
v_mfma_f32_4x4x4_16b_bf16 v[32:35], v[44:45], a[32:33], v[32:35]
v_mfma_f32_4x4x4_16b_bf16 v[36:39], v[44:45], a[34:35], v[36:39]
v_and_b32_dpp v42, v18, v2 row_newbcast:8 row_mask:0xf bank_mask:0xf
v_and_b32_dpp v43, v18, v3 row_newbcast:8 row_mask:0xf bank_mask:0xf
v_mfma_f32_4x4x4_16b_bf16 v[32:35], v[40:41], a[36:37], v[32:35]
v_mfma_f32_4x4x4_16b_bf16 v[36:39], v[40:41], a[38:39], v[36:39]
v_and_b32_dpp v44, v18, v2 row_newbcast:12 row_mask:0xf bank_mask:0xf
v_and_b32_dpp v45, v18, v3 row_newbcast:12 row_mask:0xf bank_mask:0xf
v_mfma_f32_4x4x4_16b_bf16 v[32:35], v[42:43], a[40:41], v[32:35]
v_mfma_f32_4x4x4_16b_bf16 v[36:39], v[42:43], a[42:43], v[36:39]
v_and_b32_dpp v40, v19, v2 row_newbcast:0 row_mask:0xf bank_mask:0xf
v_and_b32_dpp v41, v19, v3 row_newbcast:0 row_mask:0xf bank_mask:0xf
v_mfma_f32_4x4x4_16b_bf16 v[32:35], v[44:45], a[44:45], v[32:35]
v_mfma_f32_4x4x4_16b_bf16 v[36:39], v[44:45], a[46:47], v[36:39]
v_and_b32_dpp v42, v19, v2 row_newbcast:4 row_mask:0xf bank_mask:0xf
v_and_b32_dpp v43, v19, v3 row_newbcast:4 row_mask:0xf bank_mask:0xf
v_mfma_f32_4x4x4_16b_bf16 v[32:35], v[40:41], a[48:49], v[32:35]
v_mfma_f32_4x4x4_16b_bf16 v[36:39], v[40:41], a[50:51], v[36:39]
v_and_b32_dpp v44, v19, v2 row_newbcast:8 row_mask:0xf bank_mask:0xf
v_and_b32_dpp v45, v19, v3 row_newbcast:8 row_mask:0xf bank_mask:0xf
v_mfma_f32_4x4x4_16b_bf16 v[32:35], v[42:43], a[52:53], v[32:35]
v_mfma_f32_4x4x4_16b_bf16 v[36:39], v[42:43], a[54:55], v[36:39]
v_and_b32_dpp v40, v19, v2 row_newbcast:12 row_mask:0xf bank_mask:0xf
v_and_b32_dpp v41, v19, v3 row_newbcast:12 row_mask:0xf bank_mask:0xf
v_mfma_f32_4x4x4_16b_bf16 v[32:35], v[44:45], a[56:57], v[32:35]
v_mfma_f32_4x4x4_16b_bf16 v[36:39], v[44:45], a[58:59], v[36:39]
v_and_b32_dpp v42, v20, v2 row_newbcast:0 row_mask:0xf bank_mask:0xf
v_and_b32_dpp v43, v20, v3 row_newbcast:0 row_mask:0xf bank_mask:0xf
v_mfma_f32_4x4x4_16b_bf16 v[32:35], v[40:41], a[60:61], v[32:35]
v_mfma_f32_4x4x4_16b_bf16 v[36:39], v[40:41], a[62:63], v[36:39]
v_and_b32_dpp v44, v20, v2 row_newbcast:4 row_mask:0xf bank_mask:0xf
v_and_b32_dpp v45, v20, v3 row_newbcast:4 row_mask:0xf bank_mask:0xf
v_mfma_f32_4x4x4_16b_bf16 v[32:35], v[42:43], a[64:65], v[32:35]
v_mfma_f32_4x4x4_16b_bf16 v[36:39], v[42:43], a[66:67], v[36:39]
v_and_b32_dpp v40, v20, v2 row_newbcast:8 row_mask:0xf bank_mask:0xf
v_and_b32_dpp v41, v20, v3 row_newbcast:8 row_mask:0xf bank_mask:0xf
v_mfma_f32_4x4x4_16b_bf16 v[32:35], v[44:45], a[68:69], v[32:35]
v_mfma_f32_4x4x4_16b_bf16 v[36:39], v[44:45], a[70:71], v[36:39]
v_and_b32_dpp v42, v20, v2 row_newbcast:12 row_mask:0xf bank_mask:0xf
v_and_b32_dpp v43, v20, v3 row_newbcast:12 row_mask:0xf bank_mask:0xf
v_mfma_f32_4x4x4_16b_bf16 v[32:35], v[40:41], a[72:73], v[32:35]
v_mfma_f32_4x4x4_16b_bf16 v[36:39], v[40:41], a[74:75], v[36:39]
v_and_b32_dpp v44, v21, v2 row_newbcast:0 row_mask:0xf bank_mask:0xf
v_and_b32_dpp v45, v21, v3 row_newbcast:0 row_mask:0xf bank_mask:0xf
v_mfma_f32_4x4x4_16b_bf16 v[32:35], v[42:43], a[76:77], v[32:35]
v_mfma_f32_4x4x4_16b_bf16 v[36:39], v[42:43], a[78:79], v[36:39]
v_and_b32_dpp v40, v21, v2 row_newbcast:4 row_mask:0xf bank_mask:0xf
v_and_b32_dpp v41, v21, v3 row_newbcast:4 row_mask:0xf bank_mask:0xf
v_mfma_f32_4x4x4_16b_bf16 v[32:35], v[44:45], a[80:81], v[32:35]
v_mfma_f32_4x4x4_16b_bf16 v[36:39], v[44:45], a[82:83], v[36:39]
v_and_b32_dpp v42, v21, v2 row_newbcast:8 row_mask:0xf bank_mask:0xf
v_and_b32_dpp v43, v21, v3 row_newbcast:8 row_mask:0xf bank_mask:0xf
v_mfma_f32_4x4x4_16b_bf16 v[32:35], v[40:41], a[84:85], v[32:35]
v_mfma_f32_4x4x4_16b_bf16 v[36:39], v[40:41], a[86:87], v[36:39]
v_and_b32_dpp v44, v21, v2 row_newbcast:12 row_mask:0xf bank_mask:0xf
v_and_b32_dpp v45, v21, v3 row_newbcast:12 row_mask:0xf bank_mask:0xf
v_mfma_f32_4x4x4_16b_bf16 v[32:35], v[42:43], a[88:89], v[32:35]
v_mfma_f32_4x4x4_16b_bf16 v[36:39], v[42:43], a[90:91], v[36:39]
v_and_b32_dpp v40, v22, v2 row_newbcast:0 row_mask:0xf bank_mask:0xf
v_and_b32_dpp v41, v22, v3 row_newbcast:0 row_mask:0xf bank_mask:0xf
v_mfma_f32_4x4x4_16b_bf16 v[32:35], v[44:45], a[92:93], v[32:35]
v_mfma_f32_4x4x4_16b_bf16 v[36:39], v[44:45], a[94:95], v[36:39]
v_and_b32_dpp v42, v22, v2 row_newbcast:4 row_mask:0xf bank_mask:0xf
v_and_b32_dpp v43, v22, v3 row_newbcast:4 row_mask:0xf bank_mask:0xf
v_mfma_f32_4x4x4_16b_bf16 v[32:35], v[40:41], a[96:97], v[32:35]
v_mfma_f32_4x4x4_16b_bf16 v[36:39], v[40:41], a[98:99], v[36:39]
v_and_b32_dpp v44, v22, v2 row_newbcast:8 row_mask:0xf bank_mask:0xf
v_and_b32_dpp v45, v22, v3 row_newbcast:8 row_mask:0xf bank_mask:0xf
v_mfma_f32_4x4x4_16b_bf16 v[32:35], v[42:43], a[100:101], v[32:35]
v_mfma_f32_4x4x4_16b_bf16 v[36:39], v[42:43], a[102:103], v[36:39]
v_and_b32_dpp v40, v22, v2 row_newbcast:12 row_mask:0xf bank_mask:0xf
v_and_b32_dpp v41, v22, v3 row_newbcast:12 row_mask:0xf bank_mask:0xf
v_mfma_f32_4x4x4_16b_bf16 v[32:35], v[44:45], a[104:105], v[32:35]
v_mfma_f32_4x4x4_16b_bf16 v[36:39], v[44:45], a[106:107], v[36:39]
v_and_b32_dpp v42, v23, v2 row_newbcast:0 row_mask:0xf bank_mask:0xf
v_and_b32_dpp v43, v23, v3 row_newbcast:0 row_mask:0xf bank_mask:0xf
v_mfma_f32_4x4x4_16b_bf16 v[32:35], v[40:41], a[108:109], v[32:35]
v_mfma_f32_4x4x4_16b_bf16 v[36:39], v[40:41], a[110:111], v[36:39]
v_and_b32_dpp v44, v23, v2 row_newbcast:4 row_mask:0xf bank_mask:0xf
v_and_b32_dpp v45, v23, v3 row_newbcast:4 row_mask:0xf bank_mask:0xf
v_mfma_f32_4x4x4_16b_bf16 v[32:35], v[42:43], a[112:113], v[32:35]
v_mfma_f32_4x4x4_16b_bf16 v[36:39], v[42:43], a[114:115], v[36:39]
v_and_b32_dpp v40, v23, v2 row_newbcast:8 row_mask:0xf bank_mask:0xf
v_and_b32_dpp v41, v23, v3 row_newbcast:8 row_mask:0xf bank_mask:0xf
v_mfma_f32_4x4x4_16b_bf16 v[32:35], v[44:45], a[116:117], v[32:35]
v_mfma_f32_4x4x4_16b_bf16 v[36:39], v[44:45], a[118:119], v[36:39]
v_and_b32_dpp v42, v23, v2 row_newbcast:12 row_mask:0xf bank_mask:0xf
v_and_b32_dpp v43, v23, v3 row_newbcast:12 row_mask:0xf bank_mask:0xf
v_mfma_f32_4x4x4_16b_bf16 v[32:35], v[40:41], a[120:121], v[32:35]
v_mfma_f32_4x4x4_16b_bf16 v[36:39], v[40:41], a[122:123], v[36:39]
v_and_b32_dpp v44, v24, v2 row_newbcast:0 row_mask:0xf bank_mask:0xf
v_and_b32_dpp v45, v24, v3 row_newbcast:0 row_mask:0xf bank_mask:0xf
v_mfma_f32_4x4x4_16b_bf16 v[32:35], v[42:43], a[124:125], v[32:35]
v_mfma_f32_4x4x4_16b_bf16 v[36:39], v[42:43], a[126:127], v[36:39]
v_and_b32_dpp v40, v24, v2 row_newbcast:4 row_mask:0xf bank_mask:0xf
v_and_b32_dpp v41, v24, v3 row_newbcast:4 row_mask:0xf bank_mask:0xf
v_mfma_f32_4x4x4_16b_bf16 v[32:35], v[44:45], a[128:129], v[32:35]
v_mfma_f32_4x4x4_16b_bf16 v[36:39], v[44:45], a[130:131], v[36:39]
v_and_b32_dpp v42, v24, v2 row_newbcast:8 row_mask:0xf bank_mask:0xf
v_and_b32_dpp v43, v24, v3 row_newbcast:8 row_mask:0xf bank_mask:0xf
v_mfma_f32_4x4x4_16b_bf16 v[32:35], v[40:41], a[132:133], v[32:35]
v_mfma_f32_4x4x4_16b_bf16 v[36:39], v[40:41], a[134:135], v[36:39]
v_and_b32_dpp v44, v24, v2 row_newbcast:12 row_mask:0xf bank_mask:0xf
v_and_b32_dpp v45, v24, v3 row_newbcast:12 row_mask:0xf bank_mask:0xf
v_mfma_f32_4x4x4_16b_bf16 v[32:35], v[42:43], a[136:137], v[32:35]
v_mfma_f32_4x4x4_16b_bf16 v[36:39], v[42:43], a[138:139], v[36:39]
v_and_b32_dpp v40, v25, v2 row_newbcast:0 row_mask:0xf bank_mask:0xf
v_and_b32_dpp v41, v25, v3 row_newbcast:0 row_mask:0xf bank_mask:0xf
v_mfma_f32_4x4x4_16b_bf16 v[32:35], v[44:45], a[140:141], v[32:35]
v_mfma_f32_4x4x4_16b_bf16 v[36:39], v[44:45], a[142:143], v[36:39]
v_and_b32_dpp v42, v25, v2 row_newbcast:4 row_mask:0xf bank_mask:0xf
v_and_b32_dpp v43, v25, v3 row_newbcast:4 row_mask:0xf bank_mask:0xf
v_mfma_f32_4x4x4_16b_bf16 v[32:35], v[40:41], a[144:145], v[32:35]
v_mfma_f32_4x4x4_16b_bf16 v[36:39], v[40:41], a[146:147], v[36:39]
v_and_b32_dpp v44, v25, v2 row_newbcast:8 row_mask:0xf bank_mask:0xf
v_and_b32_dpp v45, v25, v3 row_newbcast:8 row_mask:0xf bank_mask:0xf
v_mfma_f32_4x4x4_16b_bf16 v[32:35], v[42:43], a[148:149], v[32:35]
v_mfma_f32_4x4x4_16b_bf16 v[36:39], v[42:43], a[150:151], v[36:39]
v_and_b32_dpp v40, v25, v2 row_newbcast:12 row_mask:0xf bank_mask:0xf
v_and_b32_dpp v41, v25, v3 row_newbcast:12 row_mask:0xf bank_mask:0xf
v_mfma_f32_4x4x4_16b_bf16 v[32:35], v[44:45], a[152:153], v[32:35]
v_mfma_f32_4x4x4_16b_bf16 v[36:39], v[44:45], a[154:155], v[36:39]
v_and_b32_dpp v42, v26, v2 row_newbcast:0 row_mask:0xf bank_mask:0xf
v_and_b32_dpp v43, v26, v3 row_newbcast:0 row_mask:0xf bank_mask:0xf
v_mfma_f32_4x4x4_16b_bf16 v[32:35], v[40:41], a[156:157], v[32:35]
v_mfma_f32_4x4x4_16b_bf16 v[36:39], v[40:41], a[158:159], v[36:39]
v_and_b32_dpp v44, v26, v2 row_newbcast:4 row_mask:0xf bank_mask:0xf
v_and_b32_dpp v45, v26, v3 row_newbcast:4 row_mask:0xf bank_mask:0xf
v_mfma_f32_4x4x4_16b_bf16 v[32:35], v[42:43], a[160:161], v[32:35]
v_mfma_f32_4x4x4_16b_bf16 v[36:39], v[42:43], a[162:163], v[36:39]
v_and_b32_dpp v40, v26, v2 row_newbcast:8 row_mask:0xf bank_mask:0xf
v_and_b32_dpp v41, v26, v3 row_newbcast:8 row_mask:0xf bank_mask:0xf
v_mfma_f32_4x4x4_16b_bf16 v[32:35], v[44:45], a[164:165], v[32:35]
v_mfma_f32_4x4x4_16b_bf16 v[36:39], v[44:45], a[166:167], v[36:39]
v_and_b32_dpp v42, v26, v2 row_newbcast:12 row_mask:0xf bank_mask:0xf
v_and_b32_dpp v43, v26, v3 row_newbcast:12 row_mask:0xf bank_mask:0xf
v_mfma_f32_4x4x4_16b_bf16 v[32:35], v[40:41], a[168:169], v[32:35]
v_mfma_f32_4x4x4_16b_bf16 v[36:39], v[40:41], a[170:171], v[36:39]
v_and_b32_dpp v44, v27, v2 row_newbcast:0 row_mask:0xf bank_mask:0xf
v_and_b32_dpp v45, v27, v3 row_newbcast:0 row_mask:0xf bank_mask:0xf
v_mfma_f32_4x4x4_16b_bf16 v[32:35], v[42:43], a[172:173], v[32:35]
v_mfma_f32_4x4x4_16b_bf16 v[36:39], v[42:43], a[174:175], v[36:39]
v_and_b32_dpp v40, v27, v2 row_newbcast:4 row_mask:0xf bank_mask:0xf
v_and_b32_dpp v41, v27, v3 row_newbcast:4 row_mask:0xf bank_mask:0xf
v_mfma_f32_4x4x4_16b_bf16 v[32:35], v[44:45], v[64:65], v[32:35]
v_mfma_f32_4x4x4_16b_bf16 v[36:39], v[44:45], v[66:67], v[36:39]
v_and_b32_dpp v42, v27, v2 row_newbcast:8 row_mask:0xf bank_mask:0xf
v_and_b32_dpp v43, v27, v3 row_newbcast:8 row_mask:0xf bank_mask:0xf
v_mfma_f32_4x4x4_16b_bf16 v[32:35], v[40:41], v[68:69], v[32:35]
v_mfma_f32_4x4x4_16b_bf16 v[36:39], v[40:41], v[70:71], v[36:39]
v_and_b32_dpp v44, v27, v2 row_newbcast:12 row_mask:0xf bank_mask:0xf
v_and_b32_dpp v45, v27, v3 row_newbcast:12 row_mask:0xf bank_mask:0xf
v_mfma_f32_4x4x4_16b_bf16 v[32:35], v[42:43], v[72:73], v[32:35]
v_mfma_f32_4x4x4_16b_bf16 v[36:39], v[42:43], v[74:75], v[36:39]
v_and_b32_dpp v40, v28, v2 row_newbcast:0 row_mask:0xf bank_mask:0xf
v_and_b32_dpp v41, v28, v3 row_newbcast:0 row_mask:0xf bank_mask:0xf
v_mfma_f32_4x4x4_16b_bf16 v[32:35], v[44:45], v[76:77], v[32:35]
v_mfma_f32_4x4x4_16b_bf16 v[36:39], v[44:45], v[78:79], v[36:39]
v_and_b32_dpp v42, v28, v2 row_newbcast:4 row_mask:0xf bank_mask:0xf
v_and_b32_dpp v43, v28, v3 row_newbcast:4 row_mask:0xf bank_mask:0xf
v_mfma_f32_4x4x4_16b_bf16 v[32:35], v[40:41], v[80:81], v[32:35]
v_mfma_f32_4x4x4_16b_bf16 v[36:39], v[40:41], v[82:83], v[36:39]
v_and_b32_dpp v44, v28, v2 row_newbcast:8 row_mask:0xf bank_mask:0xf
v_and_b32_dpp v45, v28, v3 row_newbcast:8 row_mask:0xf bank_mask:0xf
v_mfma_f32_4x4x4_16b_bf16 v[32:35], v[42:43], v[84:85], v[32:35]
v_mfma_f32_4x4x4_16b_bf16 v[36:39], v[42:43], v[86:87], v[36:39]
v_and_b32_dpp v40, v28, v2 row_newbcast:12 row_mask:0xf bank_mask:0xf
v_and_b32_dpp v41, v28, v3 row_newbcast:12 row_mask:0xf bank_mask:0xf
v_mfma_f32_4x4x4_16b_bf16 v[32:35], v[44:45], v[88:89], v[32:35]
v_mfma_f32_4x4x4_16b_bf16 v[36:39], v[44:45], v[90:91], v[36:39]
v_and_b32_dpp v42, v29, v2 row_newbcast:0 row_mask:0xf bank_mask:0xf
v_and_b32_dpp v43, v29, v3 row_newbcast:0 row_mask:0xf bank_mask:0xf
v_mfma_f32_4x4x4_16b_bf16 v[32:35], v[40:41], v[92:93], v[32:35]
v_mfma_f32_4x4x4_16b_bf16 v[36:39], v[40:41], v[94:95], v[36:39]
v_and_b32_dpp v44, v29, v2 row_newbcast:4 row_mask:0xf bank_mask:0xf
v_and_b32_dpp v45, v29, v3 row_newbcast:4 row_mask:0xf bank_mask:0xf
v_mfma_f32_4x4x4_16b_bf16 v[32:35], v[42:43], v[96:97], v[32:35]
v_mfma_f32_4x4x4_16b_bf16 v[36:39], v[42:43], v[98:99], v[36:39]
v_and_b32_dpp v40, v29, v2 row_newbcast:8 row_mask:0xf bank_mask:0xf
v_and_b32_dpp v41, v29, v3 row_newbcast:8 row_mask:0xf bank_mask:0xf
v_mfma_f32_4x4x4_16b_bf16 v[32:35], v[44:45], v[100:101], v[32:35]
v_mfma_f32_4x4x4_16b_bf16 v[36:39], v[44:45], v[102:103], v[36:39]
v_and_b32_dpp v42, v29, v2 row_newbcast:12 row_mask:0xf bank_mask:0xf
v_and_b32_dpp v43, v29, v3 row_newbcast:12 row_mask:0xf bank_mask:0xf
v_mfma_f32_4x4x4_16b_bf16 v[32:35], v[40:41], v[104:105], v[32:35]
v_mfma_f32_4x4x4_16b_bf16 v[36:39], v[40:41], v[106:107], v[36:39]
v_and_b32_dpp v44, v30, v2 row_newbcast:0 row_mask:0xf bank_mask:0xf
v_and_b32_dpp v45, v30, v3 row_newbcast:0 row_mask:0xf bank_mask:0xf
v_mfma_f32_4x4x4_16b_bf16 v[32:35], v[42:43], v[108:109], v[32:35]
v_mfma_f32_4x4x4_16b_bf16 v[36:39], v[42:43], v[110:111], v[36:39]
v_and_b32_dpp v40, v30, v2 row_newbcast:4 row_mask:0xf bank_mask:0xf
v_and_b32_dpp v41, v30, v3 row_newbcast:4 row_mask:0xf bank_mask:0xf
v_mfma_f32_4x4x4_16b_bf16 v[32:35], v[44:45], v[112:113], v[32:35]
v_mfma_f32_4x4x4_16b_bf16 v[36:39], v[44:45], v[114:115], v[36:39]
v_and_b32_dpp v42, v30, v2 row_newbcast:8 row_mask:0xf bank_mask:0xf
v_and_b32_dpp v43, v30, v3 row_newbcast:8 row_mask:0xf bank_mask:0xf
v_mfma_f32_4x4x4_16b_bf16 v[32:35], v[40:41], v[116:117], v[32:35]
v_mfma_f32_4x4x4_16b_bf16 v[36:39], v[40:41], v[118:119], v[36:39]
v_and_b32_dpp v44, v30, v2 row_newbcast:12 row_mask:0xf bank_mask:0xf
v_and_b32_dpp v45, v30, v3 row_newbcast:12 row_mask:0xf bank_mask:0xf
v_mfma_f32_4x4x4_16b_bf16 v[32:35], v[42:43], v[120:121], v[32:35]
v_mfma_f32_4x4x4_16b_bf16 v[36:39], v[42:43], v[122:123], v[36:39]
v_and_b32_dpp v40, v31, v2 row_newbcast:0 row_mask:0xf bank_mask:0xf
v_and_b32_dpp v41, v31, v3 row_newbcast:0 row_mask:0xf bank_mask:0xf
v_mfma_f32_4x4x4_16b_bf16 v[32:35], v[44:45], v[124:125], v[32:35]
v_mfma_f32_4x4x4_16b_bf16 v[36:39], v[44:45], v[126:127], v[36:39]
v_and_b32_dpp v42, v31, v2 row_newbcast:4 row_mask:0xf bank_mask:0xf
v_and_b32_dpp v43, v31, v3 row_newbcast:4 row_mask:0xf bank_mask:0xf
v_mfma_f32_4x4x4_16b_bf16 v[32:35], v[40:41], v[128:129], v[32:35]
v_mfma_f32_4x4x4_16b_bf16 v[36:39], v[40:41], v[130:131], v[36:39]
v_and_b32_dpp v44, v31, v2 row_newbcast:8 row_mask:0xf bank_mask:0xf
v_and_b32_dpp v45, v31, v3 row_newbcast:8 row_mask:0xf bank_mask:0xf
v_mfma_f32_4x4x4_16b_bf16 v[32:35], v[42:43], v[132:133], v[32:35]
v_mfma_f32_4x4x4_16b_bf16 v[36:39], v[42:43], v[134:135], v[36:39]
v_and_b32_dpp v40, v31, v2 row_newbcast:12 row_mask:0xf bank_mask:0xf
v_and_b32_dpp v41, v31, v3 row_newbcast:12 row_mask:0xf bank_mask:0xf
v_mfma_f32_4x4x4_16b_bf16 v[32:35], v[44:45], v[136:137], v[32:35]
v_mfma_f32_4x4x4_16b_bf16 v[36:39], v[44:45], v[138:139], v[36:39]
s_nop 1
v_mfma_f32_4x4x4_16b_bf16 v[32:35], v[40:41], v[140:141], v[32:35]
v_mfma_f32_4x4x4_16b_bf16 v[36:39], v[40:41], v[142:143], v[36:39]
s_branch L_pvdone
L_ring:
s_mul_i32 s45, s3, 20480
s_add_u32 s45, s45, 65536
s_mov_b32 s30, 0x4000000
s_add_u32 m0, s45, 0
s_nop 0
buffer_load_dwordx4 v1, s[4:7], s30 offen nt lds
s_add_u32 s30, s30, 4096
s_add_u32 m0, s45, 1024
s_nop 0
buffer_load_dwordx4 v1, s[4:7], s30 offen nt lds
s_add_u32 s30, s30, 4096
s_add_u32 m0, s45, 2048
s_nop 0
buffer_load_dwordx4 v1, s[4:7], s30 offen nt lds
s_add_u32 s30, s30, 4096
s_add_u32 m0, s45, 3072
s_nop 0
buffer_load_dwordx4 v1, s[4:7], s30 offen nt lds
s_add_u32 s30, s30, 4096
s_add_u32 m0, s45, 4096
s_nop 0
buffer_load_dwordx4 v1, s[4:7], s30 offen nt lds
s_add_u32 s30, s30, 4096
s_add_u32 m0, s45, 5120
s_nop 0
buffer_load_dwordx4 v1, s[4:7], s30 offen nt lds
s_add_u32 s30, s30, 4096
s_add_u32 m0, s45, 6144
s_nop 0
buffer_load_dwordx4 v1, s[4:7], s30 offen nt lds
s_add_u32 s30, s30, 4096
s_add_u32 m0, s45, 7168
s_nop 0
buffer_load_dwordx4 v1, s[4:7], s30 offen nt lds
s_add_u32 s30, s30, 4096
s_add_u32 m0, s45, 8192
s_nop 0
buffer_load_dwordx4 v1, s[4:7], s30 offen nt lds
s_add_u32 s30, s30, 4096
s_add_u32 m0, s45, 9216
s_nop 0
buffer_load_dwordx4 v1, s[4:7], s30 offen nt lds
s_add_u32 s30, s30, 4096
s_add_u32 m0, s45, 10240
s_nop 0
buffer_load_dwordx4 v1, s[4:7], s30 offen nt lds
s_add_u32 s30, s30, 4096
s_add_u32 m0, s45, 11264
s_nop 0
buffer_load_dwordx4 v1, s[4:7], s30 offen nt lds
s_add_u32 s30, s30, 4096
s_add_u32 m0, s45, 12288
s_nop 0
buffer_load_dwordx4 v1, s[4:7], s30 offen nt lds
s_add_u32 s30, s30, 4096
s_add_u32 m0, s45, 13312
s_nop 0
buffer_load_dwordx4 v1, s[4:7], s30 offen nt lds
s_add_u32 s30, s30, 4096
s_add_u32 m0, s45, 14336
s_nop 0
buffer_load_dwordx4 v1, s[4:7], s30 offen nt lds
s_add_u32 s30, s30, 4096
s_add_u32 m0, s45, 15360
s_nop 0
buffer_load_dwordx4 v1, s[4:7], s30 offen nt lds
s_add_u32 s30, s30, 4096
s_add_u32 m0, s45, 16384
s_nop 0
buffer_load_dwordx4 v1, s[4:7], s30 offen nt lds
s_add_u32 s30, s30, 4096
s_add_u32 m0, s45, 17408
s_nop 0
buffer_load_dwordx4 v1, s[4:7], s30 offen nt lds
s_add_u32 s30, s30, 4096
s_add_u32 m0, s45, 18432
s_nop 0
buffer_load_dwordx4 v1, s[4:7], s30 offen nt lds
s_add_u32 s30, s30, 4096
s_add_u32 m0, s45, 19456
s_nop 0
buffer_load_dwordx4 v1, s[4:7], s30 offen nt lds
s_add_u32 s30, s30, 4096
s_lshl_b32 s32, s3, 8
s_add_u32 s32, s32, 156672
v_and_b32 v58, 15, v0
v_lshlrev_b32 v58, 4, v58
v_add_u32 v58, s32, v58
ds_read_b128 v[4:7], v58
s_waitcnt lgkmcnt(0)
v_lshlrev_b32 v61, 4, v0
v_add_u32 v62, s54, v61
v_add_u32 v61, s45, v61
s_waitcnt vmcnt(16)
ds_read_b128 v[32:35], v61 offset:0
ds_read_b128 v[36:39], v61 offset:1024
ds_read_b128 v[40:43], v61 offset:2048
ds_read_b128 v[44:47], v61 offset:3072
s_waitcnt lgkmcnt(0)
s_add_u32 m0, s45, 0
s_nop 0
buffer_load_dwordx4 v1, s[4:7], s30 offen nt lds
s_add_u32 s30, s30, 4096
s_add_u32 m0, s45, 1024
s_nop 0
buffer_load_dwordx4 v1, s[4:7], s30 offen nt lds
s_add_u32 s30, s30, 4096
s_add_u32 m0, s45, 2048
s_nop 0
buffer_load_dwordx4 v1, s[4:7], s30 offen nt lds
s_add_u32 s30, s30, 4096
s_add_u32 m0, s45, 3072
s_nop 0
buffer_load_dwordx4 v1, s[4:7], s30 offen nt lds
s_add_u32 s30, s30, 4096
v_dot2_f32_bf16 v48, v32, v4, 0
v_dot2_f32_bf16 v49, v36, v4, 0
v_dot2_f32_bf16 v50, v40, v4, 0
v_dot2_f32_bf16 v51, v44, v4, 0
v_dot2c_f32_bf16 v48, v33, v5
v_dot2c_f32_bf16 v49, v37, v5
v_dot2c_f32_bf16 v50, v41, v5
v_dot2c_f32_bf16 v51, v45, v5
v_dot2c_f32_bf16 v48, v34, v6
v_dot2c_f32_bf16 v49, v38, v6
v_dot2c_f32_bf16 v50, v42, v6
v_dot2c_f32_bf16 v51, v46, v6
v_dot2c_f32_bf16 v48, v35, v7
v_dot2c_f32_bf16 v49, v39, v7
v_dot2c_f32_bf16 v50, v43, v7
v_dot2c_f32_bf16 v51, v47, v7
s_nop 2
s_waitcnt vmcnt(16)
ds_read_b128 v[32:35], v61 offset:4096
ds_read_b128 v[36:39], v61 offset:5120
ds_read_b128 v[40:43], v61 offset:6144
ds_read_b128 v[44:47], v61 offset:7168
v_add_f32_dpp v56, v48, v48 row_ror:8 row_mask:0xf bank_mask:0x3
v_add_f32_dpp v57, v49, v49 row_ror:8 row_mask:0xf bank_mask:0x3
s_nop 0
v_add_f32_dpp v56, v50, v50 row_ror:8 row_mask:0xf bank_mask:0xc
v_add_f32_dpp v57, v51, v51 row_ror:8 row_mask:0xf bank_mask:0xc
s_nop 1
v_add_f32_dpp v16, v56, v56 row_shl:4 row_mask:0xf bank_mask:0x5
s_nop 1
v_add_f32_dpp v16, v57, v57 row_shr:4 row_mask:0xf bank_mask:0xa
s_nop 1
v_add_f32_dpp v16, v16, v16 quad_perm:[1,0,3,2] row_mask:0xf bank_mask:0xf
s_nop 1
v_add_f32_dpp v16, v16, v16 quad_perm:[2,3,0,1] row_mask:0xf bank_mask:0xf
s_nop 1
s_waitcnt lgkmcnt(0)
s_add_u32 m0, s45, 4096
s_nop 0
buffer_load_dwordx4 v1, s[4:7], s30 offen nt lds
s_add_u32 s30, s30, 4096
s_add_u32 m0, s45, 5120
s_nop 0
buffer_load_dwordx4 v1, s[4:7], s30 offen nt lds
s_add_u32 s30, s30, 4096
s_add_u32 m0, s45, 6144
s_nop 0
buffer_load_dwordx4 v1, s[4:7], s30 offen nt lds
s_add_u32 s30, s30, 4096
s_add_u32 m0, s45, 7168
s_nop 0
buffer_load_dwordx4 v1, s[4:7], s30 offen nt lds
s_add_u32 s30, s30, 4096
v_dot2_f32_bf16 v52, v32, v4, 0
v_dot2_f32_bf16 v53, v36, v4, 0
v_dot2_f32_bf16 v54, v40, v4, 0
v_dot2_f32_bf16 v55, v44, v4, 0
v_dot2c_f32_bf16 v52, v33, v5
v_dot2c_f32_bf16 v53, v37, v5
v_dot2c_f32_bf16 v54, v41, v5
v_dot2c_f32_bf16 v55, v45, v5
v_dot2c_f32_bf16 v52, v34, v6
v_dot2c_f32_bf16 v53, v38, v6
v_dot2c_f32_bf16 v54, v42, v6
v_dot2c_f32_bf16 v55, v46, v6
v_dot2c_f32_bf16 v52, v35, v7
v_dot2c_f32_bf16 v53, v39, v7
v_dot2c_f32_bf16 v54, v43, v7
v_dot2c_f32_bf16 v55, v47, v7
s_nop 2
s_waitcnt vmcnt(16)
ds_read_b128 v[32:35], v61 offset:8192
ds_read_b128 v[36:39], v61 offset:9216
ds_read_b128 v[40:43], v61 offset:10240
ds_read_b128 v[44:47], v61 offset:11264
v_add_f32_dpp v56, v52, v52 row_ror:8 row_mask:0xf bank_mask:0x3
v_add_f32_dpp v57, v53, v53 row_ror:8 row_mask:0xf bank_mask:0x3
s_nop 0
v_add_f32_dpp v56, v54, v54 row_ror:8 row_mask:0xf bank_mask:0xc
v_add_f32_dpp v57, v55, v55 row_ror:8 row_mask:0xf bank_mask:0xc
s_nop 1
v_add_f32_dpp v17, v56, v56 row_shl:4 row_mask:0xf bank_mask:0x5
s_nop 1
v_add_f32_dpp v17, v57, v57 row_shr:4 row_mask:0xf bank_mask:0xa
s_nop 1
v_add_f32_dpp v17, v17, v17 quad_perm:[1,0,3,2] row_mask:0xf bank_mask:0xf
s_nop 1
v_add_f32_dpp v17, v17, v17 quad_perm:[2,3,0,1] row_mask:0xf bank_mask:0xf
s_nop 1
s_waitcnt lgkmcnt(0)
s_add_u32 m0, s45, 8192
s_nop 0
buffer_load_dwordx4 v1, s[4:7], s30 offen nt lds
s_add_u32 s30, s30, 4096
s_add_u32 m0, s45, 9216
s_nop 0
buffer_load_dwordx4 v1, s[4:7], s30 offen nt lds
s_add_u32 s30, s30, 4096
s_add_u32 m0, s45, 10240
s_nop 0
buffer_load_dwordx4 v1, s[4:7], s30 offen nt lds
s_add_u32 s30, s30, 4096
s_add_u32 m0, s45, 11264
s_nop 0
buffer_load_dwordx4 v1, s[4:7], s30 offen nt lds
s_add_u32 s30, s30, 4096
v_dot2_f32_bf16 v48, v32, v4, 0
v_dot2_f32_bf16 v49, v36, v4, 0
v_dot2_f32_bf16 v50, v40, v4, 0
v_dot2_f32_bf16 v51, v44, v4, 0
v_dot2c_f32_bf16 v48, v33, v5
v_dot2c_f32_bf16 v49, v37, v5
v_dot2c_f32_bf16 v50, v41, v5
v_dot2c_f32_bf16 v51, v45, v5
v_dot2c_f32_bf16 v48, v34, v6
v_dot2c_f32_bf16 v49, v38, v6
v_dot2c_f32_bf16 v50, v42, v6
v_dot2c_f32_bf16 v51, v46, v6
v_dot2c_f32_bf16 v48, v35, v7
v_dot2c_f32_bf16 v49, v39, v7
v_dot2c_f32_bf16 v50, v43, v7
v_dot2c_f32_bf16 v51, v47, v7
s_nop 2
s_waitcnt vmcnt(16)
ds_read_b128 v[32:35], v61 offset:12288
ds_read_b128 v[36:39], v61 offset:13312
ds_read_b128 v[40:43], v61 offset:14336
ds_read_b128 v[44:47], v61 offset:15360
v_add_f32_dpp v56, v48, v48 row_ror:8 row_mask:0xf bank_mask:0x3
v_add_f32_dpp v57, v49, v49 row_ror:8 row_mask:0xf bank_mask:0x3
s_nop 0
v_add_f32_dpp v56, v50, v50 row_ror:8 row_mask:0xf bank_mask:0xc
v_add_f32_dpp v57, v51, v51 row_ror:8 row_mask:0xf bank_mask:0xc
s_nop 1
v_add_f32_dpp v18, v56, v56 row_shl:4 row_mask:0xf bank_mask:0x5
s_nop 1
v_add_f32_dpp v18, v57, v57 row_shr:4 row_mask:0xf bank_mask:0xa
s_nop 1
v_add_f32_dpp v18, v18, v18 quad_perm:[1,0,3,2] row_mask:0xf bank_mask:0xf
s_nop 1
v_add_f32_dpp v18, v18, v18 quad_perm:[2,3,0,1] row_mask:0xf bank_mask:0xf
s_nop 1
s_waitcnt lgkmcnt(0)
s_add_u32 m0, s45, 12288
s_nop 0
buffer_load_dwordx4 v1, s[4:7], s30 offen nt lds
s_add_u32 s30, s30, 4096
s_add_u32 m0, s45, 13312
s_nop 0
buffer_load_dwordx4 v1, s[4:7], s30 offen nt lds
s_add_u32 s30, s30, 4096
s_add_u32 m0, s45, 14336
s_nop 0
buffer_load_dwordx4 v1, s[4:7], s30 offen nt lds
s_add_u32 s30, s30, 4096
s_add_u32 m0, s45, 15360
s_nop 0
buffer_load_dwordx4 v1, s[4:7], s30 offen nt lds
s_add_u32 s30, s30, 4096
v_dot2_f32_bf16 v52, v32, v4, 0
v_dot2_f32_bf16 v53, v36, v4, 0
v_dot2_f32_bf16 v54, v40, v4, 0
v_dot2_f32_bf16 v55, v44, v4, 0
v_dot2c_f32_bf16 v52, v33, v5
v_dot2c_f32_bf16 v53, v37, v5
v_dot2c_f32_bf16 v54, v41, v5
v_dot2c_f32_bf16 v55, v45, v5
v_dot2c_f32_bf16 v52, v34, v6
v_dot2c_f32_bf16 v53, v38, v6
v_dot2c_f32_bf16 v54, v42, v6
v_dot2c_f32_bf16 v55, v46, v6
v_dot2c_f32_bf16 v52, v35, v7
v_dot2c_f32_bf16 v53, v39, v7
v_dot2c_f32_bf16 v54, v43, v7
v_dot2c_f32_bf16 v55, v47, v7
s_nop 2
s_waitcnt vmcnt(16)
ds_read_b128 v[32:35], v61 offset:16384
ds_read_b128 v[36:39], v61 offset:17408
ds_read_b128 v[40:43], v61 offset:18432
ds_read_b128 v[44:47], v61 offset:19456
v_add_f32_dpp v56, v52, v52 row_ror:8 row_mask:0xf bank_mask:0x3
v_add_f32_dpp v57, v53, v53 row_ror:8 row_mask:0xf bank_mask:0x3
s_nop 0
v_add_f32_dpp v56, v54, v54 row_ror:8 row_mask:0xf bank_mask:0xc
v_add_f32_dpp v57, v55, v55 row_ror:8 row_mask:0xf bank_mask:0xc
s_nop 1
v_add_f32_dpp v19, v56, v56 row_shl:4 row_mask:0xf bank_mask:0x5
s_nop 1
v_add_f32_dpp v19, v57, v57 row_shr:4 row_mask:0xf bank_mask:0xa
s_nop 1
v_add_f32_dpp v19, v19, v19 quad_perm:[1,0,3,2] row_mask:0xf bank_mask:0xf
s_nop 1
v_add_f32_dpp v19, v19, v19 quad_perm:[2,3,0,1] row_mask:0xf bank_mask:0xf
s_nop 1
s_waitcnt lgkmcnt(0)
s_add_u32 m0, s45, 16384
s_nop 0
buffer_load_dwordx4 v1, s[4:7], s30 offen nt lds
s_add_u32 s30, s30, 4096
s_add_u32 m0, s45, 17408
s_nop 0
buffer_load_dwordx4 v1, s[4:7], s30 offen nt lds
s_add_u32 s30, s30, 4096
s_add_u32 m0, s45, 18432
s_nop 0
buffer_load_dwordx4 v1, s[4:7], s30 offen nt lds
s_add_u32 s30, s30, 4096
s_add_u32 m0, s45, 19456
s_nop 0
buffer_load_dwordx4 v1, s[4:7], s30 offen nt lds
s_add_u32 s30, s30, 4096
v_dot2_f32_bf16 v48, v32, v4, 0
v_dot2_f32_bf16 v49, v36, v4, 0
v_dot2_f32_bf16 v50, v40, v4, 0
v_dot2_f32_bf16 v51, v44, v4, 0
v_dot2c_f32_bf16 v48, v33, v5
v_dot2c_f32_bf16 v49, v37, v5
v_dot2c_f32_bf16 v50, v41, v5
v_dot2c_f32_bf16 v51, v45, v5
v_dot2c_f32_bf16 v48, v34, v6
v_dot2c_f32_bf16 v49, v38, v6
v_dot2c_f32_bf16 v50, v42, v6
v_dot2c_f32_bf16 v51, v46, v6
v_dot2c_f32_bf16 v48, v35, v7
v_dot2c_f32_bf16 v49, v39, v7
v_dot2c_f32_bf16 v50, v43, v7
v_dot2c_f32_bf16 v51, v47, v7
s_nop 2
s_waitcnt vmcnt(16)
ds_read_b128 v[32:35], v61 offset:0
ds_read_b128 v[36:39], v61 offset:1024
ds_read_b128 v[40:43], v61 offset:2048
ds_read_b128 v[44:47], v61 offset:3072
v_add_f32_dpp v56, v48, v48 row_ror:8 row_mask:0xf bank_mask:0x3
v_add_f32_dpp v57, v49, v49 row_ror:8 row_mask:0xf bank_mask:0x3
s_nop 0
v_add_f32_dpp v56, v50, v50 row_ror:8 row_mask:0xf bank_mask:0xc
v_add_f32_dpp v57, v51, v51 row_ror:8 row_mask:0xf bank_mask:0xc
s_nop 1
v_add_f32_dpp v20, v56, v56 row_shl:4 row_mask:0xf bank_mask:0x5
s_nop 1
v_add_f32_dpp v20, v57, v57 row_shr:4 row_mask:0xf bank_mask:0xa
s_nop 1
v_add_f32_dpp v20, v20, v20 quad_perm:[1,0,3,2] row_mask:0xf bank_mask:0xf
s_nop 1
v_add_f32_dpp v20, v20, v20 quad_perm:[2,3,0,1] row_mask:0xf bank_mask:0xf
s_nop 1
s_waitcnt lgkmcnt(0)
s_add_u32 m0, s45, 0
s_nop 0
buffer_load_dwordx4 v1, s[4:7], s30 offen nt lds
s_add_u32 s30, s30, 4096
s_add_u32 m0, s45, 1024
s_nop 0
buffer_load_dwordx4 v1, s[4:7], s30 offen nt lds
s_add_u32 s30, s30, 4096
s_add_u32 m0, s45, 2048
s_nop 0
buffer_load_dwordx4 v1, s[4:7], s30 offen nt lds
s_add_u32 s30, s30, 4096
s_add_u32 m0, s45, 3072
s_nop 0
buffer_load_dwordx4 v1, s[4:7], s30 offen nt lds
s_add_u32 s30, s30, 4096
v_dot2_f32_bf16 v52, v32, v4, 0
v_dot2_f32_bf16 v53, v36, v4, 0
v_dot2_f32_bf16 v54, v40, v4, 0
v_dot2_f32_bf16 v55, v44, v4, 0
v_dot2c_f32_bf16 v52, v33, v5
v_dot2c_f32_bf16 v53, v37, v5
v_dot2c_f32_bf16 v54, v41, v5
v_dot2c_f32_bf16 v55, v45, v5
v_dot2c_f32_bf16 v52, v34, v6
v_dot2c_f32_bf16 v53, v38, v6
v_dot2c_f32_bf16 v54, v42, v6
v_dot2c_f32_bf16 v55, v46, v6
v_dot2c_f32_bf16 v52, v35, v7
v_dot2c_f32_bf16 v53, v39, v7
v_dot2c_f32_bf16 v54, v43, v7
v_dot2c_f32_bf16 v55, v47, v7
s_nop 2
s_waitcnt vmcnt(16)
ds_read_b128 v[32:35], v61 offset:4096
ds_read_b128 v[36:39], v61 offset:5120
ds_read_b128 v[40:43], v61 offset:6144
ds_read_b128 v[44:47], v61 offset:7168
v_add_f32_dpp v56, v52, v52 row_ror:8 row_mask:0xf bank_mask:0x3
v_add_f32_dpp v57, v53, v53 row_ror:8 row_mask:0xf bank_mask:0x3
s_nop 0
v_add_f32_dpp v56, v54, v54 row_ror:8 row_mask:0xf bank_mask:0xc
v_add_f32_dpp v57, v55, v55 row_ror:8 row_mask:0xf bank_mask:0xc
s_nop 1
v_add_f32_dpp v21, v56, v56 row_shl:4 row_mask:0xf bank_mask:0x5
s_nop 1
v_add_f32_dpp v21, v57, v57 row_shr:4 row_mask:0xf bank_mask:0xa
s_nop 1
v_add_f32_dpp v21, v21, v21 quad_perm:[1,0,3,2] row_mask:0xf bank_mask:0xf
s_nop 1
v_add_f32_dpp v21, v21, v21 quad_perm:[2,3,0,1] row_mask:0xf bank_mask:0xf
s_nop 1
s_waitcnt lgkmcnt(0)
s_add_u32 m0, s45, 4096
s_nop 0
buffer_load_dwordx4 v1, s[4:7], s30 offen nt lds
s_add_u32 s30, s30, 4096
s_add_u32 m0, s45, 5120
s_nop 0
buffer_load_dwordx4 v1, s[4:7], s30 offen nt lds
s_add_u32 s30, s30, 4096
s_add_u32 m0, s45, 6144
s_nop 0
buffer_load_dwordx4 v1, s[4:7], s30 offen nt lds
s_add_u32 s30, s30, 4096
s_add_u32 m0, s45, 7168
s_nop 0
buffer_load_dwordx4 v1, s[4:7], s30 offen nt lds
s_add_u32 s30, s30, 4096
v_dot2_f32_bf16 v48, v32, v4, 0
v_dot2_f32_bf16 v49, v36, v4, 0
v_dot2_f32_bf16 v50, v40, v4, 0
v_dot2_f32_bf16 v51, v44, v4, 0
v_dot2c_f32_bf16 v48, v33, v5
v_dot2c_f32_bf16 v49, v37, v5
v_dot2c_f32_bf16 v50, v41, v5
v_dot2c_f32_bf16 v51, v45, v5
v_dot2c_f32_bf16 v48, v34, v6
v_dot2c_f32_bf16 v49, v38, v6
v_dot2c_f32_bf16 v50, v42, v6
v_dot2c_f32_bf16 v51, v46, v6
v_dot2c_f32_bf16 v48, v35, v7
v_dot2c_f32_bf16 v49, v39, v7
v_dot2c_f32_bf16 v50, v43, v7
v_dot2c_f32_bf16 v51, v47, v7
s_nop 2
s_waitcnt vmcnt(16)
ds_read_b128 v[32:35], v61 offset:8192
ds_read_b128 v[36:39], v61 offset:9216
ds_read_b128 v[40:43], v61 offset:10240
ds_read_b128 v[44:47], v61 offset:11264
v_add_f32_dpp v56, v48, v48 row_ror:8 row_mask:0xf bank_mask:0x3
v_add_f32_dpp v57, v49, v49 row_ror:8 row_mask:0xf bank_mask:0x3
s_nop 0
v_add_f32_dpp v56, v50, v50 row_ror:8 row_mask:0xf bank_mask:0xc
v_add_f32_dpp v57, v51, v51 row_ror:8 row_mask:0xf bank_mask:0xc
s_nop 1
v_add_f32_dpp v22, v56, v56 row_shl:4 row_mask:0xf bank_mask:0x5
s_nop 1
v_add_f32_dpp v22, v57, v57 row_shr:4 row_mask:0xf bank_mask:0xa
s_nop 1
v_add_f32_dpp v22, v22, v22 quad_perm:[1,0,3,2] row_mask:0xf bank_mask:0xf
s_nop 1
v_add_f32_dpp v22, v22, v22 quad_perm:[2,3,0,1] row_mask:0xf bank_mask:0xf
s_nop 1
s_waitcnt lgkmcnt(0)
s_add_u32 m0, s45, 8192
s_nop 0
buffer_load_dwordx4 v1, s[4:7], s30 offen nt lds
s_add_u32 s30, s30, 4096
s_add_u32 m0, s45, 9216
s_nop 0
buffer_load_dwordx4 v1, s[4:7], s30 offen nt lds
s_add_u32 s30, s30, 4096
s_add_u32 m0, s45, 10240
s_nop 0
buffer_load_dwordx4 v1, s[4:7], s30 offen nt lds
s_add_u32 s30, s30, 4096
s_add_u32 m0, s45, 11264
s_nop 0
buffer_load_dwordx4 v1, s[4:7], s30 offen nt lds
s_add_u32 s30, s30, 4096
v_dot2_f32_bf16 v52, v32, v4, 0
v_dot2_f32_bf16 v53, v36, v4, 0
v_dot2_f32_bf16 v54, v40, v4, 0
v_dot2_f32_bf16 v55, v44, v4, 0
v_dot2c_f32_bf16 v52, v33, v5
v_dot2c_f32_bf16 v53, v37, v5
v_dot2c_f32_bf16 v54, v41, v5
v_dot2c_f32_bf16 v55, v45, v5
v_dot2c_f32_bf16 v52, v34, v6
v_dot2c_f32_bf16 v53, v38, v6
v_dot2c_f32_bf16 v54, v42, v6
v_dot2c_f32_bf16 v55, v46, v6
v_dot2c_f32_bf16 v52, v35, v7
v_dot2c_f32_bf16 v53, v39, v7
v_dot2c_f32_bf16 v54, v43, v7
v_dot2c_f32_bf16 v55, v47, v7
s_nop 2
s_waitcnt vmcnt(16)
ds_read_b128 v[32:35], v61 offset:12288
ds_read_b128 v[36:39], v61 offset:13312
ds_read_b128 v[40:43], v61 offset:14336
ds_read_b128 v[44:47], v61 offset:15360
v_add_f32_dpp v56, v52, v52 row_ror:8 row_mask:0xf bank_mask:0x3
v_add_f32_dpp v57, v53, v53 row_ror:8 row_mask:0xf bank_mask:0x3
s_nop 0
v_add_f32_dpp v56, v54, v54 row_ror:8 row_mask:0xf bank_mask:0xc
v_add_f32_dpp v57, v55, v55 row_ror:8 row_mask:0xf bank_mask:0xc
s_nop 1
v_add_f32_dpp v23, v56, v56 row_shl:4 row_mask:0xf bank_mask:0x5
s_nop 1
v_add_f32_dpp v23, v57, v57 row_shr:4 row_mask:0xf bank_mask:0xa
s_nop 1
v_add_f32_dpp v23, v23, v23 quad_perm:[1,0,3,2] row_mask:0xf bank_mask:0xf
s_nop 1
v_add_f32_dpp v23, v23, v23 quad_perm:[2,3,0,1] row_mask:0xf bank_mask:0xf
s_nop 1
s_waitcnt lgkmcnt(0)
s_add_u32 m0, s45, 12288
s_nop 0
buffer_load_dwordx4 v1, s[4:7], s30 offen nt lds
s_add_u32 s30, s30, 4096
s_add_u32 m0, s45, 13312
s_nop 0
buffer_load_dwordx4 v1, s[4:7], s30 offen nt lds
s_add_u32 s30, s30, 4096
s_add_u32 m0, s45, 14336
s_nop 0
buffer_load_dwordx4 v1, s[4:7], s30 offen nt lds
s_add_u32 s30, s30, 4096
s_add_u32 m0, s45, 15360
s_nop 0
buffer_load_dwordx4 v1, s[4:7], s30 offen nt lds
s_add_u32 s30, s30, 4096
v_dot2_f32_bf16 v48, v32, v4, 0
v_dot2_f32_bf16 v49, v36, v4, 0
v_dot2_f32_bf16 v50, v40, v4, 0
v_dot2_f32_bf16 v51, v44, v4, 0
v_dot2c_f32_bf16 v48, v33, v5
v_dot2c_f32_bf16 v49, v37, v5
v_dot2c_f32_bf16 v50, v41, v5
v_dot2c_f32_bf16 v51, v45, v5
v_dot2c_f32_bf16 v48, v34, v6
v_dot2c_f32_bf16 v49, v38, v6
v_dot2c_f32_bf16 v50, v42, v6
v_dot2c_f32_bf16 v51, v46, v6
v_dot2c_f32_bf16 v48, v35, v7
v_dot2c_f32_bf16 v49, v39, v7
v_dot2c_f32_bf16 v50, v43, v7
v_dot2c_f32_bf16 v51, v47, v7
s_nop 2
s_waitcnt vmcnt(16)
ds_read_b128 v[32:35], v61 offset:16384
ds_read_b128 v[36:39], v61 offset:17408
ds_read_b128 v[40:43], v61 offset:18432
ds_read_b128 v[44:47], v61 offset:19456
v_add_f32_dpp v56, v48, v48 row_ror:8 row_mask:0xf bank_mask:0x3
v_add_f32_dpp v57, v49, v49 row_ror:8 row_mask:0xf bank_mask:0x3
s_nop 0
v_add_f32_dpp v56, v50, v50 row_ror:8 row_mask:0xf bank_mask:0xc
v_add_f32_dpp v57, v51, v51 row_ror:8 row_mask:0xf bank_mask:0xc
s_nop 1
v_add_f32_dpp v24, v56, v56 row_shl:4 row_mask:0xf bank_mask:0x5
s_nop 1
v_add_f32_dpp v24, v57, v57 row_shr:4 row_mask:0xf bank_mask:0xa
s_nop 1
v_add_f32_dpp v24, v24, v24 quad_perm:[1,0,3,2] row_mask:0xf bank_mask:0xf
s_nop 1
v_add_f32_dpp v24, v24, v24 quad_perm:[2,3,0,1] row_mask:0xf bank_mask:0xf
s_nop 1
s_waitcnt lgkmcnt(0)
s_add_u32 m0, s45, 16384
s_nop 0
buffer_load_dwordx4 v1, s[4:7], s30 offen nt lds
s_add_u32 s30, s30, 4096
s_add_u32 m0, s45, 17408
s_nop 0
buffer_load_dwordx4 v1, s[4:7], s30 offen nt lds
s_add_u32 s30, s30, 4096
s_add_u32 m0, s45, 18432
s_nop 0
buffer_load_dwordx4 v1, s[4:7], s30 offen nt lds
s_add_u32 s30, s30, 4096
s_add_u32 m0, s45, 19456
s_nop 0
buffer_load_dwordx4 v1, s[4:7], s30 offen nt lds
s_add_u32 s30, s30, 4096
v_dot2_f32_bf16 v52, v32, v4, 0
v_dot2_f32_bf16 v53, v36, v4, 0
v_dot2_f32_bf16 v54, v40, v4, 0
v_dot2_f32_bf16 v55, v44, v4, 0
v_dot2c_f32_bf16 v52, v33, v5
v_dot2c_f32_bf16 v53, v37, v5
v_dot2c_f32_bf16 v54, v41, v5
v_dot2c_f32_bf16 v55, v45, v5
v_dot2c_f32_bf16 v52, v34, v6
v_dot2c_f32_bf16 v53, v38, v6
v_dot2c_f32_bf16 v54, v42, v6
v_dot2c_f32_bf16 v55, v46, v6
v_dot2c_f32_bf16 v52, v35, v7
v_dot2c_f32_bf16 v53, v39, v7
v_dot2c_f32_bf16 v54, v43, v7
v_dot2c_f32_bf16 v55, v47, v7
s_nop 2
s_waitcnt vmcnt(16)
ds_read_b128 v[32:35], v61 offset:0
ds_read_b128 v[36:39], v61 offset:1024
ds_read_b128 v[40:43], v61 offset:2048
ds_read_b128 v[44:47], v61 offset:3072
v_add_f32_dpp v56, v52, v52 row_ror:8 row_mask:0xf bank_mask:0x3
v_add_f32_dpp v57, v53, v53 row_ror:8 row_mask:0xf bank_mask:0x3
s_nop 0
v_add_f32_dpp v56, v54, v54 row_ror:8 row_mask:0xf bank_mask:0xc
v_add_f32_dpp v57, v55, v55 row_ror:8 row_mask:0xf bank_mask:0xc
s_nop 1
v_add_f32_dpp v25, v56, v56 row_shl:4 row_mask:0xf bank_mask:0x5
s_nop 1
v_add_f32_dpp v25, v57, v57 row_shr:4 row_mask:0xf bank_mask:0xa
s_nop 1
v_add_f32_dpp v25, v25, v25 quad_perm:[1,0,3,2] row_mask:0xf bank_mask:0xf
s_nop 1
v_add_f32_dpp v25, v25, v25 quad_perm:[2,3,0,1] row_mask:0xf bank_mask:0xf
s_nop 1
s_waitcnt lgkmcnt(0)
s_add_u32 m0, s45, 0
s_nop 0
buffer_load_dwordx4 v1, s[4:7], s30 offen nt lds
s_add_u32 s30, s30, 4096
s_add_u32 m0, s45, 1024
s_nop 0
buffer_load_dwordx4 v1, s[4:7], s30 offen nt lds
s_add_u32 s30, s30, 4096
s_add_u32 m0, s45, 2048
s_nop 0
buffer_load_dwordx4 v1, s[4:7], s30 offen nt lds
s_add_u32 s30, s30, 4096
s_add_u32 m0, s45, 3072
s_nop 0
buffer_load_dwordx4 v1, s[4:7], s30 offen nt lds
s_add_u32 s30, s30, 4096
v_dot2_f32_bf16 v48, v32, v4, 0
v_dot2_f32_bf16 v49, v36, v4, 0
v_dot2_f32_bf16 v50, v40, v4, 0
v_dot2_f32_bf16 v51, v44, v4, 0
v_dot2c_f32_bf16 v48, v33, v5
v_dot2c_f32_bf16 v49, v37, v5
v_dot2c_f32_bf16 v50, v41, v5
v_dot2c_f32_bf16 v51, v45, v5
v_dot2c_f32_bf16 v48, v34, v6
v_dot2c_f32_bf16 v49, v38, v6
v_dot2c_f32_bf16 v50, v42, v6
v_dot2c_f32_bf16 v51, v46, v6
v_dot2c_f32_bf16 v48, v35, v7
v_dot2c_f32_bf16 v49, v39, v7
v_dot2c_f32_bf16 v50, v43, v7
v_dot2c_f32_bf16 v51, v47, v7
s_nop 2
s_waitcnt vmcnt(16)
ds_read_b128 v[32:35], v61 offset:4096
ds_read_b128 v[36:39], v61 offset:5120
ds_read_b128 v[40:43], v61 offset:6144
ds_read_b128 v[44:47], v61 offset:7168
v_add_f32_dpp v56, v48, v48 row_ror:8 row_mask:0xf bank_mask:0x3
v_add_f32_dpp v57, v49, v49 row_ror:8 row_mask:0xf bank_mask:0x3
s_nop 0
v_add_f32_dpp v56, v50, v50 row_ror:8 row_mask:0xf bank_mask:0xc
v_add_f32_dpp v57, v51, v51 row_ror:8 row_mask:0xf bank_mask:0xc
s_nop 1
v_add_f32_dpp v26, v56, v56 row_shl:4 row_mask:0xf bank_mask:0x5
s_nop 1
v_add_f32_dpp v26, v57, v57 row_shr:4 row_mask:0xf bank_mask:0xa
s_nop 1
v_add_f32_dpp v26, v26, v26 quad_perm:[1,0,3,2] row_mask:0xf bank_mask:0xf
s_nop 1
v_add_f32_dpp v26, v26, v26 quad_perm:[2,3,0,1] row_mask:0xf bank_mask:0xf
s_nop 1
s_waitcnt lgkmcnt(0)
s_mov_b32 s30, 0x4000000
s_add_u32 m0, s45, 4096
s_nop 0
buffer_load_dwordx4 v1, s[8:11], s30 offen nt lds
s_add_u32 s30, s30, 4096
s_add_u32 m0, s45, 5120
s_nop 0
buffer_load_dwordx4 v1, s[8:11], s30 offen nt lds
s_add_u32 s30, s30, 4096
s_add_u32 m0, s45, 6144
s_nop 0
buffer_load_dwordx4 v1, s[8:11], s30 offen nt lds
s_add_u32 s30, s30, 4096
s_add_u32 m0, s45, 7168
s_nop 0
buffer_load_dwordx4 v1, s[8:11], s30 offen nt lds
s_add_u32 s30, s30, 4096
v_dot2_f32_bf16 v52, v32, v4, 0
v_dot2_f32_bf16 v53, v36, v4, 0
v_dot2_f32_bf16 v54, v40, v4, 0
v_dot2_f32_bf16 v55, v44, v4, 0
v_dot2c_f32_bf16 v52, v33, v5
v_dot2c_f32_bf16 v53, v37, v5
v_dot2c_f32_bf16 v54, v41, v5
v_dot2c_f32_bf16 v55, v45, v5
v_dot2c_f32_bf16 v52, v34, v6
v_dot2c_f32_bf16 v53, v38, v6
v_dot2c_f32_bf16 v54, v42, v6
v_dot2c_f32_bf16 v55, v46, v6
v_dot2c_f32_bf16 v52, v35, v7
v_dot2c_f32_bf16 v53, v39, v7
v_dot2c_f32_bf16 v54, v43, v7
v_dot2c_f32_bf16 v55, v47, v7
s_nop 2
s_waitcnt vmcnt(16)
ds_read_b128 v[32:35], v61 offset:8192
ds_read_b128 v[36:39], v61 offset:9216
ds_read_b128 v[40:43], v61 offset:10240
ds_read_b128 v[44:47], v61 offset:11264
v_add_f32_dpp v56, v52, v52 row_ror:8 row_mask:0xf bank_mask:0x3
v_add_f32_dpp v57, v53, v53 row_ror:8 row_mask:0xf bank_mask:0x3
s_nop 0
v_add_f32_dpp v56, v54, v54 row_ror:8 row_mask:0xf bank_mask:0xc
v_add_f32_dpp v57, v55, v55 row_ror:8 row_mask:0xf bank_mask:0xc
s_nop 1
v_add_f32_dpp v27, v56, v56 row_shl:4 row_mask:0xf bank_mask:0x5
s_nop 1
v_add_f32_dpp v27, v57, v57 row_shr:4 row_mask:0xf bank_mask:0xa
s_nop 1
v_add_f32_dpp v27, v27, v27 quad_perm:[1,0,3,2] row_mask:0xf bank_mask:0xf
s_nop 1
v_add_f32_dpp v27, v27, v27 quad_perm:[2,3,0,1] row_mask:0xf bank_mask:0xf
s_nop 1
s_waitcnt lgkmcnt(0)
s_add_u32 m0, s45, 8192
s_nop 0
buffer_load_dwordx4 v1, s[8:11], s30 offen nt lds
s_add_u32 s30, s30, 4096
s_add_u32 m0, s45, 9216
s_nop 0
buffer_load_dwordx4 v1, s[8:11], s30 offen nt lds
s_add_u32 s30, s30, 4096
s_add_u32 m0, s45, 10240
s_nop 0
buffer_load_dwordx4 v1, s[8:11], s30 offen nt lds
s_add_u32 s30, s30, 4096
s_add_u32 m0, s45, 11264
s_nop 0
buffer_load_dwordx4 v1, s[8:11], s30 offen nt lds
s_add_u32 s30, s30, 4096
v_dot2_f32_bf16 v48, v32, v4, 0
v_dot2_f32_bf16 v49, v36, v4, 0
v_dot2_f32_bf16 v50, v40, v4, 0
v_dot2_f32_bf16 v51, v44, v4, 0
v_dot2c_f32_bf16 v48, v33, v5
v_dot2c_f32_bf16 v49, v37, v5
v_dot2c_f32_bf16 v50, v41, v5
v_dot2c_f32_bf16 v51, v45, v5
v_dot2c_f32_bf16 v48, v34, v6
v_dot2c_f32_bf16 v49, v38, v6
v_dot2c_f32_bf16 v50, v42, v6
v_dot2c_f32_bf16 v51, v46, v6
v_dot2c_f32_bf16 v48, v35, v7
v_dot2c_f32_bf16 v49, v39, v7
v_dot2c_f32_bf16 v50, v43, v7
v_dot2c_f32_bf16 v51, v47, v7
s_nop 2
s_waitcnt vmcnt(16)
ds_read_b128 v[32:35], v61 offset:12288
ds_read_b128 v[36:39], v61 offset:13312
ds_read_b128 v[40:43], v61 offset:14336
ds_read_b128 v[44:47], v61 offset:15360
v_add_f32_dpp v56, v48, v48 row_ror:8 row_mask:0xf bank_mask:0x3
v_add_f32_dpp v57, v49, v49 row_ror:8 row_mask:0xf bank_mask:0x3
s_nop 0
v_add_f32_dpp v56, v50, v50 row_ror:8 row_mask:0xf bank_mask:0xc
v_add_f32_dpp v57, v51, v51 row_ror:8 row_mask:0xf bank_mask:0xc
s_nop 1
v_add_f32_dpp v28, v56, v56 row_shl:4 row_mask:0xf bank_mask:0x5
s_nop 1
v_add_f32_dpp v28, v57, v57 row_shr:4 row_mask:0xf bank_mask:0xa
s_nop 1
v_add_f32_dpp v28, v28, v28 quad_perm:[1,0,3,2] row_mask:0xf bank_mask:0xf
s_nop 1
v_add_f32_dpp v28, v28, v28 quad_perm:[2,3,0,1] row_mask:0xf bank_mask:0xf
s_nop 1
s_waitcnt lgkmcnt(0)
s_add_u32 m0, s45, 12288
s_nop 0
buffer_load_dwordx4 v1, s[8:11], s30 offen nt lds
s_add_u32 s30, s30, 4096
s_add_u32 m0, s45, 13312
s_nop 0
buffer_load_dwordx4 v1, s[8:11], s30 offen nt lds
s_add_u32 s30, s30, 4096
s_add_u32 m0, s45, 14336
s_nop 0
buffer_load_dwordx4 v1, s[8:11], s30 offen nt lds
s_add_u32 s30, s30, 4096
s_add_u32 m0, s45, 15360
s_nop 0
buffer_load_dwordx4 v1, s[8:11], s30 offen nt lds
s_add_u32 s30, s30, 4096
v_dot2_f32_bf16 v52, v32, v4, 0
v_dot2_f32_bf16 v53, v36, v4, 0
v_dot2_f32_bf16 v54, v40, v4, 0
v_dot2_f32_bf16 v55, v44, v4, 0
v_dot2c_f32_bf16 v52, v33, v5
v_dot2c_f32_bf16 v53, v37, v5
v_dot2c_f32_bf16 v54, v41, v5
v_dot2c_f32_bf16 v55, v45, v5
v_dot2c_f32_bf16 v52, v34, v6
v_dot2c_f32_bf16 v53, v38, v6
v_dot2c_f32_bf16 v54, v42, v6
v_dot2c_f32_bf16 v55, v46, v6
v_dot2c_f32_bf16 v52, v35, v7
v_dot2c_f32_bf16 v53, v39, v7
v_dot2c_f32_bf16 v54, v43, v7
v_dot2c_f32_bf16 v55, v47, v7
s_nop 2
s_waitcnt vmcnt(16)
ds_read_b128 v[32:35], v61 offset:16384
ds_read_b128 v[36:39], v61 offset:17408
ds_read_b128 v[40:43], v61 offset:18432
ds_read_b128 v[44:47], v61 offset:19456
v_add_f32_dpp v56, v52, v52 row_ror:8 row_mask:0xf bank_mask:0x3
v_add_f32_dpp v57, v53, v53 row_ror:8 row_mask:0xf bank_mask:0x3
s_nop 0
v_add_f32_dpp v56, v54, v54 row_ror:8 row_mask:0xf bank_mask:0xc
v_add_f32_dpp v57, v55, v55 row_ror:8 row_mask:0xf bank_mask:0xc
s_nop 1
v_add_f32_dpp v29, v56, v56 row_shl:4 row_mask:0xf bank_mask:0x5
s_nop 1
v_add_f32_dpp v29, v57, v57 row_shr:4 row_mask:0xf bank_mask:0xa
s_nop 1
v_add_f32_dpp v29, v29, v29 quad_perm:[1,0,3,2] row_mask:0xf bank_mask:0xf
s_nop 1
v_add_f32_dpp v29, v29, v29 quad_perm:[2,3,0,1] row_mask:0xf bank_mask:0xf
s_nop 1
s_waitcnt lgkmcnt(0)
s_add_u32 m0, s45, 16384
s_nop 0
buffer_load_dwordx4 v1, s[8:11], s30 offen nt lds
s_add_u32 s30, s30, 4096
s_add_u32 m0, s45, 17408
s_nop 0
buffer_load_dwordx4 v1, s[8:11], s30 offen nt lds
s_add_u32 s30, s30, 4096
s_add_u32 m0, s45, 18432
s_nop 0
buffer_load_dwordx4 v1, s[8:11], s30 offen nt lds
s_add_u32 s30, s30, 4096
s_add_u32 m0, s45, 19456
s_nop 0
buffer_load_dwordx4 v1, s[8:11], s30 offen nt lds
s_add_u32 s30, s30, 4096
v_dot2_f32_bf16 v48, v32, v4, 0
v_dot2_f32_bf16 v49, v36, v4, 0
v_dot2_f32_bf16 v50, v40, v4, 0
v_dot2_f32_bf16 v51, v44, v4, 0
v_dot2c_f32_bf16 v48, v33, v5
v_dot2c_f32_bf16 v49, v37, v5
v_dot2c_f32_bf16 v50, v41, v5
v_dot2c_f32_bf16 v51, v45, v5
v_dot2c_f32_bf16 v48, v34, v6
v_dot2c_f32_bf16 v49, v38, v6
v_dot2c_f32_bf16 v50, v42, v6
v_dot2c_f32_bf16 v51, v46, v6
v_dot2c_f32_bf16 v48, v35, v7
v_dot2c_f32_bf16 v49, v39, v7
v_dot2c_f32_bf16 v50, v43, v7
v_dot2c_f32_bf16 v51, v47, v7
s_nop 2
s_waitcnt vmcnt(16)
ds_read_b128 v[32:35], v61 offset:0
ds_read_b128 v[36:39], v61 offset:1024
ds_read_b128 v[40:43], v61 offset:2048
ds_read_b128 v[44:47], v61 offset:3072
v_add_f32_dpp v56, v48, v48 row_ror:8 row_mask:0xf bank_mask:0x3
v_add_f32_dpp v57, v49, v49 row_ror:8 row_mask:0xf bank_mask:0x3
s_nop 0
v_add_f32_dpp v56, v50, v50 row_ror:8 row_mask:0xf bank_mask:0xc
v_add_f32_dpp v57, v51, v51 row_ror:8 row_mask:0xf bank_mask:0xc
s_nop 1
v_add_f32_dpp v30, v56, v56 row_shl:4 row_mask:0xf bank_mask:0x5
s_nop 1
v_add_f32_dpp v30, v57, v57 row_shr:4 row_mask:0xf bank_mask:0xa
s_nop 1
v_add_f32_dpp v30, v30, v30 quad_perm:[1,0,3,2] row_mask:0xf bank_mask:0xf
s_nop 1
v_add_f32_dpp v30, v30, v30 quad_perm:[2,3,0,1] row_mask:0xf bank_mask:0xf
s_nop 1
s_waitcnt lgkmcnt(0)
s_add_u32 m0, s45, 0
s_nop 0
buffer_load_dwordx4 v1, s[8:11], s30 offen nt lds
s_add_u32 s30, s30, 4096
s_add_u32 m0, s45, 1024
s_nop 0
buffer_load_dwordx4 v1, s[8:11], s30 offen nt lds
s_add_u32 s30, s30, 4096
s_add_u32 m0, s45, 2048
s_nop 0
buffer_load_dwordx4 v1, s[8:11], s30 offen nt lds
s_add_u32 s30, s30, 4096
s_add_u32 m0, s45, 3072
s_nop 0
buffer_load_dwordx4 v1, s[8:11], s30 offen nt lds
s_add_u32 s30, s30, 4096
v_dot2_f32_bf16 v52, v32, v4, 0
v_dot2_f32_bf16 v53, v36, v4, 0
v_dot2_f32_bf16 v54, v40, v4, 0
v_dot2_f32_bf16 v55, v44, v4, 0
v_dot2c_f32_bf16 v52, v33, v5
v_dot2c_f32_bf16 v53, v37, v5
v_dot2c_f32_bf16 v54, v41, v5
v_dot2c_f32_bf16 v55, v45, v5
v_dot2c_f32_bf16 v52, v34, v6
v_dot2c_f32_bf16 v53, v38, v6
v_dot2c_f32_bf16 v54, v42, v6
v_dot2c_f32_bf16 v55, v46, v6
v_dot2c_f32_bf16 v52, v35, v7
v_dot2c_f32_bf16 v53, v39, v7
v_dot2c_f32_bf16 v54, v43, v7
v_dot2c_f32_bf16 v55, v47, v7
s_nop 2
s_nop 2
v_add_f32_dpp v56, v52, v52 row_ror:8 row_mask:0xf bank_mask:0x3
v_add_f32_dpp v57, v53, v53 row_ror:8 row_mask:0xf bank_mask:0x3
s_nop 0
v_add_f32_dpp v56, v54, v54 row_ror:8 row_mask:0xf bank_mask:0xc
v_add_f32_dpp v57, v55, v55 row_ror:8 row_mask:0xf bank_mask:0xc
s_nop 1
v_add_f32_dpp v31, v56, v56 row_shl:4 row_mask:0xf bank_mask:0x5
s_nop 1
v_add_f32_dpp v31, v57, v57 row_shr:4 row_mask:0xf bank_mask:0xa
s_nop 1
v_add_f32_dpp v31, v31, v31 quad_perm:[1,0,3,2] row_mask:0xf bank_mask:0xf
s_nop 1
v_add_f32_dpp v31, v31, v31 quad_perm:[2,3,0,1] row_mask:0xf bank_mask:0xf
s_nop 1
s_mov_b32 s63, 1
s_branch L_softmax
L_pvring:
s_mov_b32 s63, 0
v_lshlrev_b32 v44, 4, v0
v_add_u32 v45, s54, v44
v_add_u32 v44, s45, v44
v_mov_b32 v32, 0
v_mov_b32 v33, 0
v_mov_b32 v34, 0
v_mov_b32 v35, 0
v_mov_b32 v36, 0
v_mov_b32 v37, 0
v_mov_b32 v38, 0
v_mov_b32 v39, 0
s_waitcnt vmcnt(16)
ds_read_b128 v[46:49], v44 offset:4096
ds_read_b128 v[50:53], v44 offset:5120
ds_read_b128 v[54:57], v44 offset:6144
ds_read_b128 v[60:63], v44 offset:7168
v_and_b32_dpp v40, v16, v2 row_newbcast:0 row_mask:0xf bank_mask:0xf
v_and_b32_dpp v41, v16, v3 row_newbcast:0 row_mask:0xf bank_mask:0xf
s_waitcnt lgkmcnt(0)
s_add_u32 m0, s45, 4096
s_nop 0
buffer_load_dwordx4 v1, s[8:11], s30 offen nt lds
s_add_u32 s30, s30, 4096
s_add_u32 m0, s45, 5120
s_nop 0
buffer_load_dwordx4 v1, s[8:11], s30 offen nt lds
s_add_u32 s30, s30, 4096
s_add_u32 m0, s45, 6144
s_nop 0
buffer_load_dwordx4 v1, s[8:11], s30 offen nt lds
s_add_u32 s30, s30, 4096
s_add_u32 m0, s45, 7168
s_nop 0
buffer_load_dwordx4 v1, s[8:11], s30 offen nt lds
s_add_u32 s30, s30, 4096
v_and_b32_dpp v42, v16, v2 row_newbcast:4 row_mask:0xf bank_mask:0xf
v_and_b32_dpp v43, v16, v3 row_newbcast:4 row_mask:0xf bank_mask:0xf
v_mfma_f32_4x4x4_16b_bf16 v[32:35], v[40:41], v[46:47], v[32:35]
v_mfma_f32_4x4x4_16b_bf16 v[36:39], v[40:41], v[48:49], v[36:39]
v_and_b32_dpp v40, v16, v2 row_newbcast:8 row_mask:0xf bank_mask:0xf
v_and_b32_dpp v41, v16, v3 row_newbcast:8 row_mask:0xf bank_mask:0xf
v_mfma_f32_4x4x4_16b_bf16 v[32:35], v[42:43], v[50:51], v[32:35]
v_mfma_f32_4x4x4_16b_bf16 v[36:39], v[42:43], v[52:53], v[36:39]
v_and_b32_dpp v42, v16, v2 row_newbcast:12 row_mask:0xf bank_mask:0xf
v_and_b32_dpp v43, v16, v3 row_newbcast:12 row_mask:0xf bank_mask:0xf
v_mfma_f32_4x4x4_16b_bf16 v[32:35], v[40:41], v[54:55], v[32:35]
v_mfma_f32_4x4x4_16b_bf16 v[36:39], v[40:41], v[56:57], v[36:39]
s_nop 1
v_mfma_f32_4x4x4_16b_bf16 v[32:35], v[42:43], v[60:61], v[32:35]
v_mfma_f32_4x4x4_16b_bf16 v[36:39], v[42:43], v[62:63], v[36:39]
s_waitcnt vmcnt(16)
ds_read_b128 v[46:49], v44 offset:8192
ds_read_b128 v[50:53], v44 offset:9216
ds_read_b128 v[54:57], v44 offset:10240
ds_read_b128 v[60:63], v44 offset:11264
v_and_b32_dpp v40, v17, v2 row_newbcast:0 row_mask:0xf bank_mask:0xf
v_and_b32_dpp v41, v17, v3 row_newbcast:0 row_mask:0xf bank_mask:0xf
s_waitcnt lgkmcnt(0)
s_add_u32 m0, s45, 8192
s_nop 0
buffer_load_dwordx4 v1, s[8:11], s30 offen nt lds
s_add_u32 s30, s30, 4096
s_add_u32 m0, s45, 9216
s_nop 0
buffer_load_dwordx4 v1, s[8:11], s30 offen nt lds
s_add_u32 s30, s30, 4096
s_add_u32 m0, s45, 10240
s_nop 0
buffer_load_dwordx4 v1, s[8:11], s30 offen nt lds
s_add_u32 s30, s30, 4096
s_add_u32 m0, s45, 11264
s_nop 0
buffer_load_dwordx4 v1, s[8:11], s30 offen nt lds
s_add_u32 s30, s30, 4096
v_and_b32_dpp v42, v17, v2 row_newbcast:4 row_mask:0xf bank_mask:0xf
v_and_b32_dpp v43, v17, v3 row_newbcast:4 row_mask:0xf bank_mask:0xf
v_mfma_f32_4x4x4_16b_bf16 v[32:35], v[40:41], v[46:47], v[32:35]
v_mfma_f32_4x4x4_16b_bf16 v[36:39], v[40:41], v[48:49], v[36:39]
v_and_b32_dpp v40, v17, v2 row_newbcast:8 row_mask:0xf bank_mask:0xf
v_and_b32_dpp v41, v17, v3 row_newbcast:8 row_mask:0xf bank_mask:0xf
v_mfma_f32_4x4x4_16b_bf16 v[32:35], v[42:43], v[50:51], v[32:35]
v_mfma_f32_4x4x4_16b_bf16 v[36:39], v[42:43], v[52:53], v[36:39]
v_and_b32_dpp v42, v17, v2 row_newbcast:12 row_mask:0xf bank_mask:0xf
v_and_b32_dpp v43, v17, v3 row_newbcast:12 row_mask:0xf bank_mask:0xf
v_mfma_f32_4x4x4_16b_bf16 v[32:35], v[40:41], v[54:55], v[32:35]
v_mfma_f32_4x4x4_16b_bf16 v[36:39], v[40:41], v[56:57], v[36:39]
s_nop 1
v_mfma_f32_4x4x4_16b_bf16 v[32:35], v[42:43], v[60:61], v[32:35]
v_mfma_f32_4x4x4_16b_bf16 v[36:39], v[42:43], v[62:63], v[36:39]
s_waitcnt vmcnt(16)
ds_read_b128 v[46:49], v44 offset:12288
ds_read_b128 v[50:53], v44 offset:13312
ds_read_b128 v[54:57], v44 offset:14336
ds_read_b128 v[60:63], v44 offset:15360
v_and_b32_dpp v40, v18, v2 row_newbcast:0 row_mask:0xf bank_mask:0xf
v_and_b32_dpp v41, v18, v3 row_newbcast:0 row_mask:0xf bank_mask:0xf
s_waitcnt lgkmcnt(0)
s_add_u32 m0, s45, 12288
s_nop 0
buffer_load_dwordx4 v1, s[8:11], s30 offen nt lds
s_add_u32 s30, s30, 4096
s_add_u32 m0, s45, 13312
s_nop 0
buffer_load_dwordx4 v1, s[8:11], s30 offen nt lds
s_add_u32 s30, s30, 4096
s_add_u32 m0, s45, 14336
s_nop 0
buffer_load_dwordx4 v1, s[8:11], s30 offen nt lds
s_add_u32 s30, s30, 4096
s_add_u32 m0, s45, 15360
s_nop 0
buffer_load_dwordx4 v1, s[8:11], s30 offen nt lds
s_add_u32 s30, s30, 4096
v_and_b32_dpp v42, v18, v2 row_newbcast:4 row_mask:0xf bank_mask:0xf
v_and_b32_dpp v43, v18, v3 row_newbcast:4 row_mask:0xf bank_mask:0xf
v_mfma_f32_4x4x4_16b_bf16 v[32:35], v[40:41], v[46:47], v[32:35]
v_mfma_f32_4x4x4_16b_bf16 v[36:39], v[40:41], v[48:49], v[36:39]
v_and_b32_dpp v40, v18, v2 row_newbcast:8 row_mask:0xf bank_mask:0xf
v_and_b32_dpp v41, v18, v3 row_newbcast:8 row_mask:0xf bank_mask:0xf
v_mfma_f32_4x4x4_16b_bf16 v[32:35], v[42:43], v[50:51], v[32:35]
v_mfma_f32_4x4x4_16b_bf16 v[36:39], v[42:43], v[52:53], v[36:39]
v_and_b32_dpp v42, v18, v2 row_newbcast:12 row_mask:0xf bank_mask:0xf
v_and_b32_dpp v43, v18, v3 row_newbcast:12 row_mask:0xf bank_mask:0xf
v_mfma_f32_4x4x4_16b_bf16 v[32:35], v[40:41], v[54:55], v[32:35]
v_mfma_f32_4x4x4_16b_bf16 v[36:39], v[40:41], v[56:57], v[36:39]
s_nop 1
v_mfma_f32_4x4x4_16b_bf16 v[32:35], v[42:43], v[60:61], v[32:35]
v_mfma_f32_4x4x4_16b_bf16 v[36:39], v[42:43], v[62:63], v[36:39]
s_waitcnt vmcnt(16)
ds_read_b128 v[46:49], v44 offset:16384
ds_read_b128 v[50:53], v44 offset:17408
ds_read_b128 v[54:57], v44 offset:18432
ds_read_b128 v[60:63], v44 offset:19456
v_and_b32_dpp v40, v19, v2 row_newbcast:0 row_mask:0xf bank_mask:0xf
v_and_b32_dpp v41, v19, v3 row_newbcast:0 row_mask:0xf bank_mask:0xf
s_waitcnt lgkmcnt(0)
s_add_u32 m0, s45, 16384
s_nop 0
buffer_load_dwordx4 v1, s[8:11], s30 offen nt lds
s_add_u32 s30, s30, 4096
s_add_u32 m0, s45, 17408
s_nop 0
buffer_load_dwordx4 v1, s[8:11], s30 offen nt lds
s_add_u32 s30, s30, 4096
s_add_u32 m0, s45, 18432
s_nop 0
buffer_load_dwordx4 v1, s[8:11], s30 offen nt lds
s_add_u32 s30, s30, 4096
s_add_u32 m0, s45, 19456
s_nop 0
buffer_load_dwordx4 v1, s[8:11], s30 offen nt lds
s_add_u32 s30, s30, 4096
v_and_b32_dpp v42, v19, v2 row_newbcast:4 row_mask:0xf bank_mask:0xf
v_and_b32_dpp v43, v19, v3 row_newbcast:4 row_mask:0xf bank_mask:0xf
v_mfma_f32_4x4x4_16b_bf16 v[32:35], v[40:41], v[46:47], v[32:35]
v_mfma_f32_4x4x4_16b_bf16 v[36:39], v[40:41], v[48:49], v[36:39]
v_and_b32_dpp v40, v19, v2 row_newbcast:8 row_mask:0xf bank_mask:0xf
v_and_b32_dpp v41, v19, v3 row_newbcast:8 row_mask:0xf bank_mask:0xf
v_mfma_f32_4x4x4_16b_bf16 v[32:35], v[42:43], v[50:51], v[32:35]
v_mfma_f32_4x4x4_16b_bf16 v[36:39], v[42:43], v[52:53], v[36:39]
v_and_b32_dpp v42, v19, v2 row_newbcast:12 row_mask:0xf bank_mask:0xf
v_and_b32_dpp v43, v19, v3 row_newbcast:12 row_mask:0xf bank_mask:0xf
v_mfma_f32_4x4x4_16b_bf16 v[32:35], v[40:41], v[54:55], v[32:35]
v_mfma_f32_4x4x4_16b_bf16 v[36:39], v[40:41], v[56:57], v[36:39]
s_nop 1
v_mfma_f32_4x4x4_16b_bf16 v[32:35], v[42:43], v[60:61], v[32:35]
v_mfma_f32_4x4x4_16b_bf16 v[36:39], v[42:43], v[62:63], v[36:39]
s_waitcnt vmcnt(16)
ds_read_b128 v[46:49], v44 offset:0
ds_read_b128 v[50:53], v44 offset:1024
ds_read_b128 v[54:57], v44 offset:2048
ds_read_b128 v[60:63], v44 offset:3072
v_and_b32_dpp v40, v20, v2 row_newbcast:0 row_mask:0xf bank_mask:0xf
v_and_b32_dpp v41, v20, v3 row_newbcast:0 row_mask:0xf bank_mask:0xf
s_waitcnt lgkmcnt(0)
s_add_u32 m0, s45, 0
s_nop 0
buffer_load_dwordx4 v1, s[8:11], s30 offen nt lds
s_add_u32 s30, s30, 4096
s_add_u32 m0, s45, 1024
s_nop 0
buffer_load_dwordx4 v1, s[8:11], s30 offen nt lds
s_add_u32 s30, s30, 4096
s_add_u32 m0, s45, 2048
s_nop 0
buffer_load_dwordx4 v1, s[8:11], s30 offen nt lds
s_add_u32 s30, s30, 4096
s_add_u32 m0, s45, 3072
s_nop 0
buffer_load_dwordx4 v1, s[8:11], s30 offen nt lds
s_add_u32 s30, s30, 4096
v_and_b32_dpp v42, v20, v2 row_newbcast:4 row_mask:0xf bank_mask:0xf
v_and_b32_dpp v43, v20, v3 row_newbcast:4 row_mask:0xf bank_mask:0xf
v_mfma_f32_4x4x4_16b_bf16 v[32:35], v[40:41], v[46:47], v[32:35]
v_mfma_f32_4x4x4_16b_bf16 v[36:39], v[40:41], v[48:49], v[36:39]
v_and_b32_dpp v40, v20, v2 row_newbcast:8 row_mask:0xf bank_mask:0xf
v_and_b32_dpp v41, v20, v3 row_newbcast:8 row_mask:0xf bank_mask:0xf
v_mfma_f32_4x4x4_16b_bf16 v[32:35], v[42:43], v[50:51], v[32:35]
v_mfma_f32_4x4x4_16b_bf16 v[36:39], v[42:43], v[52:53], v[36:39]
v_and_b32_dpp v42, v20, v2 row_newbcast:12 row_mask:0xf bank_mask:0xf
v_and_b32_dpp v43, v20, v3 row_newbcast:12 row_mask:0xf bank_mask:0xf
v_mfma_f32_4x4x4_16b_bf16 v[32:35], v[40:41], v[54:55], v[32:35]
v_mfma_f32_4x4x4_16b_bf16 v[36:39], v[40:41], v[56:57], v[36:39]
s_nop 1
v_mfma_f32_4x4x4_16b_bf16 v[32:35], v[42:43], v[60:61], v[32:35]
v_mfma_f32_4x4x4_16b_bf16 v[36:39], v[42:43], v[62:63], v[36:39]
s_waitcnt vmcnt(16)
ds_read_b128 v[46:49], v44 offset:4096
ds_read_b128 v[50:53], v44 offset:5120
ds_read_b128 v[54:57], v44 offset:6144
ds_read_b128 v[60:63], v44 offset:7168
v_and_b32_dpp v40, v21, v2 row_newbcast:0 row_mask:0xf bank_mask:0xf
v_and_b32_dpp v41, v21, v3 row_newbcast:0 row_mask:0xf bank_mask:0xf
s_waitcnt lgkmcnt(0)
s_add_u32 m0, s45, 4096
s_nop 0
buffer_load_dwordx4 v1, s[8:11], s30 offen nt lds
s_add_u32 s30, s30, 4096
s_add_u32 m0, s45, 5120
s_nop 0
buffer_load_dwordx4 v1, s[8:11], s30 offen nt lds
s_add_u32 s30, s30, 4096
s_add_u32 m0, s45, 6144
s_nop 0
buffer_load_dwordx4 v1, s[8:11], s30 offen nt lds
s_add_u32 s30, s30, 4096
s_add_u32 m0, s45, 7168
s_nop 0
buffer_load_dwordx4 v1, s[8:11], s30 offen nt lds
s_add_u32 s30, s30, 4096
v_and_b32_dpp v42, v21, v2 row_newbcast:4 row_mask:0xf bank_mask:0xf
v_and_b32_dpp v43, v21, v3 row_newbcast:4 row_mask:0xf bank_mask:0xf
v_mfma_f32_4x4x4_16b_bf16 v[32:35], v[40:41], v[46:47], v[32:35]
v_mfma_f32_4x4x4_16b_bf16 v[36:39], v[40:41], v[48:49], v[36:39]
v_and_b32_dpp v40, v21, v2 row_newbcast:8 row_mask:0xf bank_mask:0xf
v_and_b32_dpp v41, v21, v3 row_newbcast:8 row_mask:0xf bank_mask:0xf
v_mfma_f32_4x4x4_16b_bf16 v[32:35], v[42:43], v[50:51], v[32:35]
v_mfma_f32_4x4x4_16b_bf16 v[36:39], v[42:43], v[52:53], v[36:39]
v_and_b32_dpp v42, v21, v2 row_newbcast:12 row_mask:0xf bank_mask:0xf
v_and_b32_dpp v43, v21, v3 row_newbcast:12 row_mask:0xf bank_mask:0xf
v_mfma_f32_4x4x4_16b_bf16 v[32:35], v[40:41], v[54:55], v[32:35]
v_mfma_f32_4x4x4_16b_bf16 v[36:39], v[40:41], v[56:57], v[36:39]
s_nop 1
v_mfma_f32_4x4x4_16b_bf16 v[32:35], v[42:43], v[60:61], v[32:35]
v_mfma_f32_4x4x4_16b_bf16 v[36:39], v[42:43], v[62:63], v[36:39]
s_waitcnt vmcnt(16)
ds_read_b128 v[46:49], v44 offset:8192
ds_read_b128 v[50:53], v44 offset:9216
ds_read_b128 v[54:57], v44 offset:10240
ds_read_b128 v[60:63], v44 offset:11264
v_and_b32_dpp v40, v22, v2 row_newbcast:0 row_mask:0xf bank_mask:0xf
v_and_b32_dpp v41, v22, v3 row_newbcast:0 row_mask:0xf bank_mask:0xf
s_waitcnt lgkmcnt(0)
s_add_u32 m0, s45, 8192
s_nop 0
buffer_load_dwordx4 v1, s[8:11], s30 offen nt lds
s_add_u32 s30, s30, 4096
s_add_u32 m0, s45, 9216
s_nop 0
buffer_load_dwordx4 v1, s[8:11], s30 offen nt lds
s_add_u32 s30, s30, 4096
s_add_u32 m0, s45, 10240
s_nop 0
buffer_load_dwordx4 v1, s[8:11], s30 offen nt lds
s_add_u32 s30, s30, 4096
s_add_u32 m0, s45, 11264
s_nop 0
buffer_load_dwordx4 v1, s[8:11], s30 offen nt lds
s_add_u32 s30, s30, 4096
v_and_b32_dpp v42, v22, v2 row_newbcast:4 row_mask:0xf bank_mask:0xf
v_and_b32_dpp v43, v22, v3 row_newbcast:4 row_mask:0xf bank_mask:0xf
v_mfma_f32_4x4x4_16b_bf16 v[32:35], v[40:41], v[46:47], v[32:35]
v_mfma_f32_4x4x4_16b_bf16 v[36:39], v[40:41], v[48:49], v[36:39]
v_and_b32_dpp v40, v22, v2 row_newbcast:8 row_mask:0xf bank_mask:0xf
v_and_b32_dpp v41, v22, v3 row_newbcast:8 row_mask:0xf bank_mask:0xf
v_mfma_f32_4x4x4_16b_bf16 v[32:35], v[42:43], v[50:51], v[32:35]
v_mfma_f32_4x4x4_16b_bf16 v[36:39], v[42:43], v[52:53], v[36:39]
v_and_b32_dpp v42, v22, v2 row_newbcast:12 row_mask:0xf bank_mask:0xf
v_and_b32_dpp v43, v22, v3 row_newbcast:12 row_mask:0xf bank_mask:0xf
v_mfma_f32_4x4x4_16b_bf16 v[32:35], v[40:41], v[54:55], v[32:35]
v_mfma_f32_4x4x4_16b_bf16 v[36:39], v[40:41], v[56:57], v[36:39]
s_nop 1
v_mfma_f32_4x4x4_16b_bf16 v[32:35], v[42:43], v[60:61], v[32:35]
v_mfma_f32_4x4x4_16b_bf16 v[36:39], v[42:43], v[62:63], v[36:39]
s_waitcnt vmcnt(16)
ds_read_b128 v[46:49], v44 offset:12288
ds_read_b128 v[50:53], v44 offset:13312
ds_read_b128 v[54:57], v44 offset:14336
ds_read_b128 v[60:63], v44 offset:15360
v_and_b32_dpp v40, v23, v2 row_newbcast:0 row_mask:0xf bank_mask:0xf
v_and_b32_dpp v41, v23, v3 row_newbcast:0 row_mask:0xf bank_mask:0xf
s_waitcnt lgkmcnt(0)
s_add_u32 m0, s45, 12288
s_nop 0
buffer_load_dwordx4 v1, s[8:11], s30 offen nt lds
s_add_u32 s30, s30, 4096
s_add_u32 m0, s45, 13312
s_nop 0
buffer_load_dwordx4 v1, s[8:11], s30 offen nt lds
s_add_u32 s30, s30, 4096
s_add_u32 m0, s45, 14336
s_nop 0
buffer_load_dwordx4 v1, s[8:11], s30 offen nt lds
s_add_u32 s30, s30, 4096
s_add_u32 m0, s45, 15360
s_nop 0
buffer_load_dwordx4 v1, s[8:11], s30 offen nt lds
s_add_u32 s30, s30, 4096
v_and_b32_dpp v42, v23, v2 row_newbcast:4 row_mask:0xf bank_mask:0xf
v_and_b32_dpp v43, v23, v3 row_newbcast:4 row_mask:0xf bank_mask:0xf
v_mfma_f32_4x4x4_16b_bf16 v[32:35], v[40:41], v[46:47], v[32:35]
v_mfma_f32_4x4x4_16b_bf16 v[36:39], v[40:41], v[48:49], v[36:39]
v_and_b32_dpp v40, v23, v2 row_newbcast:8 row_mask:0xf bank_mask:0xf
v_and_b32_dpp v41, v23, v3 row_newbcast:8 row_mask:0xf bank_mask:0xf
v_mfma_f32_4x4x4_16b_bf16 v[32:35], v[42:43], v[50:51], v[32:35]
v_mfma_f32_4x4x4_16b_bf16 v[36:39], v[42:43], v[52:53], v[36:39]
v_and_b32_dpp v42, v23, v2 row_newbcast:12 row_mask:0xf bank_mask:0xf
v_and_b32_dpp v43, v23, v3 row_newbcast:12 row_mask:0xf bank_mask:0xf
v_mfma_f32_4x4x4_16b_bf16 v[32:35], v[40:41], v[54:55], v[32:35]
v_mfma_f32_4x4x4_16b_bf16 v[36:39], v[40:41], v[56:57], v[36:39]
s_nop 1
v_mfma_f32_4x4x4_16b_bf16 v[32:35], v[42:43], v[60:61], v[32:35]
v_mfma_f32_4x4x4_16b_bf16 v[36:39], v[42:43], v[62:63], v[36:39]
s_waitcnt vmcnt(16)
ds_read_b128 v[46:49], v44 offset:16384
ds_read_b128 v[50:53], v44 offset:17408
ds_read_b128 v[54:57], v44 offset:18432
ds_read_b128 v[60:63], v44 offset:19456
v_and_b32_dpp v40, v24, v2 row_newbcast:0 row_mask:0xf bank_mask:0xf
v_and_b32_dpp v41, v24, v3 row_newbcast:0 row_mask:0xf bank_mask:0xf
s_waitcnt lgkmcnt(0)
s_add_u32 m0, s45, 16384
s_nop 0
buffer_load_dwordx4 v1, s[8:11], s30 offen nt lds
s_add_u32 s30, s30, 4096
s_add_u32 m0, s45, 17408
s_nop 0
buffer_load_dwordx4 v1, s[8:11], s30 offen nt lds
s_add_u32 s30, s30, 4096
s_add_u32 m0, s45, 18432
s_nop 0
buffer_load_dwordx4 v1, s[8:11], s30 offen nt lds
s_add_u32 s30, s30, 4096
s_add_u32 m0, s45, 19456
s_nop 0
buffer_load_dwordx4 v1, s[8:11], s30 offen nt lds
s_add_u32 s30, s30, 4096
v_and_b32_dpp v42, v24, v2 row_newbcast:4 row_mask:0xf bank_mask:0xf
v_and_b32_dpp v43, v24, v3 row_newbcast:4 row_mask:0xf bank_mask:0xf
v_mfma_f32_4x4x4_16b_bf16 v[32:35], v[40:41], v[46:47], v[32:35]
v_mfma_f32_4x4x4_16b_bf16 v[36:39], v[40:41], v[48:49], v[36:39]
v_and_b32_dpp v40, v24, v2 row_newbcast:8 row_mask:0xf bank_mask:0xf
v_and_b32_dpp v41, v24, v3 row_newbcast:8 row_mask:0xf bank_mask:0xf
v_mfma_f32_4x4x4_16b_bf16 v[32:35], v[42:43], v[50:51], v[32:35]
v_mfma_f32_4x4x4_16b_bf16 v[36:39], v[42:43], v[52:53], v[36:39]
v_and_b32_dpp v42, v24, v2 row_newbcast:12 row_mask:0xf bank_mask:0xf
v_and_b32_dpp v43, v24, v3 row_newbcast:12 row_mask:0xf bank_mask:0xf
v_mfma_f32_4x4x4_16b_bf16 v[32:35], v[40:41], v[54:55], v[32:35]
v_mfma_f32_4x4x4_16b_bf16 v[36:39], v[40:41], v[56:57], v[36:39]
s_nop 1
v_mfma_f32_4x4x4_16b_bf16 v[32:35], v[42:43], v[60:61], v[32:35]
v_mfma_f32_4x4x4_16b_bf16 v[36:39], v[42:43], v[62:63], v[36:39]
s_waitcnt vmcnt(16)
ds_read_b128 v[46:49], v44 offset:0
ds_read_b128 v[50:53], v44 offset:1024
ds_read_b128 v[54:57], v44 offset:2048
ds_read_b128 v[60:63], v44 offset:3072
v_and_b32_dpp v40, v25, v2 row_newbcast:0 row_mask:0xf bank_mask:0xf
v_and_b32_dpp v41, v25, v3 row_newbcast:0 row_mask:0xf bank_mask:0xf
s_waitcnt lgkmcnt(0)
s_add_u32 m0, s45, 0
s_nop 0
buffer_load_dwordx4 v1, s[8:11], s30 offen nt lds
s_add_u32 s30, s30, 4096
s_add_u32 m0, s45, 1024
s_nop 0
buffer_load_dwordx4 v1, s[8:11], s30 offen nt lds
s_add_u32 s30, s30, 4096
s_add_u32 m0, s45, 2048
s_nop 0
buffer_load_dwordx4 v1, s[8:11], s30 offen nt lds
s_add_u32 s30, s30, 4096
s_add_u32 m0, s45, 3072
s_nop 0
buffer_load_dwordx4 v1, s[8:11], s30 offen nt lds
s_add_u32 s30, s30, 4096
v_and_b32_dpp v42, v25, v2 row_newbcast:4 row_mask:0xf bank_mask:0xf
v_and_b32_dpp v43, v25, v3 row_newbcast:4 row_mask:0xf bank_mask:0xf
v_mfma_f32_4x4x4_16b_bf16 v[32:35], v[40:41], v[46:47], v[32:35]
v_mfma_f32_4x4x4_16b_bf16 v[36:39], v[40:41], v[48:49], v[36:39]
v_and_b32_dpp v40, v25, v2 row_newbcast:8 row_mask:0xf bank_mask:0xf
v_and_b32_dpp v41, v25, v3 row_newbcast:8 row_mask:0xf bank_mask:0xf
v_mfma_f32_4x4x4_16b_bf16 v[32:35], v[42:43], v[50:51], v[32:35]
v_mfma_f32_4x4x4_16b_bf16 v[36:39], v[42:43], v[52:53], v[36:39]
v_and_b32_dpp v42, v25, v2 row_newbcast:12 row_mask:0xf bank_mask:0xf
v_and_b32_dpp v43, v25, v3 row_newbcast:12 row_mask:0xf bank_mask:0xf
v_mfma_f32_4x4x4_16b_bf16 v[32:35], v[40:41], v[54:55], v[32:35]
v_mfma_f32_4x4x4_16b_bf16 v[36:39], v[40:41], v[56:57], v[36:39]
s_nop 1
v_mfma_f32_4x4x4_16b_bf16 v[32:35], v[42:43], v[60:61], v[32:35]
v_mfma_f32_4x4x4_16b_bf16 v[36:39], v[42:43], v[62:63], v[36:39]
s_waitcnt vmcnt(16)
ds_read_b128 v[46:49], v44 offset:4096
ds_read_b128 v[50:53], v44 offset:5120
ds_read_b128 v[54:57], v44 offset:6144
ds_read_b128 v[60:63], v44 offset:7168
v_and_b32_dpp v40, v26, v2 row_newbcast:0 row_mask:0xf bank_mask:0xf
v_and_b32_dpp v41, v26, v3 row_newbcast:0 row_mask:0xf bank_mask:0xf
s_waitcnt lgkmcnt(0)
s_add_u32 m0, s45, 4096
s_nop 0
buffer_load_dwordx4 v1, s[8:11], s30 offen nt lds
s_add_u32 s30, s30, 4096
s_add_u32 m0, s45, 5120
s_nop 0
buffer_load_dwordx4 v1, s[8:11], s30 offen nt lds
s_add_u32 s30, s30, 4096
s_add_u32 m0, s45, 6144
s_nop 0
buffer_load_dwordx4 v1, s[8:11], s30 offen nt lds
s_add_u32 s30, s30, 4096
s_add_u32 m0, s45, 7168
s_nop 0
buffer_load_dwordx4 v1, s[8:11], s30 offen nt lds
s_add_u32 s30, s30, 4096
v_and_b32_dpp v42, v26, v2 row_newbcast:4 row_mask:0xf bank_mask:0xf
v_and_b32_dpp v43, v26, v3 row_newbcast:4 row_mask:0xf bank_mask:0xf
v_mfma_f32_4x4x4_16b_bf16 v[32:35], v[40:41], v[46:47], v[32:35]
v_mfma_f32_4x4x4_16b_bf16 v[36:39], v[40:41], v[48:49], v[36:39]
v_and_b32_dpp v40, v26, v2 row_newbcast:8 row_mask:0xf bank_mask:0xf
v_and_b32_dpp v41, v26, v3 row_newbcast:8 row_mask:0xf bank_mask:0xf
v_mfma_f32_4x4x4_16b_bf16 v[32:35], v[42:43], v[50:51], v[32:35]
v_mfma_f32_4x4x4_16b_bf16 v[36:39], v[42:43], v[52:53], v[36:39]
v_and_b32_dpp v42, v26, v2 row_newbcast:12 row_mask:0xf bank_mask:0xf
v_and_b32_dpp v43, v26, v3 row_newbcast:12 row_mask:0xf bank_mask:0xf
v_mfma_f32_4x4x4_16b_bf16 v[32:35], v[40:41], v[54:55], v[32:35]
v_mfma_f32_4x4x4_16b_bf16 v[36:39], v[40:41], v[56:57], v[36:39]
s_nop 1
v_mfma_f32_4x4x4_16b_bf16 v[32:35], v[42:43], v[60:61], v[32:35]
v_mfma_f32_4x4x4_16b_bf16 v[36:39], v[42:43], v[62:63], v[36:39]
s_waitcnt vmcnt(16)
ds_read_b128 v[46:49], v44 offset:8192
ds_read_b128 v[50:53], v44 offset:9216
ds_read_b128 v[54:57], v44 offset:10240
ds_read_b128 v[60:63], v44 offset:11264
v_and_b32_dpp v40, v27, v2 row_newbcast:0 row_mask:0xf bank_mask:0xf
v_and_b32_dpp v41, v27, v3 row_newbcast:0 row_mask:0xf bank_mask:0xf
s_waitcnt lgkmcnt(0)
v_and_b32_dpp v42, v27, v2 row_newbcast:4 row_mask:0xf bank_mask:0xf
v_and_b32_dpp v43, v27, v3 row_newbcast:4 row_mask:0xf bank_mask:0xf
v_mfma_f32_4x4x4_16b_bf16 v[32:35], v[40:41], v[46:47], v[32:35]
v_mfma_f32_4x4x4_16b_bf16 v[36:39], v[40:41], v[48:49], v[36:39]
v_and_b32_dpp v40, v27, v2 row_newbcast:8 row_mask:0xf bank_mask:0xf
v_and_b32_dpp v41, v27, v3 row_newbcast:8 row_mask:0xf bank_mask:0xf
v_mfma_f32_4x4x4_16b_bf16 v[32:35], v[42:43], v[50:51], v[32:35]
v_mfma_f32_4x4x4_16b_bf16 v[36:39], v[42:43], v[52:53], v[36:39]
v_and_b32_dpp v42, v27, v2 row_newbcast:12 row_mask:0xf bank_mask:0xf
v_and_b32_dpp v43, v27, v3 row_newbcast:12 row_mask:0xf bank_mask:0xf
v_mfma_f32_4x4x4_16b_bf16 v[32:35], v[40:41], v[54:55], v[32:35]
v_mfma_f32_4x4x4_16b_bf16 v[36:39], v[40:41], v[56:57], v[36:39]
s_nop 1
v_mfma_f32_4x4x4_16b_bf16 v[32:35], v[42:43], v[60:61], v[32:35]
v_mfma_f32_4x4x4_16b_bf16 v[36:39], v[42:43], v[62:63], v[36:39]
s_waitcnt vmcnt(12)
ds_read_b128 v[46:49], v44 offset:12288
ds_read_b128 v[50:53], v44 offset:13312
ds_read_b128 v[54:57], v44 offset:14336
ds_read_b128 v[60:63], v44 offset:15360
v_and_b32_dpp v40, v28, v2 row_newbcast:0 row_mask:0xf bank_mask:0xf
v_and_b32_dpp v41, v28, v3 row_newbcast:0 row_mask:0xf bank_mask:0xf
s_waitcnt lgkmcnt(0)
v_and_b32_dpp v42, v28, v2 row_newbcast:4 row_mask:0xf bank_mask:0xf
v_and_b32_dpp v43, v28, v3 row_newbcast:4 row_mask:0xf bank_mask:0xf
v_mfma_f32_4x4x4_16b_bf16 v[32:35], v[40:41], v[46:47], v[32:35]
v_mfma_f32_4x4x4_16b_bf16 v[36:39], v[40:41], v[48:49], v[36:39]
v_and_b32_dpp v40, v28, v2 row_newbcast:8 row_mask:0xf bank_mask:0xf
v_and_b32_dpp v41, v28, v3 row_newbcast:8 row_mask:0xf bank_mask:0xf
v_mfma_f32_4x4x4_16b_bf16 v[32:35], v[42:43], v[50:51], v[32:35]
v_mfma_f32_4x4x4_16b_bf16 v[36:39], v[42:43], v[52:53], v[36:39]
v_and_b32_dpp v42, v28, v2 row_newbcast:12 row_mask:0xf bank_mask:0xf
v_and_b32_dpp v43, v28, v3 row_newbcast:12 row_mask:0xf bank_mask:0xf
v_mfma_f32_4x4x4_16b_bf16 v[32:35], v[40:41], v[54:55], v[32:35]
v_mfma_f32_4x4x4_16b_bf16 v[36:39], v[40:41], v[56:57], v[36:39]
s_nop 1
v_mfma_f32_4x4x4_16b_bf16 v[32:35], v[42:43], v[60:61], v[32:35]
v_mfma_f32_4x4x4_16b_bf16 v[36:39], v[42:43], v[62:63], v[36:39]
s_waitcnt vmcnt(8)
ds_read_b128 v[46:49], v44 offset:16384
ds_read_b128 v[50:53], v44 offset:17408
ds_read_b128 v[54:57], v44 offset:18432
ds_read_b128 v[60:63], v44 offset:19456
v_and_b32_dpp v40, v29, v2 row_newbcast:0 row_mask:0xf bank_mask:0xf
v_and_b32_dpp v41, v29, v3 row_newbcast:0 row_mask:0xf bank_mask:0xf
s_waitcnt lgkmcnt(0)
v_and_b32_dpp v42, v29, v2 row_newbcast:4 row_mask:0xf bank_mask:0xf
v_and_b32_dpp v43, v29, v3 row_newbcast:4 row_mask:0xf bank_mask:0xf
v_mfma_f32_4x4x4_16b_bf16 v[32:35], v[40:41], v[46:47], v[32:35]
v_mfma_f32_4x4x4_16b_bf16 v[36:39], v[40:41], v[48:49], v[36:39]
v_and_b32_dpp v40, v29, v2 row_newbcast:8 row_mask:0xf bank_mask:0xf
v_and_b32_dpp v41, v29, v3 row_newbcast:8 row_mask:0xf bank_mask:0xf
v_mfma_f32_4x4x4_16b_bf16 v[32:35], v[42:43], v[50:51], v[32:35]
v_mfma_f32_4x4x4_16b_bf16 v[36:39], v[42:43], v[52:53], v[36:39]
v_and_b32_dpp v42, v29, v2 row_newbcast:12 row_mask:0xf bank_mask:0xf
v_and_b32_dpp v43, v29, v3 row_newbcast:12 row_mask:0xf bank_mask:0xf
v_mfma_f32_4x4x4_16b_bf16 v[32:35], v[40:41], v[54:55], v[32:35]
v_mfma_f32_4x4x4_16b_bf16 v[36:39], v[40:41], v[56:57], v[36:39]
s_nop 1
v_mfma_f32_4x4x4_16b_bf16 v[32:35], v[42:43], v[60:61], v[32:35]
v_mfma_f32_4x4x4_16b_bf16 v[36:39], v[42:43], v[62:63], v[36:39]
s_waitcnt vmcnt(4)
ds_read_b128 v[46:49], v44 offset:0
ds_read_b128 v[50:53], v44 offset:1024
ds_read_b128 v[54:57], v44 offset:2048
ds_read_b128 v[60:63], v44 offset:3072
v_and_b32_dpp v40, v30, v2 row_newbcast:0 row_mask:0xf bank_mask:0xf
v_and_b32_dpp v41, v30, v3 row_newbcast:0 row_mask:0xf bank_mask:0xf
s_waitcnt lgkmcnt(0)
v_and_b32_dpp v42, v30, v2 row_newbcast:4 row_mask:0xf bank_mask:0xf
v_and_b32_dpp v43, v30, v3 row_newbcast:4 row_mask:0xf bank_mask:0xf
v_mfma_f32_4x4x4_16b_bf16 v[32:35], v[40:41], v[46:47], v[32:35]
v_mfma_f32_4x4x4_16b_bf16 v[36:39], v[40:41], v[48:49], v[36:39]
v_and_b32_dpp v40, v30, v2 row_newbcast:8 row_mask:0xf bank_mask:0xf
v_and_b32_dpp v41, v30, v3 row_newbcast:8 row_mask:0xf bank_mask:0xf
v_mfma_f32_4x4x4_16b_bf16 v[32:35], v[42:43], v[50:51], v[32:35]
v_mfma_f32_4x4x4_16b_bf16 v[36:39], v[42:43], v[52:53], v[36:39]
v_and_b32_dpp v42, v30, v2 row_newbcast:12 row_mask:0xf bank_mask:0xf
v_and_b32_dpp v43, v30, v3 row_newbcast:12 row_mask:0xf bank_mask:0xf
v_mfma_f32_4x4x4_16b_bf16 v[32:35], v[40:41], v[54:55], v[32:35]
v_mfma_f32_4x4x4_16b_bf16 v[36:39], v[40:41], v[56:57], v[36:39]
s_nop 1
v_mfma_f32_4x4x4_16b_bf16 v[32:35], v[42:43], v[60:61], v[32:35]
v_mfma_f32_4x4x4_16b_bf16 v[36:39], v[42:43], v[62:63], v[36:39]
s_waitcnt vmcnt(0)
ds_read_b128 v[46:49], v44 offset:4096
ds_read_b128 v[50:53], v44 offset:5120
ds_read_b128 v[54:57], v44 offset:6144
ds_read_b128 v[60:63], v44 offset:7168
v_and_b32_dpp v40, v31, v2 row_newbcast:0 row_mask:0xf bank_mask:0xf
v_and_b32_dpp v41, v31, v3 row_newbcast:0 row_mask:0xf bank_mask:0xf
s_waitcnt lgkmcnt(0)
v_and_b32_dpp v42, v31, v2 row_newbcast:4 row_mask:0xf bank_mask:0xf
v_and_b32_dpp v43, v31, v3 row_newbcast:4 row_mask:0xf bank_mask:0xf
v_mfma_f32_4x4x4_16b_bf16 v[32:35], v[40:41], v[46:47], v[32:35]
v_mfma_f32_4x4x4_16b_bf16 v[36:39], v[40:41], v[48:49], v[36:39]
v_and_b32_dpp v40, v31, v2 row_newbcast:8 row_mask:0xf bank_mask:0xf
v_and_b32_dpp v41, v31, v3 row_newbcast:8 row_mask:0xf bank_mask:0xf
v_mfma_f32_4x4x4_16b_bf16 v[32:35], v[42:43], v[50:51], v[32:35]
v_mfma_f32_4x4x4_16b_bf16 v[36:39], v[42:43], v[52:53], v[36:39]
v_and_b32_dpp v42, v31, v2 row_newbcast:12 row_mask:0xf bank_mask:0xf
v_and_b32_dpp v43, v31, v3 row_newbcast:12 row_mask:0xf bank_mask:0xf
v_mfma_f32_4x4x4_16b_bf16 v[32:35], v[40:41], v[54:55], v[32:35]
v_mfma_f32_4x4x4_16b_bf16 v[36:39], v[40:41], v[56:57], v[36:39]
s_nop 1
v_mfma_f32_4x4x4_16b_bf16 v[32:35], v[42:43], v[60:61], v[32:35]
v_mfma_f32_4x4x4_16b_bf16 v[36:39], v[42:43], v[62:63], v[36:39]
s_branch L_pvdone
L_att:
s_mul_i32 s32, s27, 8192
s_add_u32 s32, s32, 786432
s_lshl_b32 s33, s24, 8
s_add_u32 s32, s32, s33
v_and_b32 v60, 15, v0
v_lshlrev_b32 v60, 4, v60
v_add_u32 v60, s32, v60
s_mov_b32 s31, 0
global_load_dwordx4 v[4:7], v60, s[16:17] sc1
s_waitcnt vmcnt(0)
s_branch L_fc_24
L_fp_21:
s_waitcnt vmcnt(5)
global_load_dwordx4 v[4:7], v60, s[16:17] sc1
L_fc_24:
v_max_u32 v58, v4, v5
v_max3_u32 v58, v58, v6, v7
v_cmp_eq_u32 vcc, -1, v58
s_nop 1
s_cmp_lg_u64 vcc, 0
s_cbranch_scc1 L_fa_22
s_branch L_fd_23
L_fa_22:
s_add_u32 s31, s31, 1
s_cmp_ge_u32 s31, 1600000
s_cbranch_scc1 L_fd_23
s_and_b32 s32, s31, 7
s_cmp_eq_u32 s32, 0
s_cbranch_scc1 L_fp_21
s_branch L_fc_24
L_fd_23:
L_qk:
v_lshlrev_b32 v61, 4, v0
v_add_u32 v61, s54, v61
s_cmp_eq_u32 s27, 1
s_cbranch_scc0 L_nqc_25
s_cmp_eq_u32 s59, 0
s_cbranch_scc0 L_nqc_25
ds_read_b128 v[32:35], v61 offset:0
ds_read_b128 v[36:39], v61 offset:1024
ds_read_b128 v[40:43], v61 offset:2048
ds_read_b128 v[44:47], v61 offset:3072
v_dot2_f32_bf16 v48, v64, v4, 0
v_dot2_f32_bf16 v49, v68, v4, 0
v_dot2_f32_bf16 v50, v72, v4, 0
v_dot2_f32_bf16 v51, v76, v4, 0
v_dot2c_f32_bf16 v48, v65, v5
v_dot2c_f32_bf16 v49, v69, v5
v_dot2c_f32_bf16 v50, v73, v5
v_dot2c_f32_bf16 v51, v77, v5
v_dot2c_f32_bf16 v48, v66, v6
v_dot2c_f32_bf16 v49, v70, v6
v_dot2c_f32_bf16 v50, v74, v6
v_dot2c_f32_bf16 v51, v78, v6
v_dot2c_f32_bf16 v48, v67, v7
v_dot2c_f32_bf16 v49, v71, v7
v_dot2c_f32_bf16 v50, v75, v7
v_dot2c_f32_bf16 v51, v79, v7
s_mov_b32 s30, 0x4000000
buffer_load_dwordx4 v[64:67], v1, s[4:7], s30 offen nt
s_mov_b32 s30, 0x4001000
buffer_load_dwordx4 v[68:71], v1, s[4:7], s30 offen nt
s_mov_b32 s30, 0x4002000
buffer_load_dwordx4 v[72:75], v1, s[4:7], s30 offen nt
s_mov_b32 s30, 0x4003000
buffer_load_dwordx4 v[76:79], v1, s[4:7], s30 offen nt
v_dot2_f32_bf16 v52, v80, v4, 0
v_dot2_f32_bf16 v53, v84, v4, 0
v_add_f32_dpp v56, v48, v48 row_ror:8 row_mask:0xf bank_mask:0x3
v_dot2_f32_bf16 v54, v88, v4, 0
v_dot2_f32_bf16 v55, v92, v4, 0
v_add_f32_dpp v57, v49, v49 row_ror:8 row_mask:0xf bank_mask:0x3
v_dot2c_f32_bf16 v52, v81, v5
v_dot2c_f32_bf16 v53, v85, v5
v_add_f32_dpp v56, v50, v50 row_ror:8 row_mask:0xf bank_mask:0xc
v_dot2c_f32_bf16 v54, v89, v5
v_dot2c_f32_bf16 v55, v93, v5
v_add_f32_dpp v57, v51, v51 row_ror:8 row_mask:0xf bank_mask:0xc
v_dot2c_f32_bf16 v52, v82, v6
v_dot2c_f32_bf16 v53, v86, v6
v_add_f32_dpp v16, v56, v56 row_shl:4 row_mask:0xf bank_mask:0x5
v_dot2c_f32_bf16 v54, v90, v6
v_dot2c_f32_bf16 v55, v94, v6
v_add_f32_dpp v16, v57, v57 row_shr:4 row_mask:0xf bank_mask:0xa
v_dot2c_f32_bf16 v52, v83, v7
v_dot2c_f32_bf16 v53, v87, v7
v_add_f32_dpp v16, v16, v16 quad_perm:[1,0,3,2] row_mask:0xf bank_mask:0xf
v_dot2c_f32_bf16 v54, v91, v7
v_dot2c_f32_bf16 v55, v95, v7
v_add_f32_dpp v16, v16, v16 quad_perm:[2,3,0,1] row_mask:0xf bank_mask:0xf
s_mov_b32 s30, 0x4004000
buffer_load_dwordx4 v[80:83], v1, s[4:7], s30 offen nt
s_mov_b32 s30, 0x4005000
buffer_load_dwordx4 v[84:87], v1, s[4:7], s30 offen nt
s_mov_b32 s30, 0x4006000
buffer_load_dwordx4 v[88:91], v1, s[4:7], s30 offen nt
s_mov_b32 s30, 0x4007000
buffer_load_dwordx4 v[92:95], v1, s[4:7], s30 offen nt
v_dot2_f32_bf16 v48, v96, v4, 0
v_dot2_f32_bf16 v49, v100, v4, 0
v_add_f32_dpp v56, v52, v52 row_ror:8 row_mask:0xf bank_mask:0x3
v_dot2_f32_bf16 v50, v104, v4, 0
v_dot2_f32_bf16 v51, v108, v4, 0
v_add_f32_dpp v57, v53, v53 row_ror:8 row_mask:0xf bank_mask:0x3
v_dot2c_f32_bf16 v48, v97, v5
v_dot2c_f32_bf16 v49, v101, v5
v_add_f32_dpp v56, v54, v54 row_ror:8 row_mask:0xf bank_mask:0xc
v_dot2c_f32_bf16 v50, v105, v5
v_dot2c_f32_bf16 v51, v109, v5
v_add_f32_dpp v57, v55, v55 row_ror:8 row_mask:0xf bank_mask:0xc
v_dot2c_f32_bf16 v48, v98, v6
v_dot2c_f32_bf16 v49, v102, v6
v_add_f32_dpp v17, v56, v56 row_shl:4 row_mask:0xf bank_mask:0x5
v_dot2c_f32_bf16 v50, v106, v6
v_dot2c_f32_bf16 v51, v110, v6
v_add_f32_dpp v17, v57, v57 row_shr:4 row_mask:0xf bank_mask:0xa
v_dot2c_f32_bf16 v48, v99, v7
v_dot2c_f32_bf16 v49, v103, v7
v_add_f32_dpp v17, v17, v17 quad_perm:[1,0,3,2] row_mask:0xf bank_mask:0xf
v_dot2c_f32_bf16 v50, v107, v7
v_dot2c_f32_bf16 v51, v111, v7
v_add_f32_dpp v17, v17, v17 quad_perm:[2,3,0,1] row_mask:0xf bank_mask:0xf
s_mov_b32 s30, 0x4008000
buffer_load_dwordx4 v[96:99], v1, s[4:7], s30 offen nt
s_mov_b32 s30, 0x4009000
buffer_load_dwordx4 v[100:103], v1, s[4:7], s30 offen nt
s_mov_b32 s30, 0x400a000
buffer_load_dwordx4 v[104:107], v1, s[4:7], s30 offen nt
s_mov_b32 s30, 0x400b000
buffer_load_dwordx4 v[108:111], v1, s[4:7], s30 offen nt
s_waitcnt lgkmcnt(0)
v_dot2_f32_bf16 v52, v32, v4, 0
v_dot2_f32_bf16 v53, v36, v4, 0
v_add_f32_dpp v56, v48, v48 row_ror:8 row_mask:0xf bank_mask:0x3
v_dot2_f32_bf16 v54, v40, v4, 0
v_dot2_f32_bf16 v55, v44, v4, 0
v_add_f32_dpp v57, v49, v49 row_ror:8 row_mask:0xf bank_mask:0x3
v_dot2c_f32_bf16 v52, v33, v5
v_dot2c_f32_bf16 v53, v37, v5
v_add_f32_dpp v56, v50, v50 row_ror:8 row_mask:0xf bank_mask:0xc
v_dot2c_f32_bf16 v54, v41, v5
v_dot2c_f32_bf16 v55, v45, v5
v_add_f32_dpp v57, v51, v51 row_ror:8 row_mask:0xf bank_mask:0xc
v_dot2c_f32_bf16 v52, v34, v6
v_dot2c_f32_bf16 v53, v38, v6
v_add_f32_dpp v18, v56, v56 row_shl:4 row_mask:0xf bank_mask:0x5
v_dot2c_f32_bf16 v54, v42, v6
v_dot2c_f32_bf16 v55, v46, v6
v_add_f32_dpp v18, v57, v57 row_shr:4 row_mask:0xf bank_mask:0xa
v_dot2c_f32_bf16 v52, v35, v7
v_dot2c_f32_bf16 v53, v39, v7
v_add_f32_dpp v18, v18, v18 quad_perm:[1,0,3,2] row_mask:0xf bank_mask:0xf
v_dot2c_f32_bf16 v54, v43, v7
v_dot2c_f32_bf16 v55, v47, v7
v_add_f32_dpp v18, v18, v18 quad_perm:[2,3,0,1] row_mask:0xf bank_mask:0xf
ds_read_b128 v[32:35], v61 offset:4096
ds_read_b128 v[36:39], v61 offset:5120
ds_read_b128 v[40:43], v61 offset:6144
ds_read_b128 v[44:47], v61 offset:7168
s_mov_b32 s30, 0x4030000
s_add_u32 m0, s54, 0
s_nop 0
buffer_load_dwordx4 v1, s[4:7], s30 offen nt lds
s_mov_b32 s30, 0x4031000
s_add_u32 m0, s54, 1024
s_nop 0
buffer_load_dwordx4 v1, s[4:7], s30 offen nt lds
s_mov_b32 s30, 0x4032000
s_add_u32 m0, s54, 2048
s_nop 0
buffer_load_dwordx4 v1, s[4:7], s30 offen nt lds
s_mov_b32 s30, 0x4033000
s_add_u32 m0, s54, 3072
s_nop 0
buffer_load_dwordx4 v1, s[4:7], s30 offen nt lds
v_dot2_f32_bf16 v48, v112, v4, 0
v_dot2_f32_bf16 v49, v116, v4, 0
v_add_f32_dpp v56, v52, v52 row_ror:8 row_mask:0xf bank_mask:0x3
v_dot2_f32_bf16 v50, v120, v4, 0
v_dot2_f32_bf16 v51, v124, v4, 0
v_add_f32_dpp v57, v53, v53 row_ror:8 row_mask:0xf bank_mask:0x3
v_dot2c_f32_bf16 v48, v113, v5
v_dot2c_f32_bf16 v49, v117, v5
v_add_f32_dpp v56, v54, v54 row_ror:8 row_mask:0xf bank_mask:0xc
v_dot2c_f32_bf16 v50, v121, v5
v_dot2c_f32_bf16 v51, v125, v5
v_add_f32_dpp v57, v55, v55 row_ror:8 row_mask:0xf bank_mask:0xc
v_dot2c_f32_bf16 v48, v114, v6
v_dot2c_f32_bf16 v49, v118, v6
v_add_f32_dpp v28, v56, v56 row_shl:4 row_mask:0xf bank_mask:0x5
v_dot2c_f32_bf16 v50, v122, v6
v_dot2c_f32_bf16 v51, v126, v6
v_add_f32_dpp v28, v57, v57 row_shr:4 row_mask:0xf bank_mask:0xa
v_dot2c_f32_bf16 v48, v115, v7
v_dot2c_f32_bf16 v49, v119, v7
v_add_f32_dpp v28, v28, v28 quad_perm:[1,0,3,2] row_mask:0xf bank_mask:0xf
v_dot2c_f32_bf16 v50, v123, v7
v_dot2c_f32_bf16 v51, v127, v7
v_add_f32_dpp v28, v28, v28 quad_perm:[2,3,0,1] row_mask:0xf bank_mask:0xf
s_mov_b32 s30, 0x400c000
buffer_load_dwordx4 v[112:115], v1, s[4:7], s30 offen nt
s_mov_b32 s30, 0x400d000
buffer_load_dwordx4 v[116:119], v1, s[4:7], s30 offen nt
s_mov_b32 s30, 0x400e000
buffer_load_dwordx4 v[120:123], v1, s[4:7], s30 offen nt
s_mov_b32 s30, 0x400f000
buffer_load_dwordx4 v[124:127], v1, s[4:7], s30 offen nt
v_dot2_f32_bf16 v52, v128, v4, 0
v_dot2_f32_bf16 v53, v132, v4, 0
v_add_f32_dpp v56, v48, v48 row_ror:8 row_mask:0xf bank_mask:0x3
v_dot2_f32_bf16 v54, v136, v4, 0
v_dot2_f32_bf16 v55, v140, v4, 0
v_add_f32_dpp v57, v49, v49 row_ror:8 row_mask:0xf bank_mask:0x3
v_dot2c_f32_bf16 v52, v129, v5
v_dot2c_f32_bf16 v53, v133, v5
v_add_f32_dpp v56, v50, v50 row_ror:8 row_mask:0xf bank_mask:0xc
v_dot2c_f32_bf16 v54, v137, v5
v_dot2c_f32_bf16 v55, v141, v5
v_add_f32_dpp v57, v51, v51 row_ror:8 row_mask:0xf bank_mask:0xc
v_dot2c_f32_bf16 v52, v130, v6
v_dot2c_f32_bf16 v53, v134, v6
v_add_f32_dpp v19, v56, v56 row_shl:4 row_mask:0xf bank_mask:0x5
v_dot2c_f32_bf16 v54, v138, v6
v_dot2c_f32_bf16 v55, v142, v6
v_add_f32_dpp v19, v57, v57 row_shr:4 row_mask:0xf bank_mask:0xa
v_dot2c_f32_bf16 v52, v131, v7
v_dot2c_f32_bf16 v53, v135, v7
v_add_f32_dpp v19, v19, v19 quad_perm:[1,0,3,2] row_mask:0xf bank_mask:0xf
v_dot2c_f32_bf16 v54, v139, v7
v_dot2c_f32_bf16 v55, v143, v7
v_add_f32_dpp v19, v19, v19 quad_perm:[2,3,0,1] row_mask:0xf bank_mask:0xf
s_mov_b32 s30, 0x4010000
buffer_load_dwordx4 v[128:131], v1, s[4:7], s30 offen nt
s_mov_b32 s30, 0x4011000
buffer_load_dwordx4 v[132:135], v1, s[4:7], s30 offen nt
s_mov_b32 s30, 0x4012000
buffer_load_dwordx4 v[136:139], v1, s[4:7], s30 offen nt
s_mov_b32 s30, 0x4013000
buffer_load_dwordx4 v[140:143], v1, s[4:7], s30 offen nt
v_dot2_f32_bf16 v48, v144, v4, 0
v_dot2_f32_bf16 v49, v148, v4, 0
v_add_f32_dpp v56, v52, v52 row_ror:8 row_mask:0xf bank_mask:0x3
v_dot2_f32_bf16 v50, v152, v4, 0
v_dot2_f32_bf16 v51, v156, v4, 0
v_add_f32_dpp v57, v53, v53 row_ror:8 row_mask:0xf bank_mask:0x3
v_dot2c_f32_bf16 v48, v145, v5
v_dot2c_f32_bf16 v49, v149, v5
v_add_f32_dpp v56, v54, v54 row_ror:8 row_mask:0xf bank_mask:0xc
v_dot2c_f32_bf16 v50, v153, v5
v_dot2c_f32_bf16 v51, v157, v5
v_add_f32_dpp v57, v55, v55 row_ror:8 row_mask:0xf bank_mask:0xc
v_dot2c_f32_bf16 v48, v146, v6
v_dot2c_f32_bf16 v49, v150, v6
v_add_f32_dpp v20, v56, v56 row_shl:4 row_mask:0xf bank_mask:0x5
v_dot2c_f32_bf16 v50, v154, v6
v_dot2c_f32_bf16 v51, v158, v6
v_add_f32_dpp v20, v57, v57 row_shr:4 row_mask:0xf bank_mask:0xa
v_dot2c_f32_bf16 v48, v147, v7
v_dot2c_f32_bf16 v49, v151, v7
v_add_f32_dpp v20, v20, v20 quad_perm:[1,0,3,2] row_mask:0xf bank_mask:0xf
v_dot2c_f32_bf16 v50, v155, v7
v_dot2c_f32_bf16 v51, v159, v7
v_add_f32_dpp v20, v20, v20 quad_perm:[2,3,0,1] row_mask:0xf bank_mask:0xf
s_mov_b32 s30, 0x4014000
buffer_load_dwordx4 v[144:147], v1, s[4:7], s30 offen nt
s_mov_b32 s30, 0x4015000
buffer_load_dwordx4 v[148:151], v1, s[4:7], s30 offen nt
s_mov_b32 s30, 0x4016000
buffer_load_dwordx4 v[152:155], v1, s[4:7], s30 offen nt
s_mov_b32 s30, 0x4017000
buffer_load_dwordx4 v[156:159], v1, s[4:7], s30 offen nt
s_waitcnt lgkmcnt(0)
v_dot2_f32_bf16 v52, v32, v4, 0
v_dot2_f32_bf16 v53, v36, v4, 0
v_add_f32_dpp v56, v48, v48 row_ror:8 row_mask:0xf bank_mask:0x3
v_dot2_f32_bf16 v54, v40, v4, 0
v_dot2_f32_bf16 v55, v44, v4, 0
v_add_f32_dpp v57, v49, v49 row_ror:8 row_mask:0xf bank_mask:0x3
v_dot2c_f32_bf16 v52, v33, v5
v_dot2c_f32_bf16 v53, v37, v5
v_add_f32_dpp v56, v50, v50 row_ror:8 row_mask:0xf bank_mask:0xc
v_dot2c_f32_bf16 v54, v41, v5
v_dot2c_f32_bf16 v55, v45, v5
v_add_f32_dpp v57, v51, v51 row_ror:8 row_mask:0xf bank_mask:0xc
v_dot2c_f32_bf16 v52, v34, v6
v_dot2c_f32_bf16 v53, v38, v6
v_add_f32_dpp v21, v56, v56 row_shl:4 row_mask:0xf bank_mask:0x5
v_dot2c_f32_bf16 v54, v42, v6
v_dot2c_f32_bf16 v55, v46, v6
v_add_f32_dpp v21, v57, v57 row_shr:4 row_mask:0xf bank_mask:0xa
v_dot2c_f32_bf16 v52, v35, v7
v_dot2c_f32_bf16 v53, v39, v7
v_add_f32_dpp v21, v21, v21 quad_perm:[1,0,3,2] row_mask:0xf bank_mask:0xf
v_dot2c_f32_bf16 v54, v43, v7
v_dot2c_f32_bf16 v55, v47, v7
v_add_f32_dpp v21, v21, v21 quad_perm:[2,3,0,1] row_mask:0xf bank_mask:0xf
ds_read_b128 v[32:35], v61 offset:8192
ds_read_b128 v[36:39], v61 offset:9216
ds_read_b128 v[40:43], v61 offset:10240
ds_read_b128 v[44:47], v61 offset:11264
s_mov_b32 s30, 0x4034000
s_add_u32 m0, s54, 4096
s_nop 0
buffer_load_dwordx4 v1, s[4:7], s30 offen nt lds
s_mov_b32 s30, 0x4035000
s_add_u32 m0, s54, 5120
s_nop 0
buffer_load_dwordx4 v1, s[4:7], s30 offen nt lds
s_mov_b32 s30, 0x4036000
s_add_u32 m0, s54, 6144
s_nop 0
buffer_load_dwordx4 v1, s[4:7], s30 offen nt lds
s_mov_b32 s30, 0x4037000
s_add_u32 m0, s54, 7168
s_nop 0
buffer_load_dwordx4 v1, s[4:7], s30 offen nt lds
v_dot2_f32_bf16 v48, v160, v4, 0
v_dot2_f32_bf16 v49, v164, v4, 0
v_add_f32_dpp v56, v52, v52 row_ror:8 row_mask:0xf bank_mask:0x3
v_dot2_f32_bf16 v50, v168, v4, 0
v_dot2_f32_bf16 v51, v172, v4, 0
v_add_f32_dpp v57, v53, v53 row_ror:8 row_mask:0xf bank_mask:0x3
v_dot2c_f32_bf16 v48, v161, v5
v_dot2c_f32_bf16 v49, v165, v5
v_add_f32_dpp v56, v54, v54 row_ror:8 row_mask:0xf bank_mask:0xc
v_dot2c_f32_bf16 v50, v169, v5
v_dot2c_f32_bf16 v51, v173, v5
v_add_f32_dpp v57, v55, v55 row_ror:8 row_mask:0xf bank_mask:0xc
v_dot2c_f32_bf16 v48, v162, v6
v_dot2c_f32_bf16 v49, v166, v6
v_add_f32_dpp v29, v56, v56 row_shl:4 row_mask:0xf bank_mask:0x5
v_dot2c_f32_bf16 v50, v170, v6
v_dot2c_f32_bf16 v51, v174, v6
v_add_f32_dpp v29, v57, v57 row_shr:4 row_mask:0xf bank_mask:0xa
v_dot2c_f32_bf16 v48, v163, v7
v_dot2c_f32_bf16 v49, v167, v7
v_add_f32_dpp v29, v29, v29 quad_perm:[1,0,3,2] row_mask:0xf bank_mask:0xf
v_dot2c_f32_bf16 v50, v171, v7
v_dot2c_f32_bf16 v51, v175, v7
v_add_f32_dpp v29, v29, v29 quad_perm:[2,3,0,1] row_mask:0xf bank_mask:0xf
s_mov_b32 s30, 0x4018000
buffer_load_dwordx4 v[160:163], v1, s[4:7], s30 offen nt
s_mov_b32 s30, 0x4019000
buffer_load_dwordx4 v[164:167], v1, s[4:7], s30 offen nt
s_mov_b32 s30, 0x401a000
buffer_load_dwordx4 v[168:171], v1, s[4:7], s30 offen nt
s_mov_b32 s30, 0x401b000
buffer_load_dwordx4 v[172:175], v1, s[4:7], s30 offen nt
v_dot2_f32_bf16 v52, v176, v4, 0
v_dot2_f32_bf16 v53, v180, v4, 0
v_add_f32_dpp v56, v48, v48 row_ror:8 row_mask:0xf bank_mask:0x3
v_dot2_f32_bf16 v54, v184, v4, 0
v_dot2_f32_bf16 v55, v188, v4, 0
v_add_f32_dpp v57, v49, v49 row_ror:8 row_mask:0xf bank_mask:0x3
v_dot2c_f32_bf16 v52, v177, v5
v_dot2c_f32_bf16 v53, v181, v5
v_add_f32_dpp v56, v50, v50 row_ror:8 row_mask:0xf bank_mask:0xc
v_dot2c_f32_bf16 v54, v185, v5
v_dot2c_f32_bf16 v55, v189, v5
v_add_f32_dpp v57, v51, v51 row_ror:8 row_mask:0xf bank_mask:0xc
v_dot2c_f32_bf16 v52, v178, v6
v_dot2c_f32_bf16 v53, v182, v6
v_add_f32_dpp v22, v56, v56 row_shl:4 row_mask:0xf bank_mask:0x5
v_dot2c_f32_bf16 v54, v186, v6
v_dot2c_f32_bf16 v55, v190, v6
v_add_f32_dpp v22, v57, v57 row_shr:4 row_mask:0xf bank_mask:0xa
v_dot2c_f32_bf16 v52, v179, v7
v_dot2c_f32_bf16 v53, v183, v7
v_add_f32_dpp v22, v22, v22 quad_perm:[1,0,3,2] row_mask:0xf bank_mask:0xf
v_dot2c_f32_bf16 v54, v187, v7
v_dot2c_f32_bf16 v55, v191, v7
v_add_f32_dpp v22, v22, v22 quad_perm:[2,3,0,1] row_mask:0xf bank_mask:0xf
s_mov_b32 s30, 0x401c000
buffer_load_dwordx4 v[176:179], v1, s[4:7], s30 offen nt
s_mov_b32 s30, 0x401d000
buffer_load_dwordx4 v[180:183], v1, s[4:7], s30 offen nt
s_mov_b32 s30, 0x401e000
buffer_load_dwordx4 v[184:187], v1, s[4:7], s30 offen nt
s_mov_b32 s30, 0x401f000
buffer_load_dwordx4 v[188:191], v1, s[4:7], s30 offen nt
v_dot2_f32_bf16 v48, v192, v4, 0
v_dot2_f32_bf16 v49, v196, v4, 0
v_add_f32_dpp v56, v52, v52 row_ror:8 row_mask:0xf bank_mask:0x3
v_dot2_f32_bf16 v50, v200, v4, 0
v_dot2_f32_bf16 v51, v204, v4, 0
v_add_f32_dpp v57, v53, v53 row_ror:8 row_mask:0xf bank_mask:0x3
v_dot2c_f32_bf16 v48, v193, v5
v_dot2c_f32_bf16 v49, v197, v5
v_add_f32_dpp v56, v54, v54 row_ror:8 row_mask:0xf bank_mask:0xc
v_dot2c_f32_bf16 v50, v201, v5
v_dot2c_f32_bf16 v51, v205, v5
v_add_f32_dpp v57, v55, v55 row_ror:8 row_mask:0xf bank_mask:0xc
v_dot2c_f32_bf16 v48, v194, v6
v_dot2c_f32_bf16 v49, v198, v6
v_add_f32_dpp v23, v56, v56 row_shl:4 row_mask:0xf bank_mask:0x5
v_dot2c_f32_bf16 v50, v202, v6
v_dot2c_f32_bf16 v51, v206, v6
v_add_f32_dpp v23, v57, v57 row_shr:4 row_mask:0xf bank_mask:0xa
v_dot2c_f32_bf16 v48, v195, v7
v_dot2c_f32_bf16 v49, v199, v7
v_add_f32_dpp v23, v23, v23 quad_perm:[1,0,3,2] row_mask:0xf bank_mask:0xf
v_dot2c_f32_bf16 v50, v203, v7
v_dot2c_f32_bf16 v51, v207, v7
v_add_f32_dpp v23, v23, v23 quad_perm:[2,3,0,1] row_mask:0xf bank_mask:0xf
s_mov_b32 s30, 0x4020000
buffer_load_dwordx4 v[192:195], v1, s[4:7], s30 offen nt
s_mov_b32 s30, 0x4021000
buffer_load_dwordx4 v[196:199], v1, s[4:7], s30 offen nt
s_mov_b32 s30, 0x4022000
buffer_load_dwordx4 v[200:203], v1, s[4:7], s30 offen nt
s_mov_b32 s30, 0x4023000
buffer_load_dwordx4 v[204:207], v1, s[4:7], s30 offen nt
s_waitcnt lgkmcnt(0)
v_dot2_f32_bf16 v52, v32, v4, 0
v_dot2_f32_bf16 v53, v36, v4, 0
v_add_f32_dpp v56, v48, v48 row_ror:8 row_mask:0xf bank_mask:0x3
v_dot2_f32_bf16 v54, v40, v4, 0
v_dot2_f32_bf16 v55, v44, v4, 0
v_add_f32_dpp v57, v49, v49 row_ror:8 row_mask:0xf bank_mask:0x3
v_dot2c_f32_bf16 v52, v33, v5
v_dot2c_f32_bf16 v53, v37, v5
v_add_f32_dpp v56, v50, v50 row_ror:8 row_mask:0xf bank_mask:0xc
v_dot2c_f32_bf16 v54, v41, v5
v_dot2c_f32_bf16 v55, v45, v5
v_add_f32_dpp v57, v51, v51 row_ror:8 row_mask:0xf bank_mask:0xc
v_dot2c_f32_bf16 v52, v34, v6
v_dot2c_f32_bf16 v53, v38, v6
v_add_f32_dpp v24, v56, v56 row_shl:4 row_mask:0xf bank_mask:0x5
v_dot2c_f32_bf16 v54, v42, v6
v_dot2c_f32_bf16 v55, v46, v6
v_add_f32_dpp v24, v57, v57 row_shr:4 row_mask:0xf bank_mask:0xa
v_dot2c_f32_bf16 v52, v35, v7
v_dot2c_f32_bf16 v53, v39, v7
v_add_f32_dpp v24, v24, v24 quad_perm:[1,0,3,2] row_mask:0xf bank_mask:0xf
v_dot2c_f32_bf16 v54, v43, v7
v_dot2c_f32_bf16 v55, v47, v7
v_add_f32_dpp v24, v24, v24 quad_perm:[2,3,0,1] row_mask:0xf bank_mask:0xf
ds_read_b128 v[32:35], v61 offset:12288
ds_read_b128 v[36:39], v61 offset:13312
ds_read_b128 v[40:43], v61 offset:14336
ds_read_b128 v[44:47], v61 offset:15360
s_mov_b32 s30, 0x4038000
s_add_u32 m0, s54, 8192
s_nop 0
buffer_load_dwordx4 v1, s[4:7], s30 offen nt lds
s_mov_b32 s30, 0x4039000
s_add_u32 m0, s54, 9216
s_nop 0
buffer_load_dwordx4 v1, s[4:7], s30 offen nt lds
s_mov_b32 s30, 0x403a000
s_add_u32 m0, s54, 10240
s_nop 0
buffer_load_dwordx4 v1, s[4:7], s30 offen nt lds
s_mov_b32 s30, 0x403b000
s_add_u32 m0, s54, 11264
s_nop 0
buffer_load_dwordx4 v1, s[4:7], s30 offen nt lds
v_dot2_f32_bf16 v48, v208, v4, 0
v_dot2_f32_bf16 v49, v212, v4, 0
v_add_f32_dpp v56, v52, v52 row_ror:8 row_mask:0xf bank_mask:0x3
v_dot2_f32_bf16 v50, v216, v4, 0
v_dot2_f32_bf16 v51, v220, v4, 0
v_add_f32_dpp v57, v53, v53 row_ror:8 row_mask:0xf bank_mask:0x3
v_dot2c_f32_bf16 v48, v209, v5
v_dot2c_f32_bf16 v49, v213, v5
v_add_f32_dpp v56, v54, v54 row_ror:8 row_mask:0xf bank_mask:0xc
v_dot2c_f32_bf16 v50, v217, v5
v_dot2c_f32_bf16 v51, v221, v5
v_add_f32_dpp v57, v55, v55 row_ror:8 row_mask:0xf bank_mask:0xc
v_dot2c_f32_bf16 v48, v210, v6
v_dot2c_f32_bf16 v49, v214, v6
v_add_f32_dpp v30, v56, v56 row_shl:4 row_mask:0xf bank_mask:0x5
v_dot2c_f32_bf16 v50, v218, v6
v_dot2c_f32_bf16 v51, v222, v6
v_add_f32_dpp v30, v57, v57 row_shr:4 row_mask:0xf bank_mask:0xa
v_dot2c_f32_bf16 v48, v211, v7
v_dot2c_f32_bf16 v49, v215, v7
v_add_f32_dpp v30, v30, v30 quad_perm:[1,0,3,2] row_mask:0xf bank_mask:0xf
v_dot2c_f32_bf16 v50, v219, v7
v_dot2c_f32_bf16 v51, v223, v7
v_add_f32_dpp v30, v30, v30 quad_perm:[2,3,0,1] row_mask:0xf bank_mask:0xf
s_mov_b32 s30, 0x4024000
buffer_load_dwordx4 v[208:211], v1, s[4:7], s30 offen nt
s_mov_b32 s30, 0x4025000
buffer_load_dwordx4 v[212:215], v1, s[4:7], s30 offen nt
s_mov_b32 s30, 0x4026000
buffer_load_dwordx4 v[216:219], v1, s[4:7], s30 offen nt
s_mov_b32 s30, 0x4027000
buffer_load_dwordx4 v[220:223], v1, s[4:7], s30 offen nt
v_dot2_f32_bf16 v52, v224, v4, 0
v_dot2_f32_bf16 v53, v228, v4, 0
v_add_f32_dpp v56, v48, v48 row_ror:8 row_mask:0xf bank_mask:0x3
v_dot2_f32_bf16 v54, v232, v4, 0
v_dot2_f32_bf16 v55, v236, v4, 0
v_add_f32_dpp v57, v49, v49 row_ror:8 row_mask:0xf bank_mask:0x3
v_dot2c_f32_bf16 v52, v225, v5
v_dot2c_f32_bf16 v53, v229, v5
v_add_f32_dpp v56, v50, v50 row_ror:8 row_mask:0xf bank_mask:0xc
v_dot2c_f32_bf16 v54, v233, v5
v_dot2c_f32_bf16 v55, v237, v5
v_add_f32_dpp v57, v51, v51 row_ror:8 row_mask:0xf bank_mask:0xc
v_dot2c_f32_bf16 v52, v226, v6
v_dot2c_f32_bf16 v53, v230, v6
v_add_f32_dpp v25, v56, v56 row_shl:4 row_mask:0xf bank_mask:0x5
v_dot2c_f32_bf16 v54, v234, v6
v_dot2c_f32_bf16 v55, v238, v6
v_add_f32_dpp v25, v57, v57 row_shr:4 row_mask:0xf bank_mask:0xa
v_dot2c_f32_bf16 v52, v227, v7
v_dot2c_f32_bf16 v53, v231, v7
v_add_f32_dpp v25, v25, v25 quad_perm:[1,0,3,2] row_mask:0xf bank_mask:0xf
v_dot2c_f32_bf16 v54, v235, v7
v_dot2c_f32_bf16 v55, v239, v7
v_add_f32_dpp v25, v25, v25 quad_perm:[2,3,0,1] row_mask:0xf bank_mask:0xf
s_waitcnt vmcnt(58)
s_mov_b32 s30, 0x4028000
buffer_load_dwordx4 v[224:227], v1, s[4:7], s30 offen nt
s_mov_b32 s30, 0x4029000
buffer_load_dwordx4 v[228:231], v1, s[4:7], s30 offen nt
s_mov_b32 s30, 0x402a000
buffer_load_dwordx4 v[232:235], v1, s[4:7], s30 offen nt
s_mov_b32 s30, 0x402b000
buffer_load_dwordx4 v[236:239], v1, s[4:7], s30 offen nt
v_dot2_f32_bf16 v48, v240, v4, 0
v_dot2_f32_bf16 v49, v244, v4, 0
v_add_f32_dpp v56, v52, v52 row_ror:8 row_mask:0xf bank_mask:0x3
v_dot2_f32_bf16 v50, v248, v4, 0
v_dot2_f32_bf16 v51, v252, v4, 0
v_add_f32_dpp v57, v53, v53 row_ror:8 row_mask:0xf bank_mask:0x3
v_dot2c_f32_bf16 v48, v241, v5
v_dot2c_f32_bf16 v49, v245, v5
v_add_f32_dpp v56, v54, v54 row_ror:8 row_mask:0xf bank_mask:0xc
v_dot2c_f32_bf16 v50, v249, v5
v_dot2c_f32_bf16 v51, v253, v5
v_add_f32_dpp v57, v55, v55 row_ror:8 row_mask:0xf bank_mask:0xc
v_dot2c_f32_bf16 v48, v242, v6
v_dot2c_f32_bf16 v49, v246, v6
v_add_f32_dpp v26, v56, v56 row_shl:4 row_mask:0xf bank_mask:0x5
v_dot2c_f32_bf16 v50, v250, v6
v_dot2c_f32_bf16 v51, v254, v6
v_add_f32_dpp v26, v57, v57 row_shr:4 row_mask:0xf bank_mask:0xa
v_dot2c_f32_bf16 v48, v243, v7
v_dot2c_f32_bf16 v49, v247, v7
v_add_f32_dpp v26, v26, v26 quad_perm:[1,0,3,2] row_mask:0xf bank_mask:0xf
v_dot2c_f32_bf16 v50, v251, v7
v_dot2c_f32_bf16 v51, v255, v7
v_add_f32_dpp v26, v26, v26 quad_perm:[2,3,0,1] row_mask:0xf bank_mask:0xf
s_waitcnt vmcnt(58)
s_mov_b32 s30, 0x402c000
buffer_load_dwordx4 v[240:243], v1, s[4:7], s30 offen nt
s_mov_b32 s30, 0x402d000
buffer_load_dwordx4 v[244:247], v1, s[4:7], s30 offen nt
s_mov_b32 s30, 0x402e000
buffer_load_dwordx4 v[248:251], v1, s[4:7], s30 offen nt
s_mov_b32 s30, 0x402f000
buffer_load_dwordx4 v[252:255], v1, s[4:7], s30 offen nt
s_waitcnt lgkmcnt(0)
v_dot2_f32_bf16 v52, v32, v4, 0
v_dot2_f32_bf16 v53, v36, v4, 0
v_add_f32_dpp v56, v48, v48 row_ror:8 row_mask:0xf bank_mask:0x3
v_dot2_f32_bf16 v54, v40, v4, 0
v_dot2_f32_bf16 v55, v44, v4, 0
v_add_f32_dpp v57, v49, v49 row_ror:8 row_mask:0xf bank_mask:0x3
v_dot2c_f32_bf16 v52, v33, v5
v_dot2c_f32_bf16 v53, v37, v5
v_add_f32_dpp v56, v50, v50 row_ror:8 row_mask:0xf bank_mask:0xc
v_dot2c_f32_bf16 v54, v41, v5
v_dot2c_f32_bf16 v55, v45, v5
v_add_f32_dpp v57, v51, v51 row_ror:8 row_mask:0xf bank_mask:0xc
v_dot2c_f32_bf16 v52, v34, v6
v_dot2c_f32_bf16 v53, v38, v6
v_add_f32_dpp v27, v56, v56 row_shl:4 row_mask:0xf bank_mask:0x5
v_dot2c_f32_bf16 v54, v42, v6
v_dot2c_f32_bf16 v55, v46, v6
v_add_f32_dpp v27, v57, v57 row_shr:4 row_mask:0xf bank_mask:0xa
v_dot2c_f32_bf16 v52, v35, v7
v_dot2c_f32_bf16 v53, v39, v7
v_add_f32_dpp v27, v27, v27 quad_perm:[1,0,3,2] row_mask:0xf bank_mask:0xf
v_dot2c_f32_bf16 v54, v43, v7
v_dot2c_f32_bf16 v55, v47, v7
v_add_f32_dpp v27, v27, v27 quad_perm:[2,3,0,1] row_mask:0xf bank_mask:0xf
s_waitcnt vmcnt(58)
s_mov_b32 s30, 0x403c000
s_add_u32 m0, s54, 12288
s_nop 0
buffer_load_dwordx4 v1, s[4:7], s30 offen nt lds
s_mov_b32 s30, 0x403d000
s_add_u32 m0, s54, 13312
s_nop 0
buffer_load_dwordx4 v1, s[4:7], s30 offen nt lds
s_mov_b32 s30, 0x403e000
s_add_u32 m0, s54, 14336
s_nop 0
buffer_load_dwordx4 v1, s[4:7], s30 offen nt lds
s_mov_b32 s30, 0x403f000
s_add_u32 m0, s54, 15360
s_nop 0
buffer_load_dwordx4 v1, s[4:7], s30 offen nt lds
s_nop 2
v_add_f32_dpp v56, v52, v52 row_ror:8 row_mask:0xf bank_mask:0x3
v_add_f32_dpp v57, v53, v53 row_ror:8 row_mask:0xf bank_mask:0x3
s_nop 0
v_add_f32_dpp v56, v54, v54 row_ror:8 row_mask:0xf bank_mask:0xc
v_add_f32_dpp v57, v55, v55 row_ror:8 row_mask:0xf bank_mask:0xc
s_nop 1
v_add_f32_dpp v31, v56, v56 row_shl:4 row_mask:0xf bank_mask:0x5
s_nop 1
v_add_f32_dpp v31, v57, v57 row_shr:4 row_mask:0xf bank_mask:0xa
s_nop 1
v_add_f32_dpp v31, v31, v31 quad_perm:[1,0,3,2] row_mask:0xf bank_mask:0xf
s_nop 1
v_add_f32_dpp v31, v31, v31 quad_perm:[2,3,0,1] row_mask:0xf bank_mask:0xf
s_nop 1
s_mov_b32 s55, 0x4000000
s_mov_b32 s57, 1
s_branch L_softmax
L_nqc_25:
ds_read_b128 v[32:35], v61 offset:0
ds_read_b128 v[36:39], v61 offset:1024
ds_read_b128 v[40:43], v61 offset:2048
ds_read_b128 v[44:47], v61 offset:3072
v_dot2_f32_bf16 v48, v64, v4, 0
v_dot2_f32_bf16 v49, v68, v4, 0
v_dot2_f32_bf16 v50, v72, v4, 0
v_dot2_f32_bf16 v51, v76, v4, 0
v_dot2c_f32_bf16 v48, v65, v5
v_dot2c_f32_bf16 v49, v69, v5
v_dot2c_f32_bf16 v50, v73, v5
v_dot2c_f32_bf16 v51, v77, v5
v_dot2c_f32_bf16 v48, v66, v6
v_dot2c_f32_bf16 v49, v70, v6
v_dot2c_f32_bf16 v50, v74, v6
v_dot2c_f32_bf16 v51, v78, v6
v_dot2c_f32_bf16 v48, v67, v7
v_dot2c_f32_bf16 v49, v71, v7
v_dot2c_f32_bf16 v50, v75, v7
v_dot2c_f32_bf16 v51, v79, v7
v_dot2_f32_bf16 v52, v80, v4, 0
v_dot2_f32_bf16 v53, v84, v4, 0
v_add_f32_dpp v56, v48, v48 row_ror:8 row_mask:0xf bank_mask:0x3
v_dot2_f32_bf16 v54, v88, v4, 0
v_dot2_f32_bf16 v55, v92, v4, 0
v_add_f32_dpp v57, v49, v49 row_ror:8 row_mask:0xf bank_mask:0x3
v_dot2c_f32_bf16 v52, v81, v5
v_dot2c_f32_bf16 v53, v85, v5
v_add_f32_dpp v56, v50, v50 row_ror:8 row_mask:0xf bank_mask:0xc
v_dot2c_f32_bf16 v54, v89, v5
v_dot2c_f32_bf16 v55, v93, v5
v_add_f32_dpp v57, v51, v51 row_ror:8 row_mask:0xf bank_mask:0xc
v_dot2c_f32_bf16 v52, v82, v6
v_dot2c_f32_bf16 v53, v86, v6
v_add_f32_dpp v16, v56, v56 row_shl:4 row_mask:0xf bank_mask:0x5
v_dot2c_f32_bf16 v54, v90, v6
v_dot2c_f32_bf16 v55, v94, v6
v_add_f32_dpp v16, v57, v57 row_shr:4 row_mask:0xf bank_mask:0xa
v_dot2c_f32_bf16 v52, v83, v7
v_dot2c_f32_bf16 v53, v87, v7
v_add_f32_dpp v16, v16, v16 quad_perm:[1,0,3,2] row_mask:0xf bank_mask:0xf
v_dot2c_f32_bf16 v54, v91, v7
v_dot2c_f32_bf16 v55, v95, v7
v_add_f32_dpp v16, v16, v16 quad_perm:[2,3,0,1] row_mask:0xf bank_mask:0xf
v_dot2_f32_bf16 v48, v96, v4, 0
v_dot2_f32_bf16 v49, v100, v4, 0
v_add_f32_dpp v56, v52, v52 row_ror:8 row_mask:0xf bank_mask:0x3
v_dot2_f32_bf16 v50, v104, v4, 0
v_dot2_f32_bf16 v51, v108, v4, 0
v_add_f32_dpp v57, v53, v53 row_ror:8 row_mask:0xf bank_mask:0x3
v_dot2c_f32_bf16 v48, v97, v5
v_dot2c_f32_bf16 v49, v101, v5
v_add_f32_dpp v56, v54, v54 row_ror:8 row_mask:0xf bank_mask:0xc
v_dot2c_f32_bf16 v50, v105, v5
v_dot2c_f32_bf16 v51, v109, v5
v_add_f32_dpp v57, v55, v55 row_ror:8 row_mask:0xf bank_mask:0xc
v_dot2c_f32_bf16 v48, v98, v6
v_dot2c_f32_bf16 v49, v102, v6
v_add_f32_dpp v17, v56, v56 row_shl:4 row_mask:0xf bank_mask:0x5
v_dot2c_f32_bf16 v50, v106, v6
v_dot2c_f32_bf16 v51, v110, v6
v_add_f32_dpp v17, v57, v57 row_shr:4 row_mask:0xf bank_mask:0xa
v_dot2c_f32_bf16 v48, v99, v7
v_dot2c_f32_bf16 v49, v103, v7
v_add_f32_dpp v17, v17, v17 quad_perm:[1,0,3,2] row_mask:0xf bank_mask:0xf
v_dot2c_f32_bf16 v50, v107, v7
v_dot2c_f32_bf16 v51, v111, v7
v_add_f32_dpp v17, v17, v17 quad_perm:[2,3,0,1] row_mask:0xf bank_mask:0xf
s_waitcnt lgkmcnt(0)
v_dot2_f32_bf16 v52, v32, v4, 0
v_dot2_f32_bf16 v53, v36, v4, 0
v_add_f32_dpp v56, v48, v48 row_ror:8 row_mask:0xf bank_mask:0x3
v_dot2_f32_bf16 v54, v40, v4, 0
v_dot2_f32_bf16 v55, v44, v4, 0
v_add_f32_dpp v57, v49, v49 row_ror:8 row_mask:0xf bank_mask:0x3
v_dot2c_f32_bf16 v52, v33, v5
v_dot2c_f32_bf16 v53, v37, v5
v_add_f32_dpp v56, v50, v50 row_ror:8 row_mask:0xf bank_mask:0xc
v_dot2c_f32_bf16 v54, v41, v5
v_dot2c_f32_bf16 v55, v45, v5
v_add_f32_dpp v57, v51, v51 row_ror:8 row_mask:0xf bank_mask:0xc
v_dot2c_f32_bf16 v52, v34, v6
v_dot2c_f32_bf16 v53, v38, v6
v_add_f32_dpp v18, v56, v56 row_shl:4 row_mask:0xf bank_mask:0x5
v_dot2c_f32_bf16 v54, v42, v6
v_dot2c_f32_bf16 v55, v46, v6
v_add_f32_dpp v18, v57, v57 row_shr:4 row_mask:0xf bank_mask:0xa
v_dot2c_f32_bf16 v52, v35, v7
v_dot2c_f32_bf16 v53, v39, v7
v_add_f32_dpp v18, v18, v18 quad_perm:[1,0,3,2] row_mask:0xf bank_mask:0xf
v_dot2c_f32_bf16 v54, v43, v7
v_dot2c_f32_bf16 v55, v47, v7
v_add_f32_dpp v18, v18, v18 quad_perm:[2,3,0,1] row_mask:0xf bank_mask:0xf
ds_read_b128 v[32:35], v61 offset:4096
ds_read_b128 v[36:39], v61 offset:5120
ds_read_b128 v[40:43], v61 offset:6144
ds_read_b128 v[44:47], v61 offset:7168
v_dot2_f32_bf16 v48, v112, v4, 0
v_dot2_f32_bf16 v49, v116, v4, 0
v_add_f32_dpp v56, v52, v52 row_ror:8 row_mask:0xf bank_mask:0x3
v_dot2_f32_bf16 v50, v120, v4, 0
v_dot2_f32_bf16 v51, v124, v4, 0
v_add_f32_dpp v57, v53, v53 row_ror:8 row_mask:0xf bank_mask:0x3
v_dot2c_f32_bf16 v48, v113, v5
v_dot2c_f32_bf16 v49, v117, v5
v_add_f32_dpp v56, v54, v54 row_ror:8 row_mask:0xf bank_mask:0xc
v_dot2c_f32_bf16 v50, v121, v5
v_dot2c_f32_bf16 v51, v125, v5
v_add_f32_dpp v57, v55, v55 row_ror:8 row_mask:0xf bank_mask:0xc
v_dot2c_f32_bf16 v48, v114, v6
v_dot2c_f32_bf16 v49, v118, v6
v_add_f32_dpp v28, v56, v56 row_shl:4 row_mask:0xf bank_mask:0x5
v_dot2c_f32_bf16 v50, v122, v6
v_dot2c_f32_bf16 v51, v126, v6
v_add_f32_dpp v28, v57, v57 row_shr:4 row_mask:0xf bank_mask:0xa
v_dot2c_f32_bf16 v48, v115, v7
v_dot2c_f32_bf16 v49, v119, v7
v_add_f32_dpp v28, v28, v28 quad_perm:[1,0,3,2] row_mask:0xf bank_mask:0xf
v_dot2c_f32_bf16 v50, v123, v7
v_dot2c_f32_bf16 v51, v127, v7
v_add_f32_dpp v28, v28, v28 quad_perm:[2,3,0,1] row_mask:0xf bank_mask:0xf
v_dot2_f32_bf16 v52, v128, v4, 0
v_dot2_f32_bf16 v53, v132, v4, 0
v_add_f32_dpp v56, v48, v48 row_ror:8 row_mask:0xf bank_mask:0x3
v_dot2_f32_bf16 v54, v136, v4, 0
v_dot2_f32_bf16 v55, v140, v4, 0
v_add_f32_dpp v57, v49, v49 row_ror:8 row_mask:0xf bank_mask:0x3
v_dot2c_f32_bf16 v52, v129, v5
v_dot2c_f32_bf16 v53, v133, v5
v_add_f32_dpp v56, v50, v50 row_ror:8 row_mask:0xf bank_mask:0xc
v_dot2c_f32_bf16 v54, v137, v5
v_dot2c_f32_bf16 v55, v141, v5
v_add_f32_dpp v57, v51, v51 row_ror:8 row_mask:0xf bank_mask:0xc
v_dot2c_f32_bf16 v52, v130, v6
v_dot2c_f32_bf16 v53, v134, v6
v_add_f32_dpp v19, v56, v56 row_shl:4 row_mask:0xf bank_mask:0x5
v_dot2c_f32_bf16 v54, v138, v6
v_dot2c_f32_bf16 v55, v142, v6
v_add_f32_dpp v19, v57, v57 row_shr:4 row_mask:0xf bank_mask:0xa
v_dot2c_f32_bf16 v52, v131, v7
v_dot2c_f32_bf16 v53, v135, v7
v_add_f32_dpp v19, v19, v19 quad_perm:[1,0,3,2] row_mask:0xf bank_mask:0xf
v_dot2c_f32_bf16 v54, v139, v7
v_dot2c_f32_bf16 v55, v143, v7
v_add_f32_dpp v19, v19, v19 quad_perm:[2,3,0,1] row_mask:0xf bank_mask:0xf
v_dot2_f32_bf16 v48, v144, v4, 0
v_dot2_f32_bf16 v49, v148, v4, 0
v_add_f32_dpp v56, v52, v52 row_ror:8 row_mask:0xf bank_mask:0x3
v_dot2_f32_bf16 v50, v152, v4, 0
v_dot2_f32_bf16 v51, v156, v4, 0
v_add_f32_dpp v57, v53, v53 row_ror:8 row_mask:0xf bank_mask:0x3
v_dot2c_f32_bf16 v48, v145, v5
v_dot2c_f32_bf16 v49, v149, v5
v_add_f32_dpp v56, v54, v54 row_ror:8 row_mask:0xf bank_mask:0xc
v_dot2c_f32_bf16 v50, v153, v5
v_dot2c_f32_bf16 v51, v157, v5
v_add_f32_dpp v57, v55, v55 row_ror:8 row_mask:0xf bank_mask:0xc
v_dot2c_f32_bf16 v48, v146, v6
v_dot2c_f32_bf16 v49, v150, v6
v_add_f32_dpp v20, v56, v56 row_shl:4 row_mask:0xf bank_mask:0x5
v_dot2c_f32_bf16 v50, v154, v6
v_dot2c_f32_bf16 v51, v158, v6
v_add_f32_dpp v20, v57, v57 row_shr:4 row_mask:0xf bank_mask:0xa
v_dot2c_f32_bf16 v48, v147, v7
v_dot2c_f32_bf16 v49, v151, v7
v_add_f32_dpp v20, v20, v20 quad_perm:[1,0,3,2] row_mask:0xf bank_mask:0xf
v_dot2c_f32_bf16 v50, v155, v7
v_dot2c_f32_bf16 v51, v159, v7
v_add_f32_dpp v20, v20, v20 quad_perm:[2,3,0,1] row_mask:0xf bank_mask:0xf
s_waitcnt lgkmcnt(0)
v_dot2_f32_bf16 v52, v32, v4, 0
v_dot2_f32_bf16 v53, v36, v4, 0
v_add_f32_dpp v56, v48, v48 row_ror:8 row_mask:0xf bank_mask:0x3
v_dot2_f32_bf16 v54, v40, v4, 0
v_dot2_f32_bf16 v55, v44, v4, 0
v_add_f32_dpp v57, v49, v49 row_ror:8 row_mask:0xf bank_mask:0x3
v_dot2c_f32_bf16 v52, v33, v5
v_dot2c_f32_bf16 v53, v37, v5
v_add_f32_dpp v56, v50, v50 row_ror:8 row_mask:0xf bank_mask:0xc
v_dot2c_f32_bf16 v54, v41, v5
v_dot2c_f32_bf16 v55, v45, v5
v_add_f32_dpp v57, v51, v51 row_ror:8 row_mask:0xf bank_mask:0xc
v_dot2c_f32_bf16 v52, v34, v6
v_dot2c_f32_bf16 v53, v38, v6
v_add_f32_dpp v21, v56, v56 row_shl:4 row_mask:0xf bank_mask:0x5
v_dot2c_f32_bf16 v54, v42, v6
v_dot2c_f32_bf16 v55, v46, v6
v_add_f32_dpp v21, v57, v57 row_shr:4 row_mask:0xf bank_mask:0xa
v_dot2c_f32_bf16 v52, v35, v7
v_dot2c_f32_bf16 v53, v39, v7
v_add_f32_dpp v21, v21, v21 quad_perm:[1,0,3,2] row_mask:0xf bank_mask:0xf
v_dot2c_f32_bf16 v54, v43, v7
v_dot2c_f32_bf16 v55, v47, v7
v_add_f32_dpp v21, v21, v21 quad_perm:[2,3,0,1] row_mask:0xf bank_mask:0xf
ds_read_b128 v[32:35], v61 offset:8192
ds_read_b128 v[36:39], v61 offset:9216
ds_read_b128 v[40:43], v61 offset:10240
ds_read_b128 v[44:47], v61 offset:11264
v_dot2_f32_bf16 v48, v160, v4, 0
v_dot2_f32_bf16 v49, v164, v4, 0
v_add_f32_dpp v56, v52, v52 row_ror:8 row_mask:0xf bank_mask:0x3
v_dot2_f32_bf16 v50, v168, v4, 0
v_dot2_f32_bf16 v51, v172, v4, 0
v_add_f32_dpp v57, v53, v53 row_ror:8 row_mask:0xf bank_mask:0x3
v_dot2c_f32_bf16 v48, v161, v5
v_dot2c_f32_bf16 v49, v165, v5
v_add_f32_dpp v56, v54, v54 row_ror:8 row_mask:0xf bank_mask:0xc
v_dot2c_f32_bf16 v50, v169, v5
v_dot2c_f32_bf16 v51, v173, v5
v_add_f32_dpp v57, v55, v55 row_ror:8 row_mask:0xf bank_mask:0xc
v_dot2c_f32_bf16 v48, v162, v6
v_dot2c_f32_bf16 v49, v166, v6
v_add_f32_dpp v29, v56, v56 row_shl:4 row_mask:0xf bank_mask:0x5
v_dot2c_f32_bf16 v50, v170, v6
v_dot2c_f32_bf16 v51, v174, v6
v_add_f32_dpp v29, v57, v57 row_shr:4 row_mask:0xf bank_mask:0xa
v_dot2c_f32_bf16 v48, v163, v7
v_dot2c_f32_bf16 v49, v167, v7
v_add_f32_dpp v29, v29, v29 quad_perm:[1,0,3,2] row_mask:0xf bank_mask:0xf
v_dot2c_f32_bf16 v50, v171, v7
v_dot2c_f32_bf16 v51, v175, v7
v_add_f32_dpp v29, v29, v29 quad_perm:[2,3,0,1] row_mask:0xf bank_mask:0xf
v_dot2_f32_bf16 v52, v176, v4, 0
v_dot2_f32_bf16 v53, v180, v4, 0
v_add_f32_dpp v56, v48, v48 row_ror:8 row_mask:0xf bank_mask:0x3
v_dot2_f32_bf16 v54, v184, v4, 0
v_dot2_f32_bf16 v55, v188, v4, 0
v_add_f32_dpp v57, v49, v49 row_ror:8 row_mask:0xf bank_mask:0x3
v_dot2c_f32_bf16 v52, v177, v5
v_dot2c_f32_bf16 v53, v181, v5
v_add_f32_dpp v56, v50, v50 row_ror:8 row_mask:0xf bank_mask:0xc
v_dot2c_f32_bf16 v54, v185, v5
v_dot2c_f32_bf16 v55, v189, v5
v_add_f32_dpp v57, v51, v51 row_ror:8 row_mask:0xf bank_mask:0xc
v_dot2c_f32_bf16 v52, v178, v6
v_dot2c_f32_bf16 v53, v182, v6
v_add_f32_dpp v22, v56, v56 row_shl:4 row_mask:0xf bank_mask:0x5
v_dot2c_f32_bf16 v54, v186, v6
v_dot2c_f32_bf16 v55, v190, v6
v_add_f32_dpp v22, v57, v57 row_shr:4 row_mask:0xf bank_mask:0xa
v_dot2c_f32_bf16 v52, v179, v7
v_dot2c_f32_bf16 v53, v183, v7
v_add_f32_dpp v22, v22, v22 quad_perm:[1,0,3,2] row_mask:0xf bank_mask:0xf
v_dot2c_f32_bf16 v54, v187, v7
v_dot2c_f32_bf16 v55, v191, v7
v_add_f32_dpp v22, v22, v22 quad_perm:[2,3,0,1] row_mask:0xf bank_mask:0xf
v_dot2_f32_bf16 v48, v192, v4, 0
v_dot2_f32_bf16 v49, v196, v4, 0
v_add_f32_dpp v56, v52, v52 row_ror:8 row_mask:0xf bank_mask:0x3
v_dot2_f32_bf16 v50, v200, v4, 0
v_dot2_f32_bf16 v51, v204, v4, 0
v_add_f32_dpp v57, v53, v53 row_ror:8 row_mask:0xf bank_mask:0x3
v_dot2c_f32_bf16 v48, v193, v5
v_dot2c_f32_bf16 v49, v197, v5
v_add_f32_dpp v56, v54, v54 row_ror:8 row_mask:0xf bank_mask:0xc
v_dot2c_f32_bf16 v50, v201, v5
v_dot2c_f32_bf16 v51, v205, v5
v_add_f32_dpp v57, v55, v55 row_ror:8 row_mask:0xf bank_mask:0xc
v_dot2c_f32_bf16 v48, v194, v6
v_dot2c_f32_bf16 v49, v198, v6
v_add_f32_dpp v23, v56, v56 row_shl:4 row_mask:0xf bank_mask:0x5
v_dot2c_f32_bf16 v50, v202, v6
v_dot2c_f32_bf16 v51, v206, v6
v_add_f32_dpp v23, v57, v57 row_shr:4 row_mask:0xf bank_mask:0xa
v_dot2c_f32_bf16 v48, v195, v7
v_dot2c_f32_bf16 v49, v199, v7
v_add_f32_dpp v23, v23, v23 quad_perm:[1,0,3,2] row_mask:0xf bank_mask:0xf
v_dot2c_f32_bf16 v50, v203, v7
v_dot2c_f32_bf16 v51, v207, v7
v_add_f32_dpp v23, v23, v23 quad_perm:[2,3,0,1] row_mask:0xf bank_mask:0xf
s_waitcnt lgkmcnt(0)
v_dot2_f32_bf16 v52, v32, v4, 0
v_dot2_f32_bf16 v53, v36, v4, 0
v_add_f32_dpp v56, v48, v48 row_ror:8 row_mask:0xf bank_mask:0x3
v_dot2_f32_bf16 v54, v40, v4, 0
v_dot2_f32_bf16 v55, v44, v4, 0
v_add_f32_dpp v57, v49, v49 row_ror:8 row_mask:0xf bank_mask:0x3
v_dot2c_f32_bf16 v52, v33, v5
v_dot2c_f32_bf16 v53, v37, v5
v_add_f32_dpp v56, v50, v50 row_ror:8 row_mask:0xf bank_mask:0xc
v_dot2c_f32_bf16 v54, v41, v5
v_dot2c_f32_bf16 v55, v45, v5
v_add_f32_dpp v57, v51, v51 row_ror:8 row_mask:0xf bank_mask:0xc
v_dot2c_f32_bf16 v52, v34, v6
v_dot2c_f32_bf16 v53, v38, v6
v_add_f32_dpp v24, v56, v56 row_shl:4 row_mask:0xf bank_mask:0x5
v_dot2c_f32_bf16 v54, v42, v6
v_dot2c_f32_bf16 v55, v46, v6
v_add_f32_dpp v24, v57, v57 row_shr:4 row_mask:0xf bank_mask:0xa
v_dot2c_f32_bf16 v52, v35, v7
v_dot2c_f32_bf16 v53, v39, v7
v_add_f32_dpp v24, v24, v24 quad_perm:[1,0,3,2] row_mask:0xf bank_mask:0xf
v_dot2c_f32_bf16 v54, v43, v7
v_dot2c_f32_bf16 v55, v47, v7
v_add_f32_dpp v24, v24, v24 quad_perm:[2,3,0,1] row_mask:0xf bank_mask:0xf
ds_read_b128 v[32:35], v61 offset:12288
ds_read_b128 v[36:39], v61 offset:13312
ds_read_b128 v[40:43], v61 offset:14336
ds_read_b128 v[44:47], v61 offset:15360
v_dot2_f32_bf16 v48, v208, v4, 0
v_dot2_f32_bf16 v49, v212, v4, 0
v_add_f32_dpp v56, v52, v52 row_ror:8 row_mask:0xf bank_mask:0x3
v_dot2_f32_bf16 v50, v216, v4, 0
v_dot2_f32_bf16 v51, v220, v4, 0
v_add_f32_dpp v57, v53, v53 row_ror:8 row_mask:0xf bank_mask:0x3
v_dot2c_f32_bf16 v48, v209, v5
v_dot2c_f32_bf16 v49, v213, v5
v_add_f32_dpp v56, v54, v54 row_ror:8 row_mask:0xf bank_mask:0xc
v_dot2c_f32_bf16 v50, v217, v5
v_dot2c_f32_bf16 v51, v221, v5
v_add_f32_dpp v57, v55, v55 row_ror:8 row_mask:0xf bank_mask:0xc
v_dot2c_f32_bf16 v48, v210, v6
v_dot2c_f32_bf16 v49, v214, v6
v_add_f32_dpp v30, v56, v56 row_shl:4 row_mask:0xf bank_mask:0x5
v_dot2c_f32_bf16 v50, v218, v6
v_dot2c_f32_bf16 v51, v222, v6
v_add_f32_dpp v30, v57, v57 row_shr:4 row_mask:0xf bank_mask:0xa
v_dot2c_f32_bf16 v48, v211, v7
v_dot2c_f32_bf16 v49, v215, v7
v_add_f32_dpp v30, v30, v30 quad_perm:[1,0,3,2] row_mask:0xf bank_mask:0xf
v_dot2c_f32_bf16 v50, v219, v7
v_dot2c_f32_bf16 v51, v223, v7
v_add_f32_dpp v30, v30, v30 quad_perm:[2,3,0,1] row_mask:0xf bank_mask:0xf
v_dot2_f32_bf16 v52, v224, v4, 0
v_dot2_f32_bf16 v53, v228, v4, 0
v_add_f32_dpp v56, v48, v48 row_ror:8 row_mask:0xf bank_mask:0x3
v_dot2_f32_bf16 v54, v232, v4, 0
v_dot2_f32_bf16 v55, v236, v4, 0
v_add_f32_dpp v57, v49, v49 row_ror:8 row_mask:0xf bank_mask:0x3
v_dot2c_f32_bf16 v52, v225, v5
v_dot2c_f32_bf16 v53, v229, v5
v_add_f32_dpp v56, v50, v50 row_ror:8 row_mask:0xf bank_mask:0xc
v_dot2c_f32_bf16 v54, v233, v5
v_dot2c_f32_bf16 v55, v237, v5
v_add_f32_dpp v57, v51, v51 row_ror:8 row_mask:0xf bank_mask:0xc
v_dot2c_f32_bf16 v52, v226, v6
v_dot2c_f32_bf16 v53, v230, v6
v_add_f32_dpp v25, v56, v56 row_shl:4 row_mask:0xf bank_mask:0x5
v_dot2c_f32_bf16 v54, v234, v6
v_dot2c_f32_bf16 v55, v238, v6
v_add_f32_dpp v25, v57, v57 row_shr:4 row_mask:0xf bank_mask:0xa
v_dot2c_f32_bf16 v52, v227, v7
v_dot2c_f32_bf16 v53, v231, v7
v_add_f32_dpp v25, v25, v25 quad_perm:[1,0,3,2] row_mask:0xf bank_mask:0xf
v_dot2c_f32_bf16 v54, v235, v7
v_dot2c_f32_bf16 v55, v239, v7
v_add_f32_dpp v25, v25, v25 quad_perm:[2,3,0,1] row_mask:0xf bank_mask:0xf
v_dot2_f32_bf16 v48, v240, v4, 0
v_dot2_f32_bf16 v49, v244, v4, 0
v_add_f32_dpp v56, v52, v52 row_ror:8 row_mask:0xf bank_mask:0x3
v_dot2_f32_bf16 v50, v248, v4, 0
v_dot2_f32_bf16 v51, v252, v4, 0
v_add_f32_dpp v57, v53, v53 row_ror:8 row_mask:0xf bank_mask:0x3
v_dot2c_f32_bf16 v48, v241, v5
v_dot2c_f32_bf16 v49, v245, v5
v_add_f32_dpp v56, v54, v54 row_ror:8 row_mask:0xf bank_mask:0xc
v_dot2c_f32_bf16 v50, v249, v5
v_dot2c_f32_bf16 v51, v253, v5
v_add_f32_dpp v57, v55, v55 row_ror:8 row_mask:0xf bank_mask:0xc
v_dot2c_f32_bf16 v48, v242, v6
v_dot2c_f32_bf16 v49, v246, v6
v_add_f32_dpp v26, v56, v56 row_shl:4 row_mask:0xf bank_mask:0x5
v_dot2c_f32_bf16 v50, v250, v6
v_dot2c_f32_bf16 v51, v254, v6
v_add_f32_dpp v26, v57, v57 row_shr:4 row_mask:0xf bank_mask:0xa
v_dot2c_f32_bf16 v48, v243, v7
v_dot2c_f32_bf16 v49, v247, v7
v_add_f32_dpp v26, v26, v26 quad_perm:[1,0,3,2] row_mask:0xf bank_mask:0xf
v_dot2c_f32_bf16 v50, v251, v7
v_dot2c_f32_bf16 v51, v255, v7
v_add_f32_dpp v26, v26, v26 quad_perm:[2,3,0,1] row_mask:0xf bank_mask:0xf
s_waitcnt lgkmcnt(0)
v_dot2_f32_bf16 v52, v32, v4, 0
v_dot2_f32_bf16 v53, v36, v4, 0
v_add_f32_dpp v56, v48, v48 row_ror:8 row_mask:0xf bank_mask:0x3
v_dot2_f32_bf16 v54, v40, v4, 0
v_dot2_f32_bf16 v55, v44, v4, 0
v_add_f32_dpp v57, v49, v49 row_ror:8 row_mask:0xf bank_mask:0x3
v_dot2c_f32_bf16 v52, v33, v5
v_dot2c_f32_bf16 v53, v37, v5
v_add_f32_dpp v56, v50, v50 row_ror:8 row_mask:0xf bank_mask:0xc
v_dot2c_f32_bf16 v54, v41, v5
v_dot2c_f32_bf16 v55, v45, v5
v_add_f32_dpp v57, v51, v51 row_ror:8 row_mask:0xf bank_mask:0xc
v_dot2c_f32_bf16 v52, v34, v6
v_dot2c_f32_bf16 v53, v38, v6
v_add_f32_dpp v27, v56, v56 row_shl:4 row_mask:0xf bank_mask:0x5
v_dot2c_f32_bf16 v54, v42, v6
v_dot2c_f32_bf16 v55, v46, v6
v_add_f32_dpp v27, v57, v57 row_shr:4 row_mask:0xf bank_mask:0xa
v_dot2c_f32_bf16 v52, v35, v7
v_dot2c_f32_bf16 v53, v39, v7
v_add_f32_dpp v27, v27, v27 quad_perm:[1,0,3,2] row_mask:0xf bank_mask:0xf
v_dot2c_f32_bf16 v54, v43, v7
v_dot2c_f32_bf16 v55, v47, v7
v_add_f32_dpp v27, v27, v27 quad_perm:[2,3,0,1] row_mask:0xf bank_mask:0xf
s_nop 2
v_add_f32_dpp v56, v52, v52 row_ror:8 row_mask:0xf bank_mask:0x3
v_add_f32_dpp v57, v53, v53 row_ror:8 row_mask:0xf bank_mask:0x3
s_nop 0
v_add_f32_dpp v56, v54, v54 row_ror:8 row_mask:0xf bank_mask:0xc
v_add_f32_dpp v57, v55, v55 row_ror:8 row_mask:0xf bank_mask:0xc
s_nop 1
v_add_f32_dpp v31, v56, v56 row_shl:4 row_mask:0xf bank_mask:0x5
s_nop 1
v_add_f32_dpp v31, v57, v57 row_shr:4 row_mask:0xf bank_mask:0xa
s_nop 1
v_add_f32_dpp v31, v31, v31 quad_perm:[1,0,3,2] row_mask:0xf bank_mask:0xf
s_nop 1
v_add_f32_dpp v31, v31, v31 quad_perm:[2,3,0,1] row_mask:0xf bank_mask:0xf
s_nop 1
s_cmp_eq_u32 s57, 2
s_cbranch_scc0 L_nkv_26
s_mul_i32 s32, s3, 20480
s_add_u32 s32, s32, 65536
v_lshlrev_b32 v60, 4, v0
v_add_u32 v60, s32, v60
ds_read_b128 v[64:67], v60 offset:8192
ds_read_b128 v[68:71], v60 offset:9216
ds_read_b128 v[72:75], v60 offset:10240
ds_read_b128 v[76:79], v60 offset:11264
ds_read_b128 v[80:83], v60 offset:12288
ds_read_b128 v[84:87], v60 offset:13312
ds_read_b128 v[88:91], v60 offset:14336
ds_read_b128 v[92:95], v60 offset:15360
ds_read_b128 v[96:99], v60 offset:16384
ds_read_b128 v[100:103], v60 offset:17408
ds_read_b128 v[104:107], v60 offset:18432
ds_read_b128 v[108:111], v60 offset:19456
s_waitcnt lgkmcnt(0)
ds_read_b128 v[112:115], v60 offset:0
ds_read_b128 v[116:119], v60 offset:1024
ds_read_b128 v[120:123], v60 offset:2048
ds_read_b128 v[124:127], v60 offset:3072
ds_read_b128 v[128:131], v60 offset:4096
ds_read_b128 v[132:135], v60 offset:5120
ds_read_b128 v[136:139], v60 offset:6144
ds_read_b128 v[140:143], v60 offset:7168
s_branch L_softmax
L_nkv_26:
s_cmp_eq_u32 s27, 1
s_cbranch_scc0 L_nolk_27
s_cmp_eq_u32 s59, 0
s_cbranch_scc0 L_nolk_27
s_mov_b32 s55, 0x4000000
s_mov_b32 s57, 1
s_branch L_lka
L_nolk_27:
L_softmax:
v_max3_f32 v58, v16, v17, v18
v_max3_f32 v58, v58, v19, v20
v_max3_f32 v58, v58, v21, v22
v_max3_f32 v58, v58, v23, v24
v_max3_f32 v58, v58, v25, v26
v_max3_f32 v58, v58, v27, v28
v_max3_f32 v58, v58, v29, v30
v_max_f32 v58, v58, v31
s_nop 1
v_max_f32_dpp v58, v58, v58 row_ror:4 row_mask:0xf bank_mask:0xf
s_nop 1
v_max_f32_dpp v58, v58, v58 row_ror:8 row_mask:0xf bank_mask:0xf
v_mov_b32 v60, v58
s_nop 1
v_permlane16_swap_b32 v58, v60
v_max_f32 v58, v58, v60
v_mov_b32 v60, v58
s_nop 1
v_permlane32_swap_b32 v58, v60
v_max_f32 v58, v58, v60
v_mul_f32 v58, s48, v58
v_fma_f32 v16, v16, s48, -v58
v_fma_f32 v17, v17, s48, -v58
v_fma_f32 v18, v18, s48, -v58
v_fma_f32 v19, v19, s48, -v58
v_fma_f32 v20, v20, s48, -v58
v_fma_f32 v21, v21, s48, -v58
v_fma_f32 v22, v22, s48, -v58
v_fma_f32 v23, v23, s48, -v58
v_fma_f32 v24, v24, s48, -v58
v_fma_f32 v25, v25, s48, -v58
v_fma_f32 v26, v26, s48, -v58
v_fma_f32 v27, v27, s48, -v58
v_fma_f32 v28, v28, s48, -v58
v_fma_f32 v29, v29, s48, -v58
v_fma_f32 v30, v30, s48, -v58
v_fma_f32 v31, v31, s48, -v58
v_exp_f32 v16, v16
v_exp_f32 v17, v17
v_exp_f32 v18, v18
v_exp_f32 v19, v19
v_exp_f32 v20, v20
v_exp_f32 v21, v21
v_exp_f32 v22, v22
v_exp_f32 v23, v23
v_exp_f32 v24, v24
v_exp_f32 v25, v25
v_exp_f32 v26, v26
v_exp_f32 v27, v27
v_exp_f32 v28, v28
v_exp_f32 v29, v29
v_exp_f32 v30, v30
v_exp_f32 v31, v31
v_add_f32 v59, v16, v17
v_add_f32 v59, v59, v18
v_add_f32 v59, v59, v19
v_add_f32 v59, v59, v20
v_add_f32 v59, v59, v21
v_add_f32 v59, v59, v22
v_add_f32 v59, v59, v23
v_add_f32 v59, v59, v24
v_add_f32 v59, v59, v25
v_add_f32 v59, v59, v26
v_add_f32 v59, v59, v27
v_add_f32 v59, v59, v28
v_add_f32 v59, v59, v29
v_add_f32 v59, v59, v30
v_add_f32 v59, v59, v31
v_cvt_pk_bf16_f32 v16, v16, v16
v_cvt_pk_bf16_f32 v17, v17, v17
v_cvt_pk_bf16_f32 v18, v18, v18
v_cvt_pk_bf16_f32 v19, v19, v19
v_cvt_pk_bf16_f32 v20, v20, v20
v_cvt_pk_bf16_f32 v21, v21, v21
v_cvt_pk_bf16_f32 v22, v22, v22
v_cvt_pk_bf16_f32 v23, v23, v23
v_cvt_pk_bf16_f32 v24, v24, v24
v_cvt_pk_bf16_f32 v25, v25, v25
v_cvt_pk_bf16_f32 v26, v26, v26
v_cvt_pk_bf16_f32 v27, v27, v27
v_cvt_pk_bf16_f32 v28, v28, v28
v_cvt_pk_bf16_f32 v29, v29, v29
v_cvt_pk_bf16_f32 v30, v30, v30
v_cvt_pk_bf16_f32 v31, v31, v31
v_add_f32_dpp v59, v59, v59 row_ror:4 row_mask:0xf bank_mask:0xf
s_nop 1
v_add_f32_dpp v59, v59, v59 row_ror:8 row_mask:0xf bank_mask:0xf
v_mov_b32 v60, v59
s_nop 1
v_permlane16_swap_b32 v59, v60
v_add_f32 v59, v59, v60
v_mov_b32 v60, v59
s_nop 1
v_permlane32_swap_b32 v59, v60
v_add_f32 v59, v59, v60
s_cmp_eq_u32 s63, 1
s_cbranch_scc1 L_pvring
s_cmp_eq_u32 s57, 2
s_cbranch_scc1 L_pvn
s_cmp_eq_u32 s57, 1
s_cbranch_scc0 L_pvstd
s_cmp_eq_u32 s27, 1
s_cbranch_scc1 L_pvc
L_pvstd:
s_cmp_eq_u32 s51, 1
s_cbranch_scc0 L_nowl_28
s_cmp_eq_u32 s28, 2
s_cbranch_scc1 L_w2l_29
s_cmp_eq_u32 s28, 3
s_cbranch_scc1 L_w3l_30
s_branch L_pvw
s_lshl_b32 s44, s52, 9
s_lshl_b32 s45, s53, 7
v_lshrrev_b32 v48, 3, v0
v_mul_u32_u24 v48, 20480, v48
v_and_b32 v49, 7, v0
v_lshl_add_u32 v48, v49, 4, v48
s_mul_i32 s42, s3, 128
s_add_u32 s42, s42, s44
s_mul_i32 s42, s42, 1280
s_add_u32 s42, s42, s45
s_mul_i32 s43, s3, 16384
s_add_u32 s43, s43, 65536
s_mov_b32 m0, s43
s_add_u32 s43, s43, 1024
buffer_load_dwordx4 v48, s[12:15], s42 offen lds
s_add_u32 s42, s42, 1280
s_mov_b32 m0, s43
s_add_u32 s43, s43, 1024
buffer_load_dwordx4 v48, s[12:15], s42 offen lds
s_add_u32 s42, s42, 1280
s_mov_b32 m0, s43
s_add_u32 s43, s43, 1024
buffer_load_dwordx4 v48, s[12:15], s42 offen lds
s_add_u32 s42, s42, 1280
s_mov_b32 m0, s43
s_add_u32 s43, s43, 1024
buffer_load_dwordx4 v48, s[12:15], s42 offen lds
s_add_u32 s42, s42, 1280
s_mov_b32 m0, s43
s_add_u32 s43, s43, 1024
buffer_load_dwordx4 v48, s[12:15], s42 offen lds
s_add_u32 s42, s42, 1280
s_mov_b32 m0, s43
s_add_u32 s43, s43, 1024
buffer_load_dwordx4 v48, s[12:15], s42 offen lds
s_add_u32 s42, s42, 1280
s_mov_b32 m0, s43
s_add_u32 s43, s43, 1024
buffer_load_dwordx4 v48, s[12:15], s42 offen lds
s_add_u32 s42, s42, 1280
s_mov_b32 m0, s43
s_add_u32 s43, s43, 1024
buffer_load_dwordx4 v48, s[12:15], s42 offen lds
s_add_u32 s42, s42, 1280
s_mov_b32 m0, s43
s_add_u32 s43, s43, 1024
buffer_load_dwordx4 v48, s[12:15], s42 offen lds
s_add_u32 s42, s42, 1280
s_mov_b32 m0, s43
s_add_u32 s43, s43, 1024
buffer_load_dwordx4 v48, s[12:15], s42 offen lds
s_add_u32 s42, s42, 1280
s_mov_b32 m0, s43
s_add_u32 s43, s43, 1024
buffer_load_dwordx4 v48, s[12:15], s42 offen lds
s_add_u32 s42, s42, 1280
s_mov_b32 m0, s43
s_add_u32 s43, s43, 1024
buffer_load_dwordx4 v48, s[12:15], s42 offen lds
s_add_u32 s42, s42, 1280
s_mov_b32 m0, s43
s_add_u32 s43, s43, 1024
buffer_load_dwordx4 v48, s[12:15], s42 offen lds
s_add_u32 s42, s42, 1280
s_mov_b32 m0, s43
s_add_u32 s43, s43, 1024
buffer_load_dwordx4 v48, s[12:15], s42 offen lds
s_add_u32 s42, s42, 1280
s_mov_b32 m0, s43
s_add_u32 s43, s43, 1024
buffer_load_dwordx4 v48, s[12:15], s42 offen lds
s_add_u32 s42, s42, 1280
s_mov_b32 m0, s43
s_add_u32 s43, s43, 1024
buffer_load_dwordx4 v48, s[12:15], s42 offen lds
s_add_u32 s42, s42, 1280
s_branch L_nowl_28
L_w2l_29:
v_lshrrev_b32 v48, 3, v0
v_mul_u32_u24 v48, 69120, v48
v_and_b32 v49, 7, v0
v_lshl_add_u32 v48, v49, 4, v48
s_mul_i32 s42, s3, 160
s_mul_i32 s42, s42, 3456
s_add_u32 s42, s42, s53
s_mul_i32 s43, s3, 20480
s_add_u32 s43, s43, 65536
s_mov_b32 m0, s43
s_add_u32 s43, s43, 1024
buffer_load_dwordx4 v48, s[12:15], s42 offen lds
s_add_u32 s42, s42, 3456
s_mov_b32 m0, s43
s_add_u32 s43, s43, 1024
buffer_load_dwordx4 v48, s[12:15], s42 offen lds
s_add_u32 s42, s42, 3456
s_mov_b32 m0, s43
s_add_u32 s43, s43, 1024
buffer_load_dwordx4 v48, s[12:15], s42 offen lds
s_add_u32 s42, s42, 3456
s_mov_b32 m0, s43
s_add_u32 s43, s43, 1024
buffer_load_dwordx4 v48, s[12:15], s42 offen lds
s_add_u32 s42, s42, 3456
s_mov_b32 m0, s43
s_add_u32 s43, s43, 1024
buffer_load_dwordx4 v48, s[12:15], s42 offen lds
s_add_u32 s42, s42, 3456
s_mov_b32 m0, s43
s_add_u32 s43, s43, 1024
buffer_load_dwordx4 v48, s[12:15], s42 offen lds
s_add_u32 s42, s42, 3456
s_mov_b32 m0, s43
s_add_u32 s43, s43, 1024
buffer_load_dwordx4 v48, s[12:15], s42 offen lds
s_add_u32 s42, s42, 3456
s_mov_b32 m0, s43
s_add_u32 s43, s43, 1024
buffer_load_dwordx4 v48, s[12:15], s42 offen lds
s_add_u32 s42, s42, 3456
s_mov_b32 m0, s43
s_add_u32 s43, s43, 1024
buffer_load_dwordx4 v48, s[12:15], s42 offen lds
s_add_u32 s42, s42, 3456
s_mov_b32 m0, s43
s_add_u32 s43, s43, 1024
buffer_load_dwordx4 v48, s[12:15], s42 offen lds
s_add_u32 s42, s42, 3456
s_mov_b32 m0, s43
s_add_u32 s43, s43, 1024
buffer_load_dwordx4 v48, s[12:15], s42 offen lds
s_add_u32 s42, s42, 3456
s_mov_b32 m0, s43
s_add_u32 s43, s43, 1024
buffer_load_dwordx4 v48, s[12:15], s42 offen lds
s_add_u32 s42, s42, 3456
s_mov_b32 m0, s43
s_add_u32 s43, s43, 1024
buffer_load_dwordx4 v48, s[12:15], s42 offen lds
s_add_u32 s42, s42, 3456
s_mov_b32 m0, s43
s_add_u32 s43, s43, 1024
buffer_load_dwordx4 v48, s[12:15], s42 offen lds
s_add_u32 s42, s42, 3456
s_mov_b32 m0, s43
s_add_u32 s43, s43, 1024
buffer_load_dwordx4 v48, s[12:15], s42 offen lds
s_add_u32 s42, s42, 3456
s_mov_b32 m0, s43
s_add_u32 s43, s43, 1024
buffer_load_dwordx4 v48, s[12:15], s42 offen lds
s_add_u32 s42, s42, 3456
s_mov_b32 m0, s43
s_add_u32 s43, s43, 1024
buffer_load_dwordx4 v48, s[12:15], s42 offen lds
s_add_u32 s42, s42, 3456
s_mov_b32 m0, s43
s_add_u32 s43, s43, 1024
buffer_load_dwordx4 v48, s[12:15], s42 offen lds
s_add_u32 s42, s42, 3456
s_mov_b32 m0, s43
s_add_u32 s43, s43, 1024
buffer_load_dwordx4 v48, s[12:15], s42 offen lds
s_add_u32 s42, s42, 3456
s_mov_b32 m0, s43
s_add_u32 s43, s43, 1024
buffer_load_dwordx4 v48, s[12:15], s42 offen lds
s_add_u32 s42, s42, 3456
s_branch L_nowl_28
L_w3l_30:
v_bfe_u32 v48, v0, 1, 4
v_mul_u32_u24 v48, 5120, v48
v_lshrrev_b32 v49, 5, v0
v_mul_u32_u24 v49, 1280, v49
v_add_u32 v48, v48, v49
v_and_b32 v49, 1, v0
v_lshl_add_u32 v48, v49, 4, v48
s_mul_i32 s42, s3, 552960
s_lshl_b32 s43, s29, 5
s_add_u32 s42, s42, s43
s_mul_i32 s43, s3, 14336
s_add_u32 s43, s43, 65536
s_mov_b32 m0, s43
s_add_u32 s44, s42, 0
buffer_load_dwordx4 v48, s[12:15], s44 offen lds
s_add_u32 s43, s43, 1024
s_mov_b32 m0, s43
s_add_u32 s44, s42, 2560
buffer_load_dwordx4 v48, s[12:15], s44 offen lds
s_add_u32 s43, s43, 1024
s_mov_b32 m0, s43
s_add_u32 s44, s42, 81920
buffer_load_dwordx4 v48, s[12:15], s44 offen lds
s_add_u32 s43, s43, 1024
s_mov_b32 m0, s43
s_add_u32 s44, s42, 84480
buffer_load_dwordx4 v48, s[12:15], s44 offen lds
s_add_u32 s43, s43, 1024
s_mov_b32 m0, s43
s_add_u32 s44, s42, 163840
buffer_load_dwordx4 v48, s[12:15], s44 offen lds
s_add_u32 s43, s43, 1024
s_mov_b32 m0, s43
s_add_u32 s44, s42, 166400
buffer_load_dwordx4 v48, s[12:15], s44 offen lds
s_add_u32 s43, s43, 1024
s_mov_b32 m0, s43
s_add_u32 s44, s42, 245760
buffer_load_dwordx4 v48, s[12:15], s44 offen lds
s_add_u32 s43, s43, 1024
s_mov_b32 m0, s43
s_add_u32 s44, s42, 248320
buffer_load_dwordx4 v48, s[12:15], s44 offen lds
s_add_u32 s43, s43, 1024
s_mov_b32 m0, s43
s_add_u32 s44, s42, 327680
buffer_load_dwordx4 v48, s[12:15], s44 offen lds
s_add_u32 s43, s43, 1024
s_mov_b32 m0, s43
s_add_u32 s44, s42, 330240
buffer_load_dwordx4 v48, s[12:15], s44 offen lds
s_add_u32 s43, s43, 1024
s_mov_b32 m0, s43
s_add_u32 s44, s42, 409600
buffer_load_dwordx4 v48, s[12:15], s44 offen lds
s_add_u32 s43, s43, 1024
s_mov_b32 m0, s43
s_add_u32 s44, s42, 412160
buffer_load_dwordx4 v48, s[12:15], s44 offen lds
s_add_u32 s43, s43, 1024
s_mov_b32 m0, s43
s_add_u32 s44, s42, 491520
buffer_load_dwordx4 v48, s[12:15], s44 offen lds
s_add_u32 s43, s43, 1024
s_mov_b32 m0, s43
s_add_u32 s44, s42, 494080
buffer_load_dwordx4 v48, s[12:15], s44 offen lds
s_add_u32 s43, s43, 1024
L_nowl_28:
s_cmp_eq_u32 s51, 1
s_cselect_b64 vcc, -1, 0
s_mov_b32 s51, 0
v_mov_b32 v32, 0
v_mov_b32 v33, 0
v_mov_b32 v34, 0
v_mov_b32 v35, 0
v_mov_b32 v36, 0
v_mov_b32 v37, 0
v_mov_b32 v38, 0
v_mov_b32 v39, 0
s_bitcmp1_b32 s27, 0
v_and_b32_dpp v40, v16, v2 row_newbcast:0 row_mask:0xf bank_mask:0xf
v_and_b32_dpp v41, v16, v3 row_newbcast:0 row_mask:0xf bank_mask:0xf
v_and_b32_dpp v42, v16, v2 row_newbcast:4 row_mask:0xf bank_mask:0xf
v_and_b32_dpp v43, v16, v3 row_newbcast:4 row_mask:0xf bank_mask:0xf
s_cbranch_scc1 L_nw_31
s_cbranch_vccnz L_nw_31
s_waitcnt vmcnt(60)
L_nw_31:
v_mfma_f32_4x4x4_16b_bf16 v[32:35], v[40:41], a[0:1], v[32:35]
v_mfma_f32_4x4x4_16b_bf16 v[36:39], v[40:41], a[2:3], v[36:39]
v_and_b32_dpp v44, v16, v2 row_newbcast:8 row_mask:0xf bank_mask:0xf
v_and_b32_dpp v45, v16, v3 row_newbcast:8 row_mask:0xf bank_mask:0xf
v_mfma_f32_4x4x4_16b_bf16 v[32:35], v[42:43], a[4:5], v[32:35]
v_mfma_f32_4x4x4_16b_bf16 v[36:39], v[42:43], a[6:7], v[36:39]
v_and_b32_dpp v40, v16, v2 row_newbcast:12 row_mask:0xf bank_mask:0xf
v_and_b32_dpp v41, v16, v3 row_newbcast:12 row_mask:0xf bank_mask:0xf
v_mfma_f32_4x4x4_16b_bf16 v[32:35], v[44:45], a[8:9], v[32:35]
v_mfma_f32_4x4x4_16b_bf16 v[36:39], v[44:45], a[10:11], v[36:39]
v_and_b32_dpp v42, v17, v2 row_newbcast:0 row_mask:0xf bank_mask:0xf
v_and_b32_dpp v43, v17, v3 row_newbcast:0 row_mask:0xf bank_mask:0xf
v_mfma_f32_4x4x4_16b_bf16 v[32:35], v[40:41], a[12:13], v[32:35]
v_mfma_f32_4x4x4_16b_bf16 v[36:39], v[40:41], a[14:15], v[36:39]
v_and_b32_dpp v44, v17, v2 row_newbcast:4 row_mask:0xf bank_mask:0xf
v_and_b32_dpp v45, v17, v3 row_newbcast:4 row_mask:0xf bank_mask:0xf
s_cbranch_scc1 L_nw_32
s_cbranch_vccnz L_nw_32
s_waitcnt vmcnt(56)
L_nw_32:
v_mfma_f32_4x4x4_16b_bf16 v[32:35], v[42:43], a[16:17], v[32:35]
v_mfma_f32_4x4x4_16b_bf16 v[36:39], v[42:43], a[18:19], v[36:39]
v_and_b32_dpp v40, v17, v2 row_newbcast:8 row_mask:0xf bank_mask:0xf
v_and_b32_dpp v41, v17, v3 row_newbcast:8 row_mask:0xf bank_mask:0xf
v_mfma_f32_4x4x4_16b_bf16 v[32:35], v[44:45], a[20:21], v[32:35]
v_mfma_f32_4x4x4_16b_bf16 v[36:39], v[44:45], a[22:23], v[36:39]
v_and_b32_dpp v42, v17, v2 row_newbcast:12 row_mask:0xf bank_mask:0xf
v_and_b32_dpp v43, v17, v3 row_newbcast:12 row_mask:0xf bank_mask:0xf
v_mfma_f32_4x4x4_16b_bf16 v[32:35], v[40:41], a[24:25], v[32:35]
v_mfma_f32_4x4x4_16b_bf16 v[36:39], v[40:41], a[26:27], v[36:39]
v_and_b32_dpp v44, v18, v2 row_newbcast:0 row_mask:0xf bank_mask:0xf
v_and_b32_dpp v45, v18, v3 row_newbcast:0 row_mask:0xf bank_mask:0xf
v_mfma_f32_4x4x4_16b_bf16 v[32:35], v[42:43], a[28:29], v[32:35]
v_mfma_f32_4x4x4_16b_bf16 v[36:39], v[42:43], a[30:31], v[36:39]
v_and_b32_dpp v40, v18, v2 row_newbcast:4 row_mask:0xf bank_mask:0xf
v_and_b32_dpp v41, v18, v3 row_newbcast:4 row_mask:0xf bank_mask:0xf
s_cbranch_scc1 L_nw_33
s_cbranch_vccnz L_nw_33
s_waitcnt vmcnt(52)
L_nw_33:
v_mfma_f32_4x4x4_16b_bf16 v[32:35], v[44:45], a[32:33], v[32:35]
v_mfma_f32_4x4x4_16b_bf16 v[36:39], v[44:45], a[34:35], v[36:39]
v_and_b32_dpp v42, v18, v2 row_newbcast:8 row_mask:0xf bank_mask:0xf
v_and_b32_dpp v43, v18, v3 row_newbcast:8 row_mask:0xf bank_mask:0xf
v_mfma_f32_4x4x4_16b_bf16 v[32:35], v[40:41], a[36:37], v[32:35]
v_mfma_f32_4x4x4_16b_bf16 v[36:39], v[40:41], a[38:39], v[36:39]
v_and_b32_dpp v44, v18, v2 row_newbcast:12 row_mask:0xf bank_mask:0xf
v_and_b32_dpp v45, v18, v3 row_newbcast:12 row_mask:0xf bank_mask:0xf
v_mfma_f32_4x4x4_16b_bf16 v[32:35], v[42:43], a[40:41], v[32:35]
v_mfma_f32_4x4x4_16b_bf16 v[36:39], v[42:43], a[42:43], v[36:39]
v_and_b32_dpp v40, v19, v2 row_newbcast:0 row_mask:0xf bank_mask:0xf
v_and_b32_dpp v41, v19, v3 row_newbcast:0 row_mask:0xf bank_mask:0xf
v_mfma_f32_4x4x4_16b_bf16 v[32:35], v[44:45], a[44:45], v[32:35]
v_mfma_f32_4x4x4_16b_bf16 v[36:39], v[44:45], a[46:47], v[36:39]
v_and_b32_dpp v42, v19, v2 row_newbcast:4 row_mask:0xf bank_mask:0xf
v_and_b32_dpp v43, v19, v3 row_newbcast:4 row_mask:0xf bank_mask:0xf
s_cbranch_scc1 L_nw_34
s_waitcnt vmcnt(62)
s_cbranch_vccnz L_nw_34
s_waitcnt vmcnt(48)
L_nw_34:
v_mfma_f32_4x4x4_16b_bf16 v[32:35], v[40:41], a[48:49], v[32:35]
v_mfma_f32_4x4x4_16b_bf16 v[36:39], v[40:41], a[50:51], v[36:39]
v_and_b32_dpp v44, v19, v2 row_newbcast:8 row_mask:0xf bank_mask:0xf
v_and_b32_dpp v45, v19, v3 row_newbcast:8 row_mask:0xf bank_mask:0xf
v_mfma_f32_4x4x4_16b_bf16 v[32:35], v[42:43], a[52:53], v[32:35]
v_mfma_f32_4x4x4_16b_bf16 v[36:39], v[42:43], a[54:55], v[36:39]
v_and_b32_dpp v40, v19, v2 row_newbcast:12 row_mask:0xf bank_mask:0xf
v_and_b32_dpp v41, v19, v3 row_newbcast:12 row_mask:0xf bank_mask:0xf
v_mfma_f32_4x4x4_16b_bf16 v[32:35], v[44:45], a[56:57], v[32:35]
v_mfma_f32_4x4x4_16b_bf16 v[36:39], v[44:45], a[58:59], v[36:39]
v_and_b32_dpp v42, v20, v2 row_newbcast:0 row_mask:0xf bank_mask:0xf
v_and_b32_dpp v43, v20, v3 row_newbcast:0 row_mask:0xf bank_mask:0xf
v_mfma_f32_4x4x4_16b_bf16 v[32:35], v[40:41], a[60:61], v[32:35]
v_mfma_f32_4x4x4_16b_bf16 v[36:39], v[40:41], a[62:63], v[36:39]
v_and_b32_dpp v44, v20, v2 row_newbcast:4 row_mask:0xf bank_mask:0xf
v_and_b32_dpp v45, v20, v3 row_newbcast:4 row_mask:0xf bank_mask:0xf
s_cbranch_scc1 L_nw_35
s_waitcnt vmcnt(58)
s_cbranch_vccnz L_nw_35
s_waitcnt vmcnt(44)
L_nw_35:
v_mfma_f32_4x4x4_16b_bf16 v[32:35], v[42:43], a[64:65], v[32:35]
v_mfma_f32_4x4x4_16b_bf16 v[36:39], v[42:43], a[66:67], v[36:39]
v_and_b32_dpp v40, v20, v2 row_newbcast:8 row_mask:0xf bank_mask:0xf
v_and_b32_dpp v41, v20, v3 row_newbcast:8 row_mask:0xf bank_mask:0xf
v_mfma_f32_4x4x4_16b_bf16 v[32:35], v[44:45], a[68:69], v[32:35]
v_mfma_f32_4x4x4_16b_bf16 v[36:39], v[44:45], a[70:71], v[36:39]
v_and_b32_dpp v42, v20, v2 row_newbcast:12 row_mask:0xf bank_mask:0xf
v_and_b32_dpp v43, v20, v3 row_newbcast:12 row_mask:0xf bank_mask:0xf
v_mfma_f32_4x4x4_16b_bf16 v[32:35], v[40:41], a[72:73], v[32:35]
v_mfma_f32_4x4x4_16b_bf16 v[36:39], v[40:41], a[74:75], v[36:39]
v_and_b32_dpp v44, v21, v2 row_newbcast:0 row_mask:0xf bank_mask:0xf
v_and_b32_dpp v45, v21, v3 row_newbcast:0 row_mask:0xf bank_mask:0xf
v_mfma_f32_4x4x4_16b_bf16 v[32:35], v[42:43], a[76:77], v[32:35]
v_mfma_f32_4x4x4_16b_bf16 v[36:39], v[42:43], a[78:79], v[36:39]
v_and_b32_dpp v40, v21, v2 row_newbcast:4 row_mask:0xf bank_mask:0xf
v_and_b32_dpp v41, v21, v3 row_newbcast:4 row_mask:0xf bank_mask:0xf
s_cbranch_scc1 L_nw_36
s_waitcnt vmcnt(54)
s_cbranch_vccnz L_nw_36
s_waitcnt vmcnt(40)
L_nw_36:
v_mfma_f32_4x4x4_16b_bf16 v[32:35], v[44:45], a[80:81], v[32:35]
v_mfma_f32_4x4x4_16b_bf16 v[36:39], v[44:45], a[82:83], v[36:39]
v_and_b32_dpp v42, v21, v2 row_newbcast:8 row_mask:0xf bank_mask:0xf
v_and_b32_dpp v43, v21, v3 row_newbcast:8 row_mask:0xf bank_mask:0xf
v_mfma_f32_4x4x4_16b_bf16 v[32:35], v[40:41], a[84:85], v[32:35]
v_mfma_f32_4x4x4_16b_bf16 v[36:39], v[40:41], a[86:87], v[36:39]
v_and_b32_dpp v44, v21, v2 row_newbcast:12 row_mask:0xf bank_mask:0xf
v_and_b32_dpp v45, v21, v3 row_newbcast:12 row_mask:0xf bank_mask:0xf
v_mfma_f32_4x4x4_16b_bf16 v[32:35], v[42:43], a[88:89], v[32:35]
v_mfma_f32_4x4x4_16b_bf16 v[36:39], v[42:43], a[90:91], v[36:39]
v_and_b32_dpp v40, v22, v2 row_newbcast:0 row_mask:0xf bank_mask:0xf
v_and_b32_dpp v41, v22, v3 row_newbcast:0 row_mask:0xf bank_mask:0xf
v_mfma_f32_4x4x4_16b_bf16 v[32:35], v[44:45], a[92:93], v[32:35]
v_mfma_f32_4x4x4_16b_bf16 v[36:39], v[44:45], a[94:95], v[36:39]
v_and_b32_dpp v42, v22, v2 row_newbcast:4 row_mask:0xf bank_mask:0xf
v_and_b32_dpp v43, v22, v3 row_newbcast:4 row_mask:0xf bank_mask:0xf
s_cbranch_scc1 L_nw_37
s_waitcnt vmcnt(50)
s_cbranch_vccnz L_nw_37
s_waitcnt vmcnt(36)
L_nw_37:
v_mfma_f32_4x4x4_16b_bf16 v[32:35], v[40:41], a[96:97], v[32:35]
v_mfma_f32_4x4x4_16b_bf16 v[36:39], v[40:41], a[98:99], v[36:39]
v_and_b32_dpp v44, v22, v2 row_newbcast:8 row_mask:0xf bank_mask:0xf
v_and_b32_dpp v45, v22, v3 row_newbcast:8 row_mask:0xf bank_mask:0xf
v_mfma_f32_4x4x4_16b_bf16 v[32:35], v[42:43], a[100:101], v[32:35]
v_mfma_f32_4x4x4_16b_bf16 v[36:39], v[42:43], a[102:103], v[36:39]
v_and_b32_dpp v40, v22, v2 row_newbcast:12 row_mask:0xf bank_mask:0xf
v_and_b32_dpp v41, v22, v3 row_newbcast:12 row_mask:0xf bank_mask:0xf
v_mfma_f32_4x4x4_16b_bf16 v[32:35], v[44:45], a[104:105], v[32:35]
v_mfma_f32_4x4x4_16b_bf16 v[36:39], v[44:45], a[106:107], v[36:39]
v_and_b32_dpp v42, v23, v2 row_newbcast:0 row_mask:0xf bank_mask:0xf
v_and_b32_dpp v43, v23, v3 row_newbcast:0 row_mask:0xf bank_mask:0xf
v_mfma_f32_4x4x4_16b_bf16 v[32:35], v[40:41], a[108:109], v[32:35]
v_mfma_f32_4x4x4_16b_bf16 v[36:39], v[40:41], a[110:111], v[36:39]
v_and_b32_dpp v44, v23, v2 row_newbcast:4 row_mask:0xf bank_mask:0xf
v_and_b32_dpp v45, v23, v3 row_newbcast:4 row_mask:0xf bank_mask:0xf
s_cbranch_scc1 L_nw_38
s_waitcnt vmcnt(46)
s_cbranch_vccnz L_nw_38
s_waitcnt vmcnt(32)
L_nw_38:
v_mfma_f32_4x4x4_16b_bf16 v[32:35], v[42:43], a[112:113], v[32:35]
v_mfma_f32_4x4x4_16b_bf16 v[36:39], v[42:43], a[114:115], v[36:39]
v_and_b32_dpp v40, v23, v2 row_newbcast:8 row_mask:0xf bank_mask:0xf
v_and_b32_dpp v41, v23, v3 row_newbcast:8 row_mask:0xf bank_mask:0xf
v_mfma_f32_4x4x4_16b_bf16 v[32:35], v[44:45], a[116:117], v[32:35]
v_mfma_f32_4x4x4_16b_bf16 v[36:39], v[44:45], a[118:119], v[36:39]
v_and_b32_dpp v42, v23, v2 row_newbcast:12 row_mask:0xf bank_mask:0xf
v_and_b32_dpp v43, v23, v3 row_newbcast:12 row_mask:0xf bank_mask:0xf
v_mfma_f32_4x4x4_16b_bf16 v[32:35], v[40:41], a[120:121], v[32:35]
v_mfma_f32_4x4x4_16b_bf16 v[36:39], v[40:41], a[122:123], v[36:39]
v_and_b32_dpp v44, v24, v2 row_newbcast:0 row_mask:0xf bank_mask:0xf
v_and_b32_dpp v45, v24, v3 row_newbcast:0 row_mask:0xf bank_mask:0xf
v_mfma_f32_4x4x4_16b_bf16 v[32:35], v[42:43], a[124:125], v[32:35]
v_mfma_f32_4x4x4_16b_bf16 v[36:39], v[42:43], a[126:127], v[36:39]
v_and_b32_dpp v40, v24, v2 row_newbcast:4 row_mask:0xf bank_mask:0xf
v_and_b32_dpp v41, v24, v3 row_newbcast:4 row_mask:0xf bank_mask:0xf
s_cbranch_scc1 L_nw_39
s_waitcnt vmcnt(42)
s_cbranch_vccnz L_nw_39
s_waitcnt vmcnt(28)
L_nw_39:
v_mfma_f32_4x4x4_16b_bf16 v[32:35], v[44:45], a[128:129], v[32:35]
v_mfma_f32_4x4x4_16b_bf16 v[36:39], v[44:45], a[130:131], v[36:39]
v_and_b32_dpp v42, v24, v2 row_newbcast:8 row_mask:0xf bank_mask:0xf
v_and_b32_dpp v43, v24, v3 row_newbcast:8 row_mask:0xf bank_mask:0xf
v_mfma_f32_4x4x4_16b_bf16 v[32:35], v[40:41], a[132:133], v[32:35]
v_mfma_f32_4x4x4_16b_bf16 v[36:39], v[40:41], a[134:135], v[36:39]
v_and_b32_dpp v44, v24, v2 row_newbcast:12 row_mask:0xf bank_mask:0xf
v_and_b32_dpp v45, v24, v3 row_newbcast:12 row_mask:0xf bank_mask:0xf
v_mfma_f32_4x4x4_16b_bf16 v[32:35], v[42:43], a[136:137], v[32:35]
v_mfma_f32_4x4x4_16b_bf16 v[36:39], v[42:43], a[138:139], v[36:39]
v_and_b32_dpp v40, v25, v2 row_newbcast:0 row_mask:0xf bank_mask:0xf
v_and_b32_dpp v41, v25, v3 row_newbcast:0 row_mask:0xf bank_mask:0xf
v_mfma_f32_4x4x4_16b_bf16 v[32:35], v[44:45], a[140:141], v[32:35]
v_mfma_f32_4x4x4_16b_bf16 v[36:39], v[44:45], a[142:143], v[36:39]
v_and_b32_dpp v42, v25, v2 row_newbcast:4 row_mask:0xf bank_mask:0xf
v_and_b32_dpp v43, v25, v3 row_newbcast:4 row_mask:0xf bank_mask:0xf
s_cbranch_scc1 L_nw_40
s_waitcnt vmcnt(38)
s_cbranch_vccnz L_nw_40
s_waitcnt vmcnt(24)
L_nw_40:
v_mfma_f32_4x4x4_16b_bf16 v[32:35], v[40:41], a[144:145], v[32:35]
v_mfma_f32_4x4x4_16b_bf16 v[36:39], v[40:41], a[146:147], v[36:39]
v_and_b32_dpp v44, v25, v2 row_newbcast:8 row_mask:0xf bank_mask:0xf
v_and_b32_dpp v45, v25, v3 row_newbcast:8 row_mask:0xf bank_mask:0xf
v_mfma_f32_4x4x4_16b_bf16 v[32:35], v[42:43], a[148:149], v[32:35]
v_mfma_f32_4x4x4_16b_bf16 v[36:39], v[42:43], a[150:151], v[36:39]
v_and_b32_dpp v40, v25, v2 row_newbcast:12 row_mask:0xf bank_mask:0xf
v_and_b32_dpp v41, v25, v3 row_newbcast:12 row_mask:0xf bank_mask:0xf
v_mfma_f32_4x4x4_16b_bf16 v[32:35], v[44:45], a[152:153], v[32:35]
v_mfma_f32_4x4x4_16b_bf16 v[36:39], v[44:45], a[154:155], v[36:39]
v_and_b32_dpp v42, v26, v2 row_newbcast:0 row_mask:0xf bank_mask:0xf
v_and_b32_dpp v43, v26, v3 row_newbcast:0 row_mask:0xf bank_mask:0xf
v_mfma_f32_4x4x4_16b_bf16 v[32:35], v[40:41], a[156:157], v[32:35]
v_mfma_f32_4x4x4_16b_bf16 v[36:39], v[40:41], a[158:159], v[36:39]
v_and_b32_dpp v44, v26, v2 row_newbcast:4 row_mask:0xf bank_mask:0xf
v_and_b32_dpp v45, v26, v3 row_newbcast:4 row_mask:0xf bank_mask:0xf
s_cbranch_scc1 L_nw_41
s_waitcnt vmcnt(34)
s_cbranch_vccnz L_nw_41
s_waitcnt vmcnt(20)
L_nw_41:
v_mfma_f32_4x4x4_16b_bf16 v[32:35], v[42:43], a[160:161], v[32:35]
v_mfma_f32_4x4x4_16b_bf16 v[36:39], v[42:43], a[162:163], v[36:39]
v_and_b32_dpp v40, v26, v2 row_newbcast:8 row_mask:0xf bank_mask:0xf
v_and_b32_dpp v41, v26, v3 row_newbcast:8 row_mask:0xf bank_mask:0xf
v_mfma_f32_4x4x4_16b_bf16 v[32:35], v[44:45], a[164:165], v[32:35]
v_mfma_f32_4x4x4_16b_bf16 v[36:39], v[44:45], a[166:167], v[36:39]
v_and_b32_dpp v42, v26, v2 row_newbcast:12 row_mask:0xf bank_mask:0xf
v_and_b32_dpp v43, v26, v3 row_newbcast:12 row_mask:0xf bank_mask:0xf
v_mfma_f32_4x4x4_16b_bf16 v[32:35], v[40:41], a[168:169], v[32:35]
v_mfma_f32_4x4x4_16b_bf16 v[36:39], v[40:41], a[170:171], v[36:39]
v_and_b32_dpp v44, v27, v2 row_newbcast:0 row_mask:0xf bank_mask:0xf
v_and_b32_dpp v45, v27, v3 row_newbcast:0 row_mask:0xf bank_mask:0xf
v_mfma_f32_4x4x4_16b_bf16 v[32:35], v[42:43], a[172:173], v[32:35]
v_mfma_f32_4x4x4_16b_bf16 v[36:39], v[42:43], a[174:175], v[36:39]
v_and_b32_dpp v40, v27, v2 row_newbcast:4 row_mask:0xf bank_mask:0xf
v_and_b32_dpp v41, v27, v3 row_newbcast:4 row_mask:0xf bank_mask:0xf
s_cbranch_scc1 L_nw_42
s_waitcnt vmcnt(30)
s_cbranch_vccnz L_nw_42
s_waitcnt vmcnt(16)
L_nw_42:
v_mfma_f32_4x4x4_16b_bf16 v[32:35], v[44:45], a[176:177], v[32:35]
v_mfma_f32_4x4x4_16b_bf16 v[36:39], v[44:45], a[178:179], v[36:39]
v_and_b32_dpp v42, v27, v2 row_newbcast:8 row_mask:0xf bank_mask:0xf
v_and_b32_dpp v43, v27, v3 row_newbcast:8 row_mask:0xf bank_mask:0xf
v_mfma_f32_4x4x4_16b_bf16 v[32:35], v[40:41], a[180:181], v[32:35]
v_mfma_f32_4x4x4_16b_bf16 v[36:39], v[40:41], a[182:183], v[36:39]
v_and_b32_dpp v44, v27, v2 row_newbcast:12 row_mask:0xf bank_mask:0xf
v_and_b32_dpp v45, v27, v3 row_newbcast:12 row_mask:0xf bank_mask:0xf
v_mfma_f32_4x4x4_16b_bf16 v[32:35], v[42:43], a[184:185], v[32:35]
v_mfma_f32_4x4x4_16b_bf16 v[36:39], v[42:43], a[186:187], v[36:39]
v_and_b32_dpp v40, v28, v2 row_newbcast:0 row_mask:0xf bank_mask:0xf
v_and_b32_dpp v41, v28, v3 row_newbcast:0 row_mask:0xf bank_mask:0xf
v_mfma_f32_4x4x4_16b_bf16 v[32:35], v[44:45], a[188:189], v[32:35]
v_mfma_f32_4x4x4_16b_bf16 v[36:39], v[44:45], a[190:191], v[36:39]
v_and_b32_dpp v42, v28, v2 row_newbcast:4 row_mask:0xf bank_mask:0xf
v_and_b32_dpp v43, v28, v3 row_newbcast:4 row_mask:0xf bank_mask:0xf
s_cbranch_scc1 L_nw_43
s_waitcnt vmcnt(26)
s_cbranch_vccnz L_nw_43
s_waitcnt vmcnt(12)
L_nw_43:
v_mfma_f32_4x4x4_16b_bf16 v[32:35], v[40:41], a[192:193], v[32:35]
v_mfma_f32_4x4x4_16b_bf16 v[36:39], v[40:41], a[194:195], v[36:39]
v_and_b32_dpp v44, v28, v2 row_newbcast:8 row_mask:0xf bank_mask:0xf
v_and_b32_dpp v45, v28, v3 row_newbcast:8 row_mask:0xf bank_mask:0xf
v_mfma_f32_4x4x4_16b_bf16 v[32:35], v[42:43], a[196:197], v[32:35]
v_mfma_f32_4x4x4_16b_bf16 v[36:39], v[42:43], a[198:199], v[36:39]
v_and_b32_dpp v40, v28, v2 row_newbcast:12 row_mask:0xf bank_mask:0xf
v_and_b32_dpp v41, v28, v3 row_newbcast:12 row_mask:0xf bank_mask:0xf
v_mfma_f32_4x4x4_16b_bf16 v[32:35], v[44:45], a[200:201], v[32:35]
v_mfma_f32_4x4x4_16b_bf16 v[36:39], v[44:45], a[202:203], v[36:39]
v_and_b32_dpp v42, v29, v2 row_newbcast:0 row_mask:0xf bank_mask:0xf
v_and_b32_dpp v43, v29, v3 row_newbcast:0 row_mask:0xf bank_mask:0xf
v_mfma_f32_4x4x4_16b_bf16 v[32:35], v[40:41], a[204:205], v[32:35]
v_mfma_f32_4x4x4_16b_bf16 v[36:39], v[40:41], a[206:207], v[36:39]
v_and_b32_dpp v44, v29, v2 row_newbcast:4 row_mask:0xf bank_mask:0xf
v_and_b32_dpp v45, v29, v3 row_newbcast:4 row_mask:0xf bank_mask:0xf
s_cbranch_scc1 L_nw_44
s_waitcnt vmcnt(22)
s_cbranch_vccnz L_nw_44
s_waitcnt vmcnt(8)
L_nw_44:
v_mfma_f32_4x4x4_16b_bf16 v[32:35], v[42:43], a[208:209], v[32:35]
v_mfma_f32_4x4x4_16b_bf16 v[36:39], v[42:43], a[210:211], v[36:39]
v_and_b32_dpp v40, v29, v2 row_newbcast:8 row_mask:0xf bank_mask:0xf
v_and_b32_dpp v41, v29, v3 row_newbcast:8 row_mask:0xf bank_mask:0xf
v_mfma_f32_4x4x4_16b_bf16 v[32:35], v[44:45], a[212:213], v[32:35]
v_mfma_f32_4x4x4_16b_bf16 v[36:39], v[44:45], a[214:215], v[36:39]
v_and_b32_dpp v42, v29, v2 row_newbcast:12 row_mask:0xf bank_mask:0xf
v_and_b32_dpp v43, v29, v3 row_newbcast:12 row_mask:0xf bank_mask:0xf
v_mfma_f32_4x4x4_16b_bf16 v[32:35], v[40:41], a[216:217], v[32:35]
v_mfma_f32_4x4x4_16b_bf16 v[36:39], v[40:41], a[218:219], v[36:39]
v_and_b32_dpp v44, v30, v2 row_newbcast:0 row_mask:0xf bank_mask:0xf
v_and_b32_dpp v45, v30, v3 row_newbcast:0 row_mask:0xf bank_mask:0xf
v_mfma_f32_4x4x4_16b_bf16 v[32:35], v[42:43], a[220:221], v[32:35]
v_mfma_f32_4x4x4_16b_bf16 v[36:39], v[42:43], a[222:223], v[36:39]
v_and_b32_dpp v40, v30, v2 row_newbcast:4 row_mask:0xf bank_mask:0xf
v_and_b32_dpp v41, v30, v3 row_newbcast:4 row_mask:0xf bank_mask:0xf
s_cbranch_scc1 L_nw_45
s_waitcnt vmcnt(18)
s_cbranch_vccnz L_nw_45
s_waitcnt vmcnt(4)
L_nw_45:
v_mfma_f32_4x4x4_16b_bf16 v[32:35], v[44:45], a[224:225], v[32:35]
v_mfma_f32_4x4x4_16b_bf16 v[36:39], v[44:45], a[226:227], v[36:39]
v_and_b32_dpp v42, v30, v2 row_newbcast:8 row_mask:0xf bank_mask:0xf
v_and_b32_dpp v43, v30, v3 row_newbcast:8 row_mask:0xf bank_mask:0xf
v_mfma_f32_4x4x4_16b_bf16 v[32:35], v[40:41], a[228:229], v[32:35]
v_mfma_f32_4x4x4_16b_bf16 v[36:39], v[40:41], a[230:231], v[36:39]
v_and_b32_dpp v44, v30, v2 row_newbcast:12 row_mask:0xf bank_mask:0xf
v_and_b32_dpp v45, v30, v3 row_newbcast:12 row_mask:0xf bank_mask:0xf
v_mfma_f32_4x4x4_16b_bf16 v[32:35], v[42:43], a[232:233], v[32:35]
v_mfma_f32_4x4x4_16b_bf16 v[36:39], v[42:43], a[234:235], v[36:39]
v_and_b32_dpp v40, v31, v2 row_newbcast:0 row_mask:0xf bank_mask:0xf
v_and_b32_dpp v41, v31, v3 row_newbcast:0 row_mask:0xf bank_mask:0xf
v_mfma_f32_4x4x4_16b_bf16 v[32:35], v[44:45], a[236:237], v[32:35]
v_mfma_f32_4x4x4_16b_bf16 v[36:39], v[44:45], a[238:239], v[36:39]
v_and_b32_dpp v42, v31, v2 row_newbcast:4 row_mask:0xf bank_mask:0xf
v_and_b32_dpp v43, v31, v3 row_newbcast:4 row_mask:0xf bank_mask:0xf
s_cbranch_scc1 L_nw_46
s_waitcnt vmcnt(14)
s_cbranch_vccnz L_nw_46
s_waitcnt vmcnt(0)
L_nw_46:
v_mfma_f32_4x4x4_16b_bf16 v[32:35], v[40:41], a[240:241], v[32:35]
v_mfma_f32_4x4x4_16b_bf16 v[36:39], v[40:41], a[242:243], v[36:39]
v_and_b32_dpp v44, v31, v2 row_newbcast:8 row_mask:0xf bank_mask:0xf
v_and_b32_dpp v45, v31, v3 row_newbcast:8 row_mask:0xf bank_mask:0xf
v_mfma_f32_4x4x4_16b_bf16 v[32:35], v[42:43], a[244:245], v[32:35]
v_mfma_f32_4x4x4_16b_bf16 v[36:39], v[42:43], a[246:247], v[36:39]
v_and_b32_dpp v40, v31, v2 row_newbcast:12 row_mask:0xf bank_mask:0xf
v_and_b32_dpp v41, v31, v3 row_newbcast:12 row_mask:0xf bank_mask:0xf
v_mfma_f32_4x4x4_16b_bf16 v[32:35], v[44:45], a[248:249], v[32:35]
v_mfma_f32_4x4x4_16b_bf16 v[36:39], v[44:45], a[250:251], v[36:39]
s_nop 1
v_mfma_f32_4x4x4_16b_bf16 v[32:35], v[40:41], a[252:253], v[32:35]
v_mfma_f32_4x4x4_16b_bf16 v[36:39], v[40:41], a[254:255], v[36:39]
L_pvdone:
s_nop 4
v_permlane32_swap_b32 v32, v36
v_permlane32_swap_b32 v33, v37
v_permlane32_swap_b32 v34, v38
v_permlane32_swap_b32 v35, v39
v_add_f32 v32, v32, v36
v_add_f32 v33, v33, v37
v_add_f32 v34, v34, v38
v_add_f32 v35, v35, v39
s_nop 0
v_permlane16_swap_b32 v32, v33
v_permlane16_swap_b32 v34, v35
v_add_f32 v32, v32, v33
v_add_f32 v34, v34, v35
s_mul_i32 s32, s62, 2112
s_add_u32 s32, s32, 147456
s_xor_b32 s62, s62, 1
s_lshl_b32 s33, s3, 9
s_add_u32 s33, s33, s32
v_and_b32 v60, 15, v0
v_lshlrev_b32 v60, 5, v60
v_lshrrev_b32 v61, 5, v0
v_lshl_add_u32 v60, v61, 4, v60
v_bfe_u32 v61, v0, 4, 1
v_lshl_add_u32 v60, v61, 2, v60
v_add_u32 v60, s33, v60
ds_write2_b32 v60, v32, v34 offset0:0 offset1:2
s_lshl_b32 s33, s3, 3
s_add_u32 s33, s33, s32
v_mov_b32 v60, s33
v_mov_b32 v62, v58
v_mov_b32 v63, v59
s_mov_b64 exec, 1
ds_write_b64 v60, v[62:63] offset:2048
s_mov_b64 exec, -1
s_waitcnt lgkmcnt(0)
s_barrier
s_cmp_lg_u32 s3, 0
s_cbranch_scc1 L_npub_47
v_and_b32 v60, 31, v0
v_lshlrev_b32 v60, 4, v60
v_add_u32 v60, s32, v60
ds_read_b128 v[16:19], v60 offset:0
ds_read_b128 v[20:23], v60 offset:512
ds_read_b128 v[24:27], v60 offset:1024
ds_read_b128 v[28:31], v60 offset:1536
v_mov_b32 v61, s32
ds_read_b128 v[40:43], v61 offset:2048
ds_read_b128 v[44:47], v61 offset:2064
s_waitcnt lgkmcnt(0)
v_max_f32 v32, v40, v42
v_max3_f32 v32, v32, v44, v46
v_sub_f32 v40, v40, v32
v_sub_f32 v42, v42, v32
v_sub_f32 v44, v44, v32
v_sub_f32 v46, v46, v32
v_exp_f32 v40, v40
v_exp_f32 v42, v42
v_exp_f32 v44, v44
v_exp_f32 v46, v46
s_nop 0
v_mul_f32 v36, v16, v40
v_mul_f32 v37, v17, v40
v_mul_f32 v38, v18, v40
v_mul_f32 v39, v19, v40
v_mul_f32 v33, v41, v40
v_fmac_f32 v36, v20, v42
v_fmac_f32 v37, v21, v42
v_fmac_f32 v38, v22, v42
v_fmac_f32 v39, v23, v42
v_fmac_f32 v33, v43, v42
v_fmac_f32 v36, v24, v44
v_fmac_f32 v37, v25, v44
v_fmac_f32 v38, v26, v44
v_fmac_f32 v39, v27, v44
v_fmac_f32 v33, v45, v44
v_fmac_f32 v36, v28, v46
v_fmac_f32 v37, v29, v46
v_fmac_f32 v38, v30, v46
v_fmac_f32 v39, v31, v46
v_fmac_f32 v33, v47, v46
s_mul_i32 s32, s27, 131072
s_lshl_b32 s33, s24, 12
s_add_u32 s32, s32, s33
s_lshl_b32 s33, s25, 9
s_add_u32 s32, s32, s33
v_lshlrev_b32 v60, 4, v0
v_add_u32 v60, s32, v60
s_mov_b32 exec_hi, 0
global_store_dwordx4 v60, v[36:39], s[16:17] sc1
s_mov_b64 exec, -1
s_mul_i32 s32, s27, 2048
s_add_u32 s32, s32, 524288
s_lshl_b32 s33, s24, 6
s_add_u32 s32, s32, s33
s_and_b32 s33, s25, 1
s_lshl_b32 s33, s33, 5
s_add_u32 s32, s32, s33
s_lshr_b32 s33, s25, 1
s_lshl_b32 s33, s33, 3
s_add_u32 s32, s32, s33
v_mov_b32 v60, s32
s_mov_b64 exec, 1
global_store_dwordx2 v60, v[32:33], s[16:17] sc1
s_mov_b64 exec, -1
L_npub_47:
s_cmp_eq_u32 s59, 0
s_cbranch_scc0 L_disp
s_cmp_eq_u32 s27, 1
s_cbranch_scc1 L_mid2
s_cmp_eq_u32 s27, 0
s_cbranch_scc1 L_wload
s_branch L_disp
L_s1:
s_cmp_eq_u32 s59, 2
s_cbranch_scc0 L_nwo_48
s_lshl_b32 s44, s52, 9
s_lshl_b32 s45, s53, 7
v_lshrrev_b32 v48, 3, v0
v_mul_u32_u24 v48, 20480, v48
v_and_b32 v49, 7, v0
v_lshl_add_u32 v48, v49, 4, v48
s_mul_i32 s42, s3, 128
s_add_u32 s42, s42, s44
s_mul_i32 s42, s42, 1280
s_add_u32 s42, s42, s45
s_mul_i32 s43, s3, 16384
s_add_u32 s43, s43, 65536
s_mov_b32 m0, s43
s_add_u32 s43, s43, 1024
buffer_load_dwordx4 v48, s[12:15], s42 offen lds
s_add_u32 s42, s42, 1280
s_mov_b32 m0, s43
s_add_u32 s43, s43, 1024
buffer_load_dwordx4 v48, s[12:15], s42 offen lds
s_add_u32 s42, s42, 1280
s_mov_b32 m0, s43
s_add_u32 s43, s43, 1024
buffer_load_dwordx4 v48, s[12:15], s42 offen lds
s_add_u32 s42, s42, 1280
s_mov_b32 m0, s43
s_add_u32 s43, s43, 1024
buffer_load_dwordx4 v48, s[12:15], s42 offen lds
s_add_u32 s42, s42, 1280
s_mov_b32 m0, s43
s_add_u32 s43, s43, 1024
buffer_load_dwordx4 v48, s[12:15], s42 offen lds
s_add_u32 s42, s42, 1280
s_mov_b32 m0, s43
s_add_u32 s43, s43, 1024
buffer_load_dwordx4 v48, s[12:15], s42 offen lds
s_add_u32 s42, s42, 1280
s_mov_b32 m0, s43
s_add_u32 s43, s43, 1024
buffer_load_dwordx4 v48, s[12:15], s42 offen lds
s_add_u32 s42, s42, 1280
s_mov_b32 m0, s43
s_add_u32 s43, s43, 1024
buffer_load_dwordx4 v48, s[12:15], s42 offen lds
s_add_u32 s42, s42, 1280
s_mov_b32 m0, s43
s_add_u32 s43, s43, 1024
buffer_load_dwordx4 v48, s[12:15], s42 offen lds
s_add_u32 s42, s42, 1280
s_mov_b32 m0, s43
s_add_u32 s43, s43, 1024
buffer_load_dwordx4 v48, s[12:15], s42 offen lds
s_add_u32 s42, s42, 1280
s_mov_b32 m0, s43
s_add_u32 s43, s43, 1024
buffer_load_dwordx4 v48, s[12:15], s42 offen lds
s_add_u32 s42, s42, 1280
s_mov_b32 m0, s43
s_add_u32 s43, s43, 1024
buffer_load_dwordx4 v48, s[12:15], s42 offen lds
s_add_u32 s42, s42, 1280
s_mov_b32 m0, s43
s_add_u32 s43, s43, 1024
buffer_load_dwordx4 v48, s[12:15], s42 offen lds
s_add_u32 s42, s42, 1280
s_mov_b32 m0, s43
s_add_u32 s43, s43, 1024
buffer_load_dwordx4 v48, s[12:15], s42 offen lds
s_add_u32 s42, s42, 1280
s_mov_b32 m0, s43
s_add_u32 s43, s43, 1024
buffer_load_dwordx4 v48, s[12:15], s42 offen lds
s_add_u32 s42, s42, 1280
s_mov_b32 m0, s43
s_add_u32 s43, s43, 1024
buffer_load_dwordx4 v48, s[12:15], s42 offen lds
s_add_u32 s42, s42, 1280
L_nwo_48:
s_mul_i32 s42, s3, 16384
s_add_u32 s42, s42, 65536
v_lshlrev_b32 v8, 4, v0
v_add_u32 v8, s42, v8
v_lshrrev_b32 v58, 3, v0
v_mul_u32_u24 v9, 64, v58
s_mul_i32 s42, s3, 512
s_add_u32 s42, s42, 151808
v_add_u32 v9, s42, v9
v_and_b32 v10, 7, v0
v_lshlrev_b32 v10, 3, v10
v_lshrrev_b32 v59, 5, v0
v_lshl_add_u32 v10, v59, 2, v10
v_bfe_u32 v59, v0, 4, 1
v_add_u32 v10, v10, v59
v_bfe_u32 v59, v0, 3, 1
v_lshl_add_u32 v10, v59, 1, v10
s_lshl_b32 s42, s3, 8
s_add_u32 s42, s42, 154624
v_lshlrev_b32 v10, 2, v10
v_add_u32 v10, s42, v10
s_lshl_b32 s42, s52, 2
s_add_u32 s42, s42, s3
v_lshrrev_b32 v58, 5, v0
v_and_b32 v59, 31, v0
v_lshlrev_b32 v59, 4, v59
v_lshl_add_u32 v11, v58, 9, v59
s_lshl_b32 s43, s42, 12
v_add_u32 v11, s43, v11
v_lshlrev_b32 v14, 5, v58
s_lshl_b32 s43, s42, 6
v_add_u32 v14, s43, v14
v_lshl_add_u32 v12, v58, 2, v59
s_lshl_b32 s43, s3, 9
s_add_u32 s43, s43, 151808
v_add_u32 v12, s43, v12
s_mul_i32 s32, s27, 131072
v_add_u32 v50, s32, v11
s_mul_i32 s32, s27, 2048
s_add_u32 s32, s32, 524288
v_add_u32 v51, s32, v14
s_mov_b32 s31, 0
L_poll_49:
global_load_dwordx4 v[16:19], v50, s[16:17] offset:0 sc1
global_load_dwordx4 v[20:23], v50, s[16:17] offset:1024 sc1
global_load_dwordx4 v[24:27], v50, s[16:17] offset:2048 sc1
global_load_dwordx4 v[28:31], v50, s[16:17] offset:3072 sc1
global_load_dwordx4 v[32:35], v51, s[16:17] sc1
global_load_dwordx4 v[36:39], v51, s[16:17] offset:16 sc1
s_waitcnt vmcnt(0)
v_max_u32 v58, v16, v17
v_max3_u32 v58, v58, v18, v19
v_max3_u32 v58, v58, v20, v21
v_max3_u32 v58, v58, v22, v23
v_max3_u32 v58, v58, v24, v25
v_max3_u32 v58, v58, v26, v27
v_max3_u32 v58, v58, v28, v29
v_max3_u32 v58, v58, v30, v31
v_max3_u32 v58, v58, v32, v33
v_max3_u32 v58, v58, v34, v35
v_max3_u32 v58, v58, v36, v37
v_max3_u32 v58, v58, v38, v39
v_cmp_eq_u32 vcc, -1, v58
s_nop 1
s_cmp_lg_u64 vcc, 0
s_cbranch_scc1 L_again_50
s_branch L_pdone_51
L_again_50:
s_add_u32 s31, s31, 1
s_cmp_lt_u32 s31, 200000
s_cbranch_scc1 L_poll_49
L_pdone_51:
v_max_f32 v40, v32, v34
v_max3_f32 v40, v40, v36, v38
v_mov_b32 v41, v40
s_nop 1
v_permlane32_swap_b32 v40, v41
v_max_f32 v40, v40, v41
v_sub_f32 v32, v32, v40
v_sub_f32 v34, v34, v40
v_sub_f32 v36, v36, v40
v_sub_f32 v38, v38, v40
v_exp_f32 v32, v32
v_exp_f32 v34, v34
v_exp_f32 v36, v36
v_exp_f32 v38, v38
s_nop 0
v_mul_f32 v42, v33, v32
v_fmac_f32 v42, v35, v34
v_fmac_f32 v42, v37, v36
v_fmac_f32 v42, v39, v38
v_mul_f32 v44, v16, v32
v_mul_f32 v45, v17, v32
v_mul_f32 v46, v18, v32
v_mul_f32 v47, v19, v32
v_fmac_f32 v44, v20, v34
v_fmac_f32 v45, v21, v34
v_fmac_f32 v46, v22, v34
v_fmac_f32 v47, v23, v34
v_fmac_f32 v44, v24, v36
v_fmac_f32 v45, v25, v36
v_fmac_f32 v46, v26, v36
v_fmac_f32 v47, v27, v36
v_fmac_f32 v44, v28, v38
v_fmac_f32 v45, v29, v38
v_fmac_f32 v46, v30, v38
v_fmac_f32 v47, v31, v38
v_mov_b32 v43, v42
s_nop 1
v_permlane32_swap_b32 v42, v43
v_permlane32_swap_b32 v44, v45
v_permlane32_swap_b32 v46, v47
v_add_f32 v42, v42, v43
v_add_f32 v44, v44, v45
v_add_f32 v46, v46, v47
v_rcp_f32 v42, v42
s_nop 0
v_mul_f32 v44, v44, v42
v_mul_f32 v46, v46, v42
v_cvt_pk_bf16_f32 v44, v44, v44
v_cvt_pk_bf16_f32 v46, v46, v46
ds_write2_b32 v12, v44, v46 offset0:0 offset1:2
s_waitcnt lgkmcnt(0)
ds_read_b128 v[48:51], v8 offset:0
ds_read_b128 v[52:55], v8 offset:1024
ds_read_b128 v[56:59], v8 offset:2048
ds_read_b128 v[60:63], v8 offset:3072
ds_read_b128 v[16:19], v9 offset:0
ds_read_b128 v[20:23], v9 offset:16
ds_read_b128 v[24:27], v9 offset:32
ds_read_b128 v[28:31], v9 offset:48
v_mov_b32 v36, 0
v_mov_b32 v37, 0
v_mov_b32 v38, 0
v_mov_b32 v39, 0
v_mov_b32 v40, 0
v_mov_b32 v41, 0
v_mov_b32 v42, 0
v_mov_b32 v43, 0
s_waitcnt lgkmcnt(3)
v_and_b32 v44, v16, v2
v_and_b32 v45, v16, v3
v_and_b32 v46, v17, v2
v_and_b32 v47, v17, v3
s_nop 1
v_mfma_f32_4x4x4_16b_bf16 v[36:39], v[44:45], v[48:49], v[36:39]
v_mfma_f32_4x4x4_16b_bf16 v[40:43], v[44:45], v[50:51], v[40:43]
ds_read_b128 v[48:51], v8 offset:4096
v_and_b32 v44, v18, v2
v_and_b32 v45, v18, v3
v_mfma_f32_4x4x4_16b_bf16 v[36:39], v[46:47], v[52:53], v[36:39]
v_mfma_f32_4x4x4_16b_bf16 v[40:43], v[46:47], v[54:55], v[40:43]
ds_read_b128 v[52:55], v8 offset:5120
v_and_b32 v46, v19, v2
v_and_b32 v47, v19, v3
v_mfma_f32_4x4x4_16b_bf16 v[36:39], v[44:45], v[56:57], v[36:39]
v_mfma_f32_4x4x4_16b_bf16 v[40:43], v[44:45], v[58:59], v[40:43]
ds_read_b128 v[56:59], v8 offset:6144
s_waitcnt lgkmcnt(5)
v_and_b32 v44, v20, v2
v_and_b32 v45, v20, v3
v_mfma_f32_4x4x4_16b_bf16 v[36:39], v[46:47], v[60:61], v[36:39]
v_mfma_f32_4x4x4_16b_bf16 v[40:43], v[46:47], v[62:63], v[40:43]
ds_read_b128 v[60:63], v8 offset:7168
v_and_b32 v46, v21, v2
v_and_b32 v47, v21, v3
s_waitcnt lgkmcnt(3)
v_mfma_f32_4x4x4_16b_bf16 v[36:39], v[44:45], v[48:49], v[36:39]
v_mfma_f32_4x4x4_16b_bf16 v[40:43], v[44:45], v[50:51], v[40:43]
ds_read_b128 v[48:51], v8 offset:8192
v_and_b32 v44, v22, v2
v_and_b32 v45, v22, v3
s_waitcnt lgkmcnt(3)
v_mfma_f32_4x4x4_16b_bf16 v[36:39], v[46:47], v[52:53], v[36:39]
v_mfma_f32_4x4x4_16b_bf16 v[40:43], v[46:47], v[54:55], v[40:43]
ds_read_b128 v[52:55], v8 offset:9216
v_and_b32 v46, v23, v2
v_and_b32 v47, v23, v3
s_waitcnt lgkmcnt(3)
v_mfma_f32_4x4x4_16b_bf16 v[36:39], v[44:45], v[56:57], v[36:39]
v_mfma_f32_4x4x4_16b_bf16 v[40:43], v[44:45], v[58:59], v[40:43]
ds_read_b128 v[56:59], v8 offset:10240
v_and_b32 v44, v24, v2
v_and_b32 v45, v24, v3
s_waitcnt lgkmcnt(3)
v_mfma_f32_4x4x4_16b_bf16 v[36:39], v[46:47], v[60:61], v[36:39]
v_mfma_f32_4x4x4_16b_bf16 v[40:43], v[46:47], v[62:63], v[40:43]
ds_read_b128 v[60:63], v8 offset:11264
v_and_b32 v46, v25, v2
v_and_b32 v47, v25, v3
s_waitcnt lgkmcnt(3)
v_mfma_f32_4x4x4_16b_bf16 v[36:39], v[44:45], v[48:49], v[36:39]
v_mfma_f32_4x4x4_16b_bf16 v[40:43], v[44:45], v[50:51], v[40:43]
ds_read_b128 v[48:51], v8 offset:12288
v_and_b32 v44, v26, v2
v_and_b32 v45, v26, v3
s_waitcnt lgkmcnt(3)
v_mfma_f32_4x4x4_16b_bf16 v[36:39], v[46:47], v[52:53], v[36:39]
v_mfma_f32_4x4x4_16b_bf16 v[40:43], v[46:47], v[54:55], v[40:43]
ds_read_b128 v[52:55], v8 offset:13312
v_and_b32 v46, v27, v2
v_and_b32 v47, v27, v3
s_waitcnt lgkmcnt(3)
v_mfma_f32_4x4x4_16b_bf16 v[36:39], v[44:45], v[56:57], v[36:39]
v_mfma_f32_4x4x4_16b_bf16 v[40:43], v[44:45], v[58:59], v[40:43]
ds_read_b128 v[56:59], v8 offset:14336
v_and_b32 v44, v28, v2
v_and_b32 v45, v28, v3
s_waitcnt lgkmcnt(3)
v_mfma_f32_4x4x4_16b_bf16 v[36:39], v[46:47], v[60:61], v[36:39]
v_mfma_f32_4x4x4_16b_bf16 v[40:43], v[46:47], v[62:63], v[40:43]
ds_read_b128 v[60:63], v8 offset:15360
v_and_b32 v46, v29, v2
v_and_b32 v47, v29, v3
s_waitcnt lgkmcnt(3)
v_mfma_f32_4x4x4_16b_bf16 v[36:39], v[44:45], v[48:49], v[36:39]
v_mfma_f32_4x4x4_16b_bf16 v[40:43], v[44:45], v[50:51], v[40:43]
v_and_b32 v44, v30, v2
v_and_b32 v45, v30, v3
s_waitcnt lgkmcnt(2)
v_mfma_f32_4x4x4_16b_bf16 v[36:39], v[46:47], v[52:53], v[36:39]
v_mfma_f32_4x4x4_16b_bf16 v[40:43], v[46:47], v[54:55], v[40:43]
v_and_b32 v46, v31, v2
v_and_b32 v47, v31, v3
s_waitcnt lgkmcnt(1)
v_mfma_f32_4x4x4_16b_bf16 v[36:39], v[44:45], v[56:57], v[36:39]
v_mfma_f32_4x4x4_16b_bf16 v[40:43], v[44:45], v[58:59], v[40:43]
s_waitcnt lgkmcnt(0)
v_mfma_f32_4x4x4_16b_bf16 v[36:39], v[46:47], v[60:61], v[36:39]
v_mfma_f32_4x4x4_16b_bf16 v[40:43], v[46:47], v[62:63], v[40:43]
s_nop 4
v_permlane32_swap_b32 v36, v40
v_permlane32_swap_b32 v37, v41
v_permlane32_swap_b32 v38, v42
v_permlane32_swap_b32 v39, v43
v_add_f32 v36, v36, v40
v_add_f32 v37, v37, v41
v_add_f32 v38, v38, v42
v_add_f32 v39, v39, v43
s_nop 0
v_permlane16_swap_b32 v36, v37
v_permlane16_swap_b32 v38, v39
v_add_f32 v36, v36, v37
v_add_f32 v38, v38, v39
s_nop 1
v_add_f32_dpp v44, v36, v36 row_ror:8 row_mask:0xf bank_mask:0x3
v_add_f32_dpp v44, v38, v38 row_ror:8 row_mask:0xf bank_mask:0xc
ds_write_b32 v10, v44
s_waitcnt lgkmcnt(0)
s_barrier
s_cmp_lg_u32 s3, 0
s_cbranch_scc1 L_s1w_52
v_lshlrev_b32 v58, 2, v0
v_add_u32 v59, 154624, v58
ds_read2_b32 v[16:17], v59 offset0:0 offset1:64
ds_read2_b32 v[18:19], v59 offset0:128 offset1:192
s_waitcnt lgkmcnt(0)
v_add_f32 v16, v16, v17
v_add_f32 v18, v18, v19
v_add_f32 v30, v16, v18
s_mul_i32 s32, s27, 20480
s_add_u32 s32, s32, 532480
s_mul_i32 s33, s52, 2560
s_add_u32 s32, s32, s33
s_lshl_b32 s33, s53, 8
s_add_u32 s32, s32, s33
v_add_u32 v58, s32, v58
v_mov_b32_dpp v32, v30 quad_perm:[0,0,0,0] row_mask:0xf bank_mask:0xf
v_mov_b32_dpp v33, v30 quad_perm:[1,1,1,1] row_mask:0xf bank_mask:0xf
v_mov_b32_dpp v34, v30 quad_perm:[2,2,2,2] row_mask:0xf bank_mask:0xf
v_mov_b32_dpp v35, v30 quad_perm:[3,3,3,3] row_mask:0xf bank_mask:0xf
s_mov_b32 exec_lo, 0x11111111
s_mov_b32 exec_hi, 0x11111111
global_store_dwordx4 v58, v[32:35], s[16:17] sc1
s_mov_b64 exec, -1
L_s1w_52:
s_cmp_eq_u32 s58, 1
s_cbranch_scc0 L_s1nr_53
s_cmp_lt_u32 s27, 2
s_cbranch_scc0 L_s1nr_53
s_lshl_b32 s45, s29, 7
v_lshrrev_b32 v16, 3, v0
v_mul_u32_u24 v16, 163840, v16
v_and_b32 v17, 7, v0
v_lshl_add_u32 v16, v17, 4, v16
s_mul_i32 s42, s3, 160
s_mul_i32 s42, s42, 8192
s_add_u32 s42, s42, s45
s_mul_i32 s43, s3, 20480
s_add_u32 s43, s43, 65536
s_mov_b32 m0, s43
s_add_u32 s43, s43, 1024
buffer_load_dwordx4 v16, s[96:99], s42 offen lds
s_add_u32 s42, s42, 8192
s_mov_b32 m0, s43
s_add_u32 s43, s43, 1024
buffer_load_dwordx4 v16, s[96:99], s42 offen lds
s_add_u32 s42, s42, 8192
s_mov_b32 m0, s43
s_add_u32 s43, s43, 1024
buffer_load_dwordx4 v16, s[96:99], s42 offen lds
s_add_u32 s42, s42, 8192
s_mov_b32 m0, s43
s_add_u32 s43, s43, 1024
buffer_load_dwordx4 v16, s[96:99], s42 offen lds
s_add_u32 s42, s42, 8192
s_mov_b32 m0, s43
s_add_u32 s43, s43, 1024
buffer_load_dwordx4 v16, s[96:99], s42 offen lds
s_add_u32 s42, s42, 8192
s_mov_b32 m0, s43
s_add_u32 s43, s43, 1024
buffer_load_dwordx4 v16, s[96:99], s42 offen lds
s_add_u32 s42, s42, 8192
s_mov_b32 m0, s43
s_add_u32 s43, s43, 1024
buffer_load_dwordx4 v16, s[96:99], s42 offen lds
s_add_u32 s42, s42, 8192
s_mov_b32 m0, s43
s_add_u32 s43, s43, 1024
buffer_load_dwordx4 v16, s[96:99], s42 offen lds
s_add_u32 s42, s42, 8192
s_mov_b32 m0, s43
s_add_u32 s43, s43, 1024
buffer_load_dwordx4 v16, s[96:99], s42 offen lds
s_add_u32 s42, s42, 8192
s_mov_b32 m0, s43
s_add_u32 s43, s43, 1024
buffer_load_dwordx4 v16, s[96:99], s42 offen lds
s_add_u32 s42, s42, 8192
s_mov_b32 m0, s43
s_add_u32 s43, s43, 1024
buffer_load_dwordx4 v16, s[96:99], s42 offen lds
s_add_u32 s42, s42, 8192
s_mov_b32 m0, s43
s_add_u32 s43, s43, 1024
buffer_load_dwordx4 v16, s[96:99], s42 offen lds
s_add_u32 s42, s42, 8192
s_mov_b32 m0, s43
s_add_u32 s43, s43, 1024
buffer_load_dwordx4 v16, s[96:99], s42 offen lds
s_add_u32 s42, s42, 8192
s_mov_b32 m0, s43
s_add_u32 s43, s43, 1024
buffer_load_dwordx4 v16, s[96:99], s42 offen lds
s_add_u32 s42, s42, 8192
s_mov_b32 m0, s43
s_add_u32 s43, s43, 1024
buffer_load_dwordx4 v16, s[96:99], s42 offen lds
s_add_u32 s42, s42, 8192
s_mov_b32 m0, s43
s_add_u32 s43, s43, 1024
buffer_load_dwordx4 v16, s[96:99], s42 offen lds
s_add_u32 s42, s42, 8192
s_mov_b32 m0, s43
s_add_u32 s43, s43, 1024
buffer_load_dwordx4 v16, s[96:99], s42 offen lds
s_add_u32 s42, s42, 8192
s_mov_b32 m0, s43
s_add_u32 s43, s43, 1024
buffer_load_dwordx4 v16, s[96:99], s42 offen lds
s_add_u32 s42, s42, 8192
s_mov_b32 m0, s43
s_add_u32 s43, s43, 1024
buffer_load_dwordx4 v16, s[96:99], s42 offen lds
s_add_u32 s42, s42, 8192
s_mov_b32 m0, s43
s_add_u32 s43, s43, 1024
buffer_load_dwordx4 v16, s[96:99], s42 offen lds
s_add_u32 s42, s42, 8192
L_s1nr_53:
s_barrier
s_branch L_disp
L_s2:
s_cmp_lg_u32 s27, 0
s_cbranch_scc1 L_s2nc_54
s_waitcnt vmcnt(0)
ds_read_b128 v[48:51], v8 offset:0
ds_read_b128 v[52:55], v8 offset:1024
ds_read_b128 v[56:59], v8 offset:2048
ds_read_b128 v[60:63], v8 offset:3072
v_mov_b32 v36, 0
v_mov_b32 v37, 0
v_mov_b32 v38, 0
v_mov_b32 v39, 0
v_mov_b32 v40, 0
v_mov_b32 v41, 0
v_mov_b32 v42, 0
v_mov_b32 v43, 0
v_and_b32 v44, s49, v2
v_and_b32 v45, s49, v3
v_and_b32 v46, s49, v2
v_and_b32 v47, s49, v3
s_waitcnt lgkmcnt(3)
s_nop 1
v_mfma_f32_4x4x4_16b_bf16 v[36:39], v[44:45], v[48:49], v[36:39]
v_mfma_f32_4x4x4_16b_bf16 v[40:43], v[44:45], v[50:51], v[40:43]
ds_read_b128 v[48:51], v8 offset:4096
s_waitcnt lgkmcnt(3)
s_nop 1
v_mfma_f32_4x4x4_16b_bf16 v[36:39], v[46:47], v[52:53], v[36:39]
v_mfma_f32_4x4x4_16b_bf16 v[40:43], v[46:47], v[54:55], v[40:43]
ds_read_b128 v[52:55], v8 offset:5120
s_waitcnt lgkmcnt(3)
s_nop 1
v_mfma_f32_4x4x4_16b_bf16 v[36:39], v[44:45], v[56:57], v[36:39]
v_mfma_f32_4x4x4_16b_bf16 v[40:43], v[44:45], v[58:59], v[40:43]
ds_read_b128 v[56:59], v8 offset:6144
s_waitcnt lgkmcnt(3)
s_nop 1
v_mfma_f32_4x4x4_16b_bf16 v[36:39], v[46:47], v[60:61], v[36:39]
v_mfma_f32_4x4x4_16b_bf16 v[40:43], v[46:47], v[62:63], v[40:43]
ds_read_b128 v[60:63], v8 offset:7168
s_waitcnt lgkmcnt(3)
s_nop 1
v_mfma_f32_4x4x4_16b_bf16 v[36:39], v[44:45], v[48:49], v[36:39]
v_mfma_f32_4x4x4_16b_bf16 v[40:43], v[44:45], v[50:51], v[40:43]
ds_read_b128 v[48:51], v8 offset:8192
s_waitcnt lgkmcnt(3)
s_nop 1
v_mfma_f32_4x4x4_16b_bf16 v[36:39], v[46:47], v[52:53], v[36:39]
v_mfma_f32_4x4x4_16b_bf16 v[40:43], v[46:47], v[54:55], v[40:43]
ds_read_b128 v[52:55], v8 offset:9216
s_waitcnt lgkmcnt(3)
s_nop 1
v_mfma_f32_4x4x4_16b_bf16 v[36:39], v[44:45], v[56:57], v[36:39]
v_mfma_f32_4x4x4_16b_bf16 v[40:43], v[44:45], v[58:59], v[40:43]
ds_read_b128 v[56:59], v8 offset:10240
s_waitcnt lgkmcnt(3)
s_nop 1
v_mfma_f32_4x4x4_16b_bf16 v[36:39], v[46:47], v[60:61], v[36:39]
v_mfma_f32_4x4x4_16b_bf16 v[40:43], v[46:47], v[62:63], v[40:43]
ds_read_b128 v[60:63], v8 offset:11264
s_waitcnt lgkmcnt(3)
s_nop 1
v_mfma_f32_4x4x4_16b_bf16 v[36:39], v[44:45], v[48:49], v[36:39]
v_mfma_f32_4x4x4_16b_bf16 v[40:43], v[44:45], v[50:51], v[40:43]
ds_read_b128 v[48:51], v8 offset:12288
s_waitcnt lgkmcnt(3)
s_nop 1
v_mfma_f32_4x4x4_16b_bf16 v[36:39], v[46:47], v[52:53], v[36:39]
v_mfma_f32_4x4x4_16b_bf16 v[40:43], v[46:47], v[54:55], v[40:43]
ds_read_b128 v[52:55], v8 offset:13312
s_waitcnt lgkmcnt(3)
s_nop 1
v_mfma_f32_4x4x4_16b_bf16 v[36:39], v[44:45], v[56:57], v[36:39]
v_mfma_f32_4x4x4_16b_bf16 v[40:43], v[44:45], v[58:59], v[40:43]
ds_read_b128 v[56:59], v8 offset:14336
s_waitcnt lgkmcnt(3)
s_nop 1
v_mfma_f32_4x4x4_16b_bf16 v[36:39], v[46:47], v[60:61], v[36:39]
v_mfma_f32_4x4x4_16b_bf16 v[40:43], v[46:47], v[62:63], v[40:43]
ds_read_b128 v[60:63], v8 offset:15360
s_waitcnt lgkmcnt(3)
s_nop 1
v_mfma_f32_4x4x4_16b_bf16 v[36:39], v[44:45], v[48:49], v[36:39]
v_mfma_f32_4x4x4_16b_bf16 v[40:43], v[44:45], v[50:51], v[40:43]
ds_read_b128 v[48:51], v8 offset:16384
s_waitcnt lgkmcnt(3)
s_nop 1
v_mfma_f32_4x4x4_16b_bf16 v[36:39], v[46:47], v[52:53], v[36:39]
v_mfma_f32_4x4x4_16b_bf16 v[40:43], v[46:47], v[54:55], v[40:43]
ds_read_b128 v[52:55], v8 offset:17408
s_waitcnt lgkmcnt(3)
s_nop 1
v_mfma_f32_4x4x4_16b_bf16 v[36:39], v[44:45], v[56:57], v[36:39]
v_mfma_f32_4x4x4_16b_bf16 v[40:43], v[44:45], v[58:59], v[40:43]
ds_read_b128 v[56:59], v8 offset:18432
s_waitcnt lgkmcnt(3)
s_nop 1
v_mfma_f32_4x4x4_16b_bf16 v[36:39], v[46:47], v[60:61], v[36:39]
v_mfma_f32_4x4x4_16b_bf16 v[40:43], v[46:47], v[62:63], v[40:43]
ds_read_b128 v[60:63], v8 offset:19456
s_waitcnt lgkmcnt(3)
s_nop 1
v_mfma_f32_4x4x4_16b_bf16 v[36:39], v[44:45], v[48:49], v[36:39]
v_mfma_f32_4x4x4_16b_bf16 v[40:43], v[44:45], v[50:51], v[40:43]
s_waitcnt lgkmcnt(2)
s_nop 1
v_mfma_f32_4x4x4_16b_bf16 v[36:39], v[46:47], v[52:53], v[36:39]
v_mfma_f32_4x4x4_16b_bf16 v[40:43], v[46:47], v[54:55], v[40:43]
s_waitcnt lgkmcnt(1)
s_nop 1
v_mfma_f32_4x4x4_16b_bf16 v[36:39], v[44:45], v[56:57], v[36:39]
v_mfma_f32_4x4x4_16b_bf16 v[40:43], v[44:45], v[58:59], v[40:43]
s_waitcnt lgkmcnt(0)
s_nop 1
v_mfma_f32_4x4x4_16b_bf16 v[36:39], v[46:47], v[60:61], v[36:39]
v_mfma_f32_4x4x4_16b_bf16 v[40:43], v[46:47], v[62:63], v[40:43]
s_nop 4
v_permlane32_swap_b32 v36, v40
v_permlane32_swap_b32 v37, v41
v_permlane32_swap_b32 v38, v42
v_permlane32_swap_b32 v39, v43
v_add_f32 v36, v36, v40
v_add_f32 v37, v37, v41
v_add_f32 v38, v38, v42
v_add_f32 v39, v39, v43
s_nop 0
v_permlane16_swap_b32 v36, v37
v_permlane16_swap_b32 v38, v39
v_add_f32 v36, v36, v37
v_add_f32 v38, v38, v39
s_nop 1
v_add_f32_dpp v44, v36, v36 row_ror:8 row_mask:0xf bank_mask:0x3
v_add_f32_dpp v44, v38, v38 row_ror:8 row_mask:0xf bank_mask:0xc
ds_write_b32 v10, v44
s_waitcnt lgkmcnt(0)
s_barrier
s_cmp_lg_u32 s3, 0
s_cbranch_scc1 L_cs_55
v_lshlrev_b32 v58, 2, v0
v_add_u32 v59, 154624, v58
ds_read2_b32 v[16:17], v59 offset0:0 offset1:64
ds_read2_b32 v[18:19], v59 offset0:128 offset1:192
s_waitcnt lgkmcnt(0)
v_add_f32 v16, v16, v17
v_add_f32 v18, v18, v19
v_add_f32 v30, v16, v18
v_add_u32 v59, 155904, v58
ds_write_b32 v59, v30
s_waitcnt lgkmcnt(0)
L_cs_55:
s_barrier
L_s2nc_54:
s_mul_i32 s32, s27, 20480
s_add_u32 s32, s32, 532480
v_add_u32 v52, s32, v11
v_add_u32 v53, 5120, v52
v_add_u32 v54, 10240, v52
v_add_u32 v55, 15360, v52
s_and_b32 s32, s27, 1
s_cmp_eq_u32 s32, 1
s_cbranch_scc1 L_s2odd_56
s_lshr_b32 s32, s27, 1
s_mul_i32 s32, s32, 1280
v_add_u32 v50, s32, v14
global_load_dwordx2 v[48:49], v50, s[22:23]
s_branch L_s2got_57
L_s2odd_56:
s_sub_u32 s32, s27, 1
s_mul_i32 s32, s32, 2048
s_add_u32 s32, s32, 688128
s_and_b32 s33, s29, 3
s_mul_i32 s33, s33, 8192
s_add_u32 s32, s32, s33
v_add_u32 v50, s32, v14
s_mov_b32 s31, 0
L_poll_58:
global_load_dwordx2 v[48:49], v50, s[16:17] sc1
s_waitcnt vmcnt(0)
v_max_u32 v58, v48, v49
v_cmp_eq_u32 vcc, -1, v58
s_nop 1
s_cmp_lg_u64 vcc, 0
s_cbranch_scc1 L_again_59
s_branch L_pdone_60
L_again_59:
s_add_u32 s31, s31, 1
s_cmp_lt_u32 s31, 200000
s_cbranch_scc1 L_poll_58
L_pdone_60:
L_s2got_57:
s_mov_b32 s31, 0
L_poll_61:
global_load_dwordx4 v[16:19], v52, s[16:17] offset:0 sc1
global_load_dwordx4 v[20:23], v52, s[16:17] offset:2560 sc1
global_load_dwordx4 v[24:27], v53, s[16:17] offset:0 sc1
global_load_dwordx4 v[28:31], v53, s[16:17] offset:2560 sc1
global_load_dwordx4 v[32:35], v54, s[16:17] offset:0 sc1
global_load_dwordx4 v[36:39], v54, s[16:17] offset:2560 sc1
global_load_dwordx4 v[40:43], v55, s[16:17] offset:0 sc1
global_load_dwordx4 v[44:47], v55, s[16:17] offset:2560 sc1
s_waitcnt vmcnt(0)
v_max_u32 v58, v16, v17
v_max3_u32 v58, v58, v18, v19
v_max3_u32 v58, v58, v20, v21
v_max3_u32 v58, v58, v22, v23
v_max3_u32 v58, v58, v24, v25
v_max3_u32 v58, v58, v26, v27
v_max3_u32 v58, v58, v28, v29
v_max3_u32 v58, v58, v30, v31
v_max3_u32 v58, v58, v32, v33
v_max3_u32 v58, v58, v34, v35
v_max3_u32 v58, v58, v36, v37
v_max3_u32 v58, v58, v38, v39
v_max3_u32 v58, v58, v40, v41
v_max3_u32 v58, v58, v42, v43
v_max3_u32 v58, v58, v44, v45
v_max3_u32 v58, v58, v46, v47
v_cmp_eq_u32 vcc, -1, v58
s_nop 1
s_cmp_lg_u64 vcc, 0
s_cbranch_scc1 L_again_62
s_branch L_pdone_63
L_again_62:
s_add_u32 s31, s31, 1
s_cmp_lt_u32 s31, 200000
s_cbranch_scc1 L_poll_61
L_pdone_63:
v_add_f32 v16, v16, v20
v_add_f32 v24, v24, v28
v_add_f32 v32, v32, v36
v_add_f32 v40, v40, v44
v_add_f32 v17, v17, v21
v_add_f32 v25, v25, v29
v_add_f32 v33, v33, v37
v_add_f32 v41, v41, v45
v_add_f32 v18, v18, v22
v_add_f32 v26, v26, v30
v_add_f32 v34, v34, v38
v_add_f32 v42, v42, v46
v_add_f32 v19, v19, v23
v_add_f32 v27, v27, v31
v_add_f32 v35, v35, v39
v_add_f32 v43, v43, v47
v_add_f32 v16, v16, v24
v_add_f32 v32, v32, v40
v_add_f32 v17, v17, v25
v_add_f32 v33, v33, v41
v_add_f32 v18, v18, v26
v_add_f32 v34, v34, v42
v_add_f32 v19, v19, v27
v_add_f32 v35, v35, v43
v_add_f32 v16, v16, v32
v_add_f32 v17, v17, v33
v_add_f32 v18, v18, v34
v_add_f32 v19, v19, v35
v_cvt_pk_bf16_f32 v16, v16, v16
v_and_b32 v16, 0xffff0000, v16
v_cvt_pk_bf16_f32 v17, v17, v17
v_and_b32 v17, 0xffff0000, v17
v_cvt_pk_bf16_f32 v18, v18, v18
v_and_b32 v18, 0xffff0000, v18
v_cvt_pk_bf16_f32 v19, v19, v19
v_and_b32 v19, 0xffff0000, v19
v_lshlrev_b32 v20, 16, v48
v_and_b32 v21, 0xffff0000, v48
v_lshlrev_b32 v22, 16, v49
v_and_b32 v23, 0xffff0000, v49
v_add_f32 v16, v16, v20
v_add_f32 v17, v17, v21
v_add_f32 v18, v18, v22
v_add_f32 v19, v19, v23
v_cvt_pk_bf16_f32 v16, v16, v16
v_and_b32 v16, 0xffff0000, v16
v_cvt_pk_bf16_f32 v17, v17, v17
v_and_b32 v17, 0xffff0000, v17
v_cvt_pk_bf16_f32 v18, v18, v18
v_and_b32 v18, 0xffff0000, v18
v_cvt_pk_bf16_f32 v19, v19, v19
v_and_b32 v19, 0xffff0000, v19
s_cmp_lg_u32 s29, 0
s_cbranch_scc1 L_s2nx_64
v_cvt_pk_bf16_f32 v20, v16, v17
v_cvt_pk_bf16_f32 v21, v18, v19
s_mul_i32 s32, s27, 2048
s_add_u32 s32, s32, 630784
v_add_u32 v50, s32, v14
global_store_dwordx2 v50, v[20:21], s[16:17] sc1
L_s2nx_64:
v_cvt_pk_bf16_f32 v48, v16, v16
v_cvt_pk_bf16_f32 v49, v17, v17
v_cvt_pk_bf16_f32 v50, v18, v18
v_cvt_pk_bf16_f32 v51, v19, v19
ds_write_b128 v12, v[48:51]
v_add_f32 v58, v16, v17
v_add_f32 v59, v18, v19
v_mul_f32 v60, v16, v16
v_add_f32 v58, v58, v59
v_fmac_f32 v60, v17, v17
v_fmac_f32 v60, v18, v18
v_fmac_f32 v60, v19, v19
v_mul_f32 v58, v58, v13
v_mul_f32 v60, v60, v13
s_nop 0
v_add_f32_dpp v58, v58, v58 quad_perm:[1,0,3,2] row_mask:0xf bank_mask:0xf
v_add_f32_dpp v60, v60, v60 quad_perm:[1,0,3,2] row_mask:0xf bank_mask:0xf
s_nop 0
v_add_f32_dpp v58, v58, v58 quad_perm:[2,3,0,1] row_mask:0xf bank_mask:0xf
v_add_f32_dpp v60, v60, v60 quad_perm:[2,3,0,1] row_mask:0xf bank_mask:0xf
s_nop 0
v_add_f32_dpp v58, v58, v58 row_half_mirror row_mask:0xf bank_mask:0xf
v_add_f32_dpp v60, v60, v60 row_half_mirror row_mask:0xf bank_mask:0xf
s_nop 0
v_add_f32_dpp v58, v58, v58 row_mirror row_mask:0xf bank_mask:0xf
v_add_f32_dpp v60, v60, v60 row_mirror row_mask:0xf bank_mask:0xf
s_nop 1
v_permlane32_swap_b32 v58, v60
v_add_f32 v58, v58, v60
v_mov_b32 v59, v58
s_nop 1
v_permlane16_swap_b32 v58, v59
v_add_f32 v58, v58, v59
v_lshrrev_b32 v59, 5, v0
v_lshlrev_b32 v59, 2, v59
s_lshl_b32 s32, s3, 3
s_add_u32 s32, s32, 155648
v_add_u32 v59, s32, v59
s_mov_b32 exec_lo, 1
s_mov_b32 exec_hi, 1
ds_write_b32 v59, v58
s_mov_b64 exec, -1
s_waitcnt lgkmcnt(0)
ds_read_b128 v[48:51], v8 offset:0
ds_read_b128 v[52:55], v8 offset:1024
ds_read_b128 v[56:59], v8 offset:2048
ds_read_b128 v[60:63], v8 offset:3072
ds_read_b128 v[16:19], v9 offset:0
ds_read_b128 v[20:23], v9 offset:16
ds_read_b128 v[24:27], v9 offset:32
ds_read_b128 v[28:31], v9 offset:48
ds_read_b128 v[32:35], v9 offset:64
v_mov_b32 v36, 0
v_mov_b32 v37, 0
v_mov_b32 v38, 0
v_mov_b32 v39, 0
v_mov_b32 v40, 0
v_mov_b32 v41, 0
v_mov_b32 v42, 0
v_mov_b32 v43, 0
s_waitcnt lgkmcnt(4)
v_and_b32 v44, v16, v2
v_and_b32 v45, v16, v3
v_and_b32 v46, v17, v2
v_and_b32 v47, v17, v3
s_nop 1
v_mfma_f32_4x4x4_16b_bf16 v[36:39], v[44:45], v[48:49], v[36:39]
v_mfma_f32_4x4x4_16b_bf16 v[40:43], v[44:45], v[50:51], v[40:43]
ds_read_b128 v[48:51], v8 offset:4096
v_and_b32 v44, v18, v2
v_and_b32 v45, v18, v3
v_mfma_f32_4x4x4_16b_bf16 v[36:39], v[46:47], v[52:53], v[36:39]
v_mfma_f32_4x4x4_16b_bf16 v[40:43], v[46:47], v[54:55], v[40:43]
ds_read_b128 v[52:55], v8 offset:5120
v_and_b32 v46, v19, v2
v_and_b32 v47, v19, v3
v_mfma_f32_4x4x4_16b_bf16 v[36:39], v[44:45], v[56:57], v[36:39]
v_mfma_f32_4x4x4_16b_bf16 v[40:43], v[44:45], v[58:59], v[40:43]
ds_read_b128 v[56:59], v8 offset:6144
s_waitcnt lgkmcnt(6)
v_and_b32 v44, v20, v2
v_and_b32 v45, v20, v3
v_mfma_f32_4x4x4_16b_bf16 v[36:39], v[46:47], v[60:61], v[36:39]
v_mfma_f32_4x4x4_16b_bf16 v[40:43], v[46:47], v[62:63], v[40:43]
ds_read_b128 v[60:63], v8 offset:7168
v_and_b32 v46, v21, v2
v_and_b32 v47, v21, v3
s_waitcnt lgkmcnt(3)
v_mfma_f32_4x4x4_16b_bf16 v[36:39], v[44:45], v[48:49], v[36:39]
v_mfma_f32_4x4x4_16b_bf16 v[40:43], v[44:45], v[50:51], v[40:43]
ds_read_b128 v[48:51], v8 offset:8192
v_and_b32 v44, v22, v2
v_and_b32 v45, v22, v3
s_waitcnt lgkmcnt(3)
v_mfma_f32_4x4x4_16b_bf16 v[36:39], v[46:47], v[52:53], v[36:39]
v_mfma_f32_4x4x4_16b_bf16 v[40:43], v[46:47], v[54:55], v[40:43]
ds_read_b128 v[52:55], v8 offset:9216
v_and_b32 v46, v23, v2
v_and_b32 v47, v23, v3
s_waitcnt lgkmcnt(3)
v_mfma_f32_4x4x4_16b_bf16 v[36:39], v[44:45], v[56:57], v[36:39]
v_mfma_f32_4x4x4_16b_bf16 v[40:43], v[44:45], v[58:59], v[40:43]
ds_read_b128 v[56:59], v8 offset:10240
v_and_b32 v44, v24, v2
v_and_b32 v45, v24, v3
s_waitcnt lgkmcnt(3)
v_mfma_f32_4x4x4_16b_bf16 v[36:39], v[46:47], v[60:61], v[36:39]
v_mfma_f32_4x4x4_16b_bf16 v[40:43], v[46:47], v[62:63], v[40:43]
ds_read_b128 v[60:63], v8 offset:11264
v_and_b32 v46, v25, v2
v_and_b32 v47, v25, v3
s_waitcnt lgkmcnt(3)
v_mfma_f32_4x4x4_16b_bf16 v[36:39], v[44:45], v[48:49], v[36:39]
v_mfma_f32_4x4x4_16b_bf16 v[40:43], v[44:45], v[50:51], v[40:43]
ds_read_b128 v[48:51], v8 offset:12288
v_and_b32 v44, v26, v2
v_and_b32 v45, v26, v3
s_waitcnt lgkmcnt(3)
v_mfma_f32_4x4x4_16b_bf16 v[36:39], v[46:47], v[52:53], v[36:39]
v_mfma_f32_4x4x4_16b_bf16 v[40:43], v[46:47], v[54:55], v[40:43]
ds_read_b128 v[52:55], v8 offset:13312
v_and_b32 v46, v27, v2
v_and_b32 v47, v27, v3
s_waitcnt lgkmcnt(3)
v_mfma_f32_4x4x4_16b_bf16 v[36:39], v[44:45], v[56:57], v[36:39]
v_mfma_f32_4x4x4_16b_bf16 v[40:43], v[44:45], v[58:59], v[40:43]
ds_read_b128 v[56:59], v8 offset:14336
v_and_b32 v44, v28, v2
v_and_b32 v45, v28, v3
s_waitcnt lgkmcnt(3)
v_mfma_f32_4x4x4_16b_bf16 v[36:39], v[46:47], v[60:61], v[36:39]
v_mfma_f32_4x4x4_16b_bf16 v[40:43], v[46:47], v[62:63], v[40:43]
ds_read_b128 v[60:63], v8 offset:15360
v_and_b32 v46, v29, v2
v_and_b32 v47, v29, v3
s_waitcnt lgkmcnt(3)
v_mfma_f32_4x4x4_16b_bf16 v[36:39], v[44:45], v[48:49], v[36:39]
v_mfma_f32_4x4x4_16b_bf16 v[40:43], v[44:45], v[50:51], v[40:43]
ds_read_b128 v[48:51], v8 offset:16384
v_and_b32 v44, v30, v2
v_and_b32 v45, v30, v3
s_waitcnt lgkmcnt(3)
v_mfma_f32_4x4x4_16b_bf16 v[36:39], v[46:47], v[52:53], v[36:39]
v_mfma_f32_4x4x4_16b_bf16 v[40:43], v[46:47], v[54:55], v[40:43]
ds_read_b128 v[52:55], v8 offset:17408
v_and_b32 v46, v31, v2
v_and_b32 v47, v31, v3
s_waitcnt lgkmcnt(3)
v_mfma_f32_4x4x4_16b_bf16 v[36:39], v[44:45], v[56:57], v[36:39]
v_mfma_f32_4x4x4_16b_bf16 v[40:43], v[44:45], v[58:59], v[40:43]
ds_read_b128 v[56:59], v8 offset:18432
v_and_b32 v44, v32, v2
v_and_b32 v45, v32, v3
s_waitcnt lgkmcnt(3)
v_mfma_f32_4x4x4_16b_bf16 v[36:39], v[46:47], v[60:61], v[36:39]
v_mfma_f32_4x4x4_16b_bf16 v[40:43], v[46:47], v[62:63], v[40:43]
ds_read_b128 v[60:63], v8 offset:19456
v_and_b32 v46, v33, v2
v_and_b32 v47, v33, v3
s_waitcnt lgkmcnt(3)
v_mfma_f32_4x4x4_16b_bf16 v[36:39], v[44:45], v[48:49], v[36:39]
v_mfma_f32_4x4x4_16b_bf16 v[40:43], v[44:45], v[50:51], v[40:43]
v_and_b32 v44, v34, v2
v_and_b32 v45, v34, v3
s_waitcnt lgkmcnt(2)
v_mfma_f32_4x4x4_16b_bf16 v[36:39], v[46:47], v[52:53], v[36:39]
v_mfma_f32_4x4x4_16b_bf16 v[40:43], v[46:47], v[54:55], v[40:43]
v_and_b32 v46, v35, v2
v_and_b32 v47, v35, v3
s_waitcnt lgkmcnt(1)
v_mfma_f32_4x4x4_16b_bf16 v[36:39], v[44:45], v[56:57], v[36:39]
v_mfma_f32_4x4x4_16b_bf16 v[40:43], v[44:45], v[58:59], v[40:43]
s_waitcnt lgkmcnt(0)
v_mfma_f32_4x4x4_16b_bf16 v[36:39], v[46:47], v[60:61], v[36:39]
v_mfma_f32_4x4x4_16b_bf16 v[40:43], v[46:47], v[62:63], v[40:43]
s_nop 4
v_permlane32_swap_b32 v36, v40
v_permlane32_swap_b32 v37, v41
v_permlane32_swap_b32 v38, v42
v_permlane32_swap_b32 v39, v43
v_add_f32 v36, v36, v40
v_add_f32 v37, v37, v41
v_add_f32 v38, v38, v42
v_add_f32 v39, v39, v43
s_nop 0
v_permlane16_swap_b32 v36, v37
v_permlane16_swap_b32 v38, v39
v_add_f32 v36, v36, v37
v_add_f32 v38, v38, v39
s_nop 1
v_add_f32_dpp v44, v36, v36 row_ror:8 row_mask:0xf bank_mask:0x3
v_add_f32_dpp v44, v38, v38 row_ror:8 row_mask:0xf bank_mask:0xc
ds_write_b32 v10, v44
s_waitcnt lgkmcnt(0)
s_barrier
s_cmp_lg_u32 s3, 0
s_cbranch_scc1 L_s2w_65
v_lshlrev_b32 v58, 2, v0
v_add_u32 v59, 154624, v58
ds_read2_b32 v[16:17], v59 offset0:0 offset1:64
ds_read2_b32 v[18:19], v59 offset0:128 offset1:192
v_mov_b32 v60, 155648
ds_read_b128 v[20:23], v60
ds_read_b128 v[24:27], v60 offset:16
v_add_u32 v59, 155904, v58
ds_read_b32 v28, v59
s_waitcnt lgkmcnt(0)
v_add_f32 v16, v16, v17
v_add_f32 v18, v18, v19
v_add_f32 v30, v16, v18
v_add_f32 v20, v20, v22
v_add_f32 v24, v24, v26
v_add_f32 v20, v20, v24
v_add_f32 v21, v21, v23
v_add_f32 v25, v25, v27
v_add_f32 v21, v21, v25
v_mul_f32 v20, 0x3acccccd, v20
v_mul_f32 v21, 0x3acccccd, v21
v_fma_f32 v21, -v20, v20, v21
v_add_f32 v21, 0x3727c5ac, v21
v_rsq_f32 v21, v21
v_fma_f32 v30, -v20, v28, v30
v_mul_f32 v30, v30, v21
v_cvt_pk_bf16_f32 v30, v30, v30
v_and_b32 v30, 0xffff0000, v30
v_mul_f32 v31, 0xbfb8aa3b, v30
v_exp_f32 v31, v31
s_nop 0
v_add_f32 v31, 1.0, v31
v_rcp_f32 v31, v31
s_nop 0
v_mul_f32 v30, v30, v31
s_nop 1
v_mov_b32_dpp v32, v30 quad_perm:[1,0,3,2] row_mask:0xf bank_mask:0xf
v_cvt_pk_bf16_f32 v32, v30, v32
s_nop 1
v_mov_b32_dpp v33, v32 quad_perm:[2,3,0,1] row_mask:0xf bank_mask:0xf
v_mov_b32_dpp v34, v32 row_shl:4 row_mask:0xf bank_mask:0xf
s_nop 0
v_mov_b32_dpp v35, v33 row_shl:4 row_mask:0xf bank_mask:0xf
s_mul_i32 s32, s27, 4096
s_add_u32 s32, s32, 614400
s_lshl_b32 s33, s29, 7
s_add_u32 s32, s32, s33
v_lshlrev_b32 v58, 1, v0
v_add_u32 v58, s32, v58
s_mov_b32 exec_lo, 0x01010101
s_mov_b32 exec_hi, 0x01010101
global_store_dwordx4 v58, v[32:35], s[16:17] sc1
s_mov_b64 exec, -1
L_s2w_65:
s_barrier
s_branch L_disp
L_s3:
s_mul_i32 s32, s27, 4096
s_add_u32 s32, s32, 614400
v_add_u32 v50, s32, v11
s_mul_i32 s32, s27, 2048
s_add_u32 s32, s32, 630784
v_add_u32 v51, s32, v14
s_mov_b32 s31, 0
global_load_dwordx4 v[4:7], v50, s[16:17] sc1
global_load_dword v15, v51, s[16:17] sc1
s_waitcnt vmcnt(0)
s_branch L_fc_69
L_fp_66:
s_waitcnt vmcnt(10)
global_load_dwordx4 v[4:7], v50, s[16:17] sc1
global_load_dword v15, v51, s[16:17] sc1
L_fc_69:
v_max_u32 v58, v4, v5
v_max3_u32 v58, v58, v6, v7
v_max_u32 v58, v58, v15
v_cmp_eq_u32 vcc, -1, v58
s_nop 1
s_cmp_lg_u64 vcc, 0
s_cbranch_scc1 L_fa_67
s_branch L_fd_68
L_fa_67:
s_add_u32 s31, s31, 1
s_cmp_ge_u32 s31, 1600000
s_cbranch_scc1 L_fd_68
s_and_b32 s32, s31, 7
s_cmp_eq_u32 s32, 0
s_cbranch_scc1 L_fp_66
s_branch L_fc_69
L_fd_68:
v_and_b32 v28, 0xffff, v4
v_lshl_or_b32 v20, v28, 16, v28
v_lshrrev_b32 v28, 16, v4
v_lshl_or_b32 v21, v28, 16, v28
v_and_b32 v28, 0xffff, v5
v_lshl_or_b32 v22, v28, 16, v28
v_lshrrev_b32 v28, 16, v5
v_lshl_or_b32 v23, v28, 16, v28
v_and_b32 v28, 0xffff, v6
v_lshl_or_b32 v24, v28, 16, v28
v_lshrrev_b32 v28, 16, v6
v_lshl_or_b32 v25, v28, 16, v28
v_and_b32 v28, 0xffff, v7
v_lshl_or_b32 v26, v28, 16, v28
v_lshrrev_b32 v28, 16, v7
v_lshl_or_b32 v27, v28, 16, v28
ds_write_b128 v12, v[20:23]
ds_write_b128 v12, v[24:27] offset:16
s_waitcnt lgkmcnt(0)
ds_read_b64 v[52:53], v8 offset:0
ds_read_b64 v[54:55], v8 offset:512
ds_read_b64 v[56:57], v8 offset:1024
ds_read_b64 v[58:59], v8 offset:1536
ds_read_b64 v[60:61], v8 offset:2048
ds_read_b64 v[62:63], v8 offset:2560
ds_read_b128 v[16:19], v9 offset:0
ds_read_b128 v[20:23], v9 offset:256
ds_read_b128 v[24:27], v9 offset:512
ds_read_b128 v[28:31], v9 offset:768
ds_read_b128 v[32:35], v9 offset:1024
ds_read_b128 v[36:39], v9 offset:1280
ds_read_b128 v[40:43], v9 offset:1536
v_mov_b32 v44, 0
v_mov_b32 v45, 0
v_mov_b32 v46, 0
v_mov_b32 v47, 0
s_waitcnt lgkmcnt(6)
v_and_b32 v48, v16, v2
v_and_b32 v49, v16, v3
v_and_b32 v50, v17, v2
v_and_b32 v51, v17, v3
s_nop 1
v_mfma_f32_4x4x4_16b_bf16 v[44:47], v[48:49], v[52:53], v[44:47]
ds_read_b64 v[52:53], v8 offset:3072
v_and_b32 v48, v18, v2
v_and_b32 v49, v18, v3
v_mfma_f32_4x4x4_16b_bf16 v[44:47], v[50:51], v[54:55], v[44:47]
ds_read_b64 v[54:55], v8 offset:3584
v_and_b32 v50, v19, v2
v_and_b32 v51, v19, v3
v_mfma_f32_4x4x4_16b_bf16 v[44:47], v[48:49], v[56:57], v[44:47]
ds_read_b64 v[56:57], v8 offset:4096
s_waitcnt lgkmcnt(8)
v_and_b32 v48, v20, v2
v_and_b32 v49, v20, v3
v_mfma_f32_4x4x4_16b_bf16 v[44:47], v[50:51], v[58:59], v[44:47]
ds_read_b64 v[58:59], v8 offset:4608
v_and_b32 v50, v21, v2
v_and_b32 v51, v21, v3
v_mfma_f32_4x4x4_16b_bf16 v[44:47], v[48:49], v[60:61], v[44:47]
ds_read_b64 v[60:61], v8 offset:5120
v_and_b32 v48, v22, v2
v_and_b32 v49, v22, v3
v_mfma_f32_4x4x4_16b_bf16 v[44:47], v[50:51], v[62:63], v[44:47]
ds_read_b64 v[62:63], v8 offset:5632
v_and_b32 v50, v23, v2
v_and_b32 v51, v23, v3
s_waitcnt lgkmcnt(5)
v_mfma_f32_4x4x4_16b_bf16 v[44:47], v[48:49], v[52:53], v[44:47]
ds_read_b64 v[52:53], v8 offset:6144
v_and_b32 v48, v24, v2
v_and_b32 v49, v24, v3
s_waitcnt lgkmcnt(5)
v_mfma_f32_4x4x4_16b_bf16 v[44:47], v[50:51], v[54:55], v[44:47]
ds_read_b64 v[54:55], v8 offset:6656
v_and_b32 v50, v25, v2
v_and_b32 v51, v25, v3
s_waitcnt lgkmcnt(5)
v_mfma_f32_4x4x4_16b_bf16 v[44:47], v[48:49], v[56:57], v[44:47]
ds_read_b64 v[56:57], v8 offset:7168
v_and_b32 v48, v26, v2
v_and_b32 v49, v26, v3
s_waitcnt lgkmcnt(5)
v_mfma_f32_4x4x4_16b_bf16 v[44:47], v[50:51], v[58:59], v[44:47]
ds_read_b64 v[58:59], v8 offset:7680
v_and_b32 v50, v27, v2
v_and_b32 v51, v27, v3
s_waitcnt lgkmcnt(5)
v_mfma_f32_4x4x4_16b_bf16 v[44:47], v[48:49], v[60:61], v[44:47]
ds_read_b64 v[60:61], v8 offset:8192
v_and_b32 v48, v28, v2
v_and_b32 v49, v28, v3
s_waitcnt lgkmcnt(5)
v_mfma_f32_4x4x4_16b_bf16 v[44:47], v[50:51], v[62:63], v[44:47]
ds_read_b64 v[62:63], v8 offset:8704
v_and_b32 v50, v29, v2
v_and_b32 v51, v29, v3
s_waitcnt lgkmcnt(5)
v_mfma_f32_4x4x4_16b_bf16 v[44:47], v[48:49], v[52:53], v[44:47]
ds_read_b64 v[52:53], v8 offset:9216
v_and_b32 v48, v30, v2
v_and_b32 v49, v30, v3
s_waitcnt lgkmcnt(5)
v_mfma_f32_4x4x4_16b_bf16 v[44:47], v[50:51], v[54:55], v[44:47]
ds_read_b64 v[54:55], v8 offset:9728
v_and_b32 v50, v31, v2
v_and_b32 v51, v31, v3
s_waitcnt lgkmcnt(5)
v_mfma_f32_4x4x4_16b_bf16 v[44:47], v[48:49], v[56:57], v[44:47]
ds_read_b64 v[56:57], v8 offset:10240
v_and_b32 v48, v32, v2
v_and_b32 v49, v32, v3
s_waitcnt lgkmcnt(5)
v_mfma_f32_4x4x4_16b_bf16 v[44:47], v[50:51], v[58:59], v[44:47]
ds_read_b64 v[58:59], v8 offset:10752
v_and_b32 v50, v33, v2
v_and_b32 v51, v33, v3
s_waitcnt lgkmcnt(5)
v_mfma_f32_4x4x4_16b_bf16 v[44:47], v[48:49], v[60:61], v[44:47]
ds_read_b64 v[60:61], v8 offset:11264
v_and_b32 v48, v34, v2
v_and_b32 v49, v34, v3
s_waitcnt lgkmcnt(5)
v_mfma_f32_4x4x4_16b_bf16 v[44:47], v[50:51], v[62:63], v[44:47]
ds_read_b64 v[62:63], v8 offset:11776
v_and_b32 v50, v35, v2
v_and_b32 v51, v35, v3
s_waitcnt lgkmcnt(5)
v_mfma_f32_4x4x4_16b_bf16 v[44:47], v[48:49], v[52:53], v[44:47]
ds_read_b64 v[52:53], v8 offset:12288
v_and_b32 v48, v36, v2
v_and_b32 v49, v36, v3
s_waitcnt lgkmcnt(5)
v_mfma_f32_4x4x4_16b_bf16 v[44:47], v[50:51], v[54:55], v[44:47]
ds_read_b64 v[54:55], v8 offset:12800
v_and_b32 v50, v37, v2
v_and_b32 v51, v37, v3
s_waitcnt lgkmcnt(5)
v_mfma_f32_4x4x4_16b_bf16 v[44:47], v[48:49], v[56:57], v[44:47]
ds_read_b64 v[56:57], v8 offset:13312
v_and_b32 v48, v38, v2
v_and_b32 v49, v38, v3
s_waitcnt lgkmcnt(5)
v_mfma_f32_4x4x4_16b_bf16 v[44:47], v[50:51], v[58:59], v[44:47]
ds_read_b64 v[58:59], v8 offset:13824
v_and_b32 v50, v39, v2
v_and_b32 v51, v39, v3
s_waitcnt lgkmcnt(5)
v_mfma_f32_4x4x4_16b_bf16 v[44:47], v[48:49], v[60:61], v[44:47]
v_and_b32 v48, v40, v2
v_and_b32 v49, v40, v3
s_waitcnt lgkmcnt(4)
v_mfma_f32_4x4x4_16b_bf16 v[44:47], v[50:51], v[62:63], v[44:47]
v_and_b32 v50, v41, v2
v_and_b32 v51, v41, v3
s_waitcnt lgkmcnt(3)
v_mfma_f32_4x4x4_16b_bf16 v[44:47], v[48:49], v[52:53], v[44:47]
v_and_b32 v48, v42, v2
v_and_b32 v49, v42, v3
s_waitcnt lgkmcnt(2)
v_mfma_f32_4x4x4_16b_bf16 v[44:47], v[50:51], v[54:55], v[44:47]
v_and_b32 v50, v43, v2
v_and_b32 v51, v43, v3
s_waitcnt lgkmcnt(1)
v_mfma_f32_4x4x4_16b_bf16 v[44:47], v[48:49], v[56:57], v[44:47]
s_nop 1
s_waitcnt lgkmcnt(0)
v_mfma_f32_4x4x4_16b_bf16 v[44:47], v[50:51], v[58:59], v[44:47]
s_nop 4
v_permlane32_swap_b32 v44, v46
v_permlane32_swap_b32 v45, v47
v_add_f32 v44, v44, v46
v_add_f32 v45, v45, v47
s_nop 1
v_permlane16_swap_b32 v44, v45
v_add_f32 v44, v44, v45
s_nop 1
v_add_f32_dpp v44, v44, v44 row_ror:8 row_mask:0xf bank_mask:0xf
s_nop 1
v_add_f32_dpp v44, v44, v44 row_ror:4 row_mask:0xf bank_mask:0xf
ds_write_b32 v10, v44
s_waitcnt lgkmcnt(0)
s_barrier
s_cmp_lg_u32 s3, 0
s_cbranch_scc1 L_s3w_70
v_and_b32 v58, 15, v0
v_lshlrev_b32 v58, 2, v58
v_add_u32 v58, 154624, v58
ds_read2_b32 v[16:17], v58 offset0:0 offset1:16
ds_read2_b32 v[18:19], v58 offset0:32 offset1:48
s_waitcnt lgkmcnt(0)
v_add_f32 v16, v16, v17
v_add_f32 v18, v18, v19
v_add_f32 v30, v16, v18
v_cvt_pk_bf16_f32 v30, v30, v30
v_and_b32 v30, 0xffff0000, v30
v_lshlrev_b32 v16, 16, v15
v_and_b32 v17, 0xffff0000, v15
v_and_b32 v18, 1, v0
v_cmp_eq_u32 vcc, 1, v18
s_nop 1
v_cndmask_b32 v16, v16, v17, vcc
v_add_f32 v30, v30, v16
s_nop 1
v_mov_b32_dpp v32, v30 quad_perm:[1,0,3,2] row_mask:0xf bank_mask:0xf
v_cvt_pk_bf16_f32 v32, v30, v32
s_nop 1
v_mov_b32_dpp v33, v32 quad_perm:[2,3,0,1] row_mask:0xf bank_mask:0xf
v_mov_b32_dpp v34, v32 row_shl:4 row_mask:0xf bank_mask:0xf
s_nop 0
v_mov_b32_dpp v35, v33 row_shl:4 row_mask:0xf bank_mask:0xf
s_mov_b32 exec_lo, 0x0101
s_mov_b32 exec_hi, 0
s_and_b32 s32, s27, 1
s_cmp_eq_u32 s32, 1
s_cbranch_scc1 L_s3odd_71
s_mul_i32 s32, s27, 2048
s_add_u32 s32, s32, 688128
v_add_u32 v58, s32, v14
s_mov_b64 exec, -1
v_lshrrev_b32 v59, 4, v0
v_mul_u32_u24 v59, 8192, v59
v_add3_u32 v58, v14, s32, v59
s_mov_b32 exec_lo, 0x01010101
s_mov_b32 exec_hi, 0x01010101
global_store_dwordx4 v58, v[32:35], s[16:17] sc1
s_branch L_s3fin_72
L_s3odd_71:
s_lshr_b32 s32, s27, 1
s_mul_i32 s32, s32, 1280
v_add_u32 v58, s32, v14
global_store_dwordx4 v58, v[32:35], s[20:21] sc1
L_s3fin_72:
s_mov_b64 exec, -1
L_s3w_70:
s_barrier
s_branch L_disp
L_wload:
s_cmp_eq_u32 s28, 2
s_cbranch_scc0 L_wl_73
v_lshrrev_b32 v16, 3, v0
v_mul_u32_u24 v16, 69120, v16
v_and_b32 v17, 7, v0
v_lshl_add_u32 v16, v17, 4, v16
s_mul_i32 s42, s3, 160
s_mul_i32 s42, s42, 3456
s_add_u32 s42, s42, s53
s_mul_i32 s43, s3, 20480
s_add_u32 s43, s43, 65536
s_mov_b32 m0, s43
s_add_u32 s43, s43, 1024
buffer_load_dwordx4 v16, s[12:15], s42 offen lds
s_add_u32 s42, s42, 3456
s_mov_b32 m0, s43
s_add_u32 s43, s43, 1024
buffer_load_dwordx4 v16, s[12:15], s42 offen lds
s_add_u32 s42, s42, 3456
s_mov_b32 m0, s43
s_add_u32 s43, s43, 1024
buffer_load_dwordx4 v16, s[12:15], s42 offen lds
s_add_u32 s42, s42, 3456
s_mov_b32 m0, s43
s_add_u32 s43, s43, 1024
buffer_load_dwordx4 v16, s[12:15], s42 offen lds
s_add_u32 s42, s42, 3456
s_mov_b32 m0, s43
s_add_u32 s43, s43, 1024
buffer_load_dwordx4 v16, s[12:15], s42 offen lds
s_add_u32 s42, s42, 3456
s_mov_b32 m0, s43
s_add_u32 s43, s43, 1024
buffer_load_dwordx4 v16, s[12:15], s42 offen lds
s_add_u32 s42, s42, 3456
s_mov_b32 m0, s43
s_add_u32 s43, s43, 1024
buffer_load_dwordx4 v16, s[12:15], s42 offen lds
s_add_u32 s42, s42, 3456
s_mov_b32 m0, s43
s_add_u32 s43, s43, 1024
buffer_load_dwordx4 v16, s[12:15], s42 offen lds
s_add_u32 s42, s42, 3456
s_mov_b32 m0, s43
s_add_u32 s43, s43, 1024
buffer_load_dwordx4 v16, s[12:15], s42 offen lds
s_add_u32 s42, s42, 3456
s_mov_b32 m0, s43
s_add_u32 s43, s43, 1024
buffer_load_dwordx4 v16, s[12:15], s42 offen lds
s_add_u32 s42, s42, 3456
s_mov_b32 m0, s43
s_add_u32 s43, s43, 1024
buffer_load_dwordx4 v16, s[12:15], s42 offen lds
s_add_u32 s42, s42, 3456
s_mov_b32 m0, s43
s_add_u32 s43, s43, 1024
buffer_load_dwordx4 v16, s[12:15], s42 offen lds
s_add_u32 s42, s42, 3456
s_mov_b32 m0, s43
s_add_u32 s43, s43, 1024
buffer_load_dwordx4 v16, s[12:15], s42 offen lds
s_add_u32 s42, s42, 3456
s_mov_b32 m0, s43
s_add_u32 s43, s43, 1024
buffer_load_dwordx4 v16, s[12:15], s42 offen lds
s_add_u32 s42, s42, 3456
s_mov_b32 m0, s43
s_add_u32 s43, s43, 1024
buffer_load_dwordx4 v16, s[12:15], s42 offen lds
s_add_u32 s42, s42, 3456
s_mov_b32 m0, s43
s_add_u32 s43, s43, 1024
buffer_load_dwordx4 v16, s[12:15], s42 offen lds
s_add_u32 s42, s42, 3456
s_mov_b32 m0, s43
s_add_u32 s43, s43, 1024
buffer_load_dwordx4 v16, s[12:15], s42 offen lds
s_add_u32 s42, s42, 3456
s_mov_b32 m0, s43
s_add_u32 s43, s43, 1024
buffer_load_dwordx4 v16, s[12:15], s42 offen lds
s_add_u32 s42, s42, 3456
s_mov_b32 m0, s43
s_add_u32 s43, s43, 1024
buffer_load_dwordx4 v16, s[12:15], s42 offen lds
s_add_u32 s42, s42, 3456
s_mov_b32 m0, s43
s_add_u32 s43, s43, 1024
buffer_load_dwordx4 v16, s[12:15], s42 offen lds
s_add_u32 s42, s42, 3456
s_branch L_disp
L_wl_73:
s_cmp_eq_u32 s28, 3
s_cbranch_scc0 L_disp
v_bfe_u32 v16, v0, 1, 4
v_mul_u32_u24 v16, 5120, v16
v_lshrrev_b32 v17, 5, v0
v_mul_u32_u24 v17, 1280, v17
v_add_u32 v16, v16, v17
v_and_b32 v17, 1, v0
v_lshl_add_u32 v16, v17, 4, v16
s_mul_i32 s42, s3, 552960
s_lshl_b32 s43, s29, 5
s_add_u32 s42, s42, s43
s_mul_i32 s43, s3, 14336
s_add_u32 s43, s43, 65536
s_mov_b32 m0, s43
s_add_u32 s44, s42, 0
buffer_load_dwordx4 v16, s[12:15], s44 offen lds
s_add_u32 s43, s43, 1024
s_mov_b32 m0, s43
s_add_u32 s44, s42, 2560
buffer_load_dwordx4 v16, s[12:15], s44 offen lds
s_add_u32 s43, s43, 1024
s_mov_b32 m0, s43
s_add_u32 s44, s42, 81920
buffer_load_dwordx4 v16, s[12:15], s44 offen lds
s_add_u32 s43, s43, 1024
s_mov_b32 m0, s43
s_add_u32 s44, s42, 84480
buffer_load_dwordx4 v16, s[12:15], s44 offen lds
s_add_u32 s43, s43, 1024
s_mov_b32 m0, s43
s_add_u32 s44, s42, 163840
buffer_load_dwordx4 v16, s[12:15], s44 offen lds
s_add_u32 s43, s43, 1024
s_mov_b32 m0, s43
s_add_u32 s44, s42, 166400
buffer_load_dwordx4 v16, s[12:15], s44 offen lds
s_add_u32 s43, s43, 1024
s_mov_b32 m0, s43
s_add_u32 s44, s42, 245760
buffer_load_dwordx4 v16, s[12:15], s44 offen lds
s_add_u32 s43, s43, 1024
s_mov_b32 m0, s43
s_add_u32 s44, s42, 248320
buffer_load_dwordx4 v16, s[12:15], s44 offen lds
s_add_u32 s43, s43, 1024
s_mov_b32 m0, s43
s_add_u32 s44, s42, 327680
buffer_load_dwordx4 v16, s[12:15], s44 offen lds
s_add_u32 s43, s43, 1024
s_mov_b32 m0, s43
s_add_u32 s44, s42, 330240
buffer_load_dwordx4 v16, s[12:15], s44 offen lds
s_add_u32 s43, s43, 1024
s_mov_b32 m0, s43
s_add_u32 s44, s42, 409600
buffer_load_dwordx4 v16, s[12:15], s44 offen lds
s_add_u32 s43, s43, 1024
s_mov_b32 m0, s43
s_add_u32 s44, s42, 412160
buffer_load_dwordx4 v16, s[12:15], s44 offen lds
s_add_u32 s43, s43, 1024
s_mov_b32 m0, s43
s_add_u32 s44, s42, 491520
buffer_load_dwordx4 v16, s[12:15], s44 offen lds
s_add_u32 s43, s43, 1024
s_mov_b32 m0, s43
s_add_u32 s44, s42, 494080
buffer_load_dwordx4 v16, s[12:15], s44 offen lds
s_add_u32 s43, s43, 1024
s_branch L_disp
L_lk:
s_lshl_b32 s32, s24, 7
s_add_u32 s32, s32, 655360
v_lshlrev_b32 v60, 4, v0
v_add_u32 v60, s32, v60
s_cmp_lt_u32 s24, 19
s_cselect_b32 s34, 31, 15
s_mov_b32 exec_lo, s34
s_mov_b32 exec_hi, 0
s_mov_b32 s31, 0
L_poll_74:
global_load_dword v61, v60, s[16:17] sc1
s_waitcnt vmcnt(0)
v_cmp_eq_u32 vcc, -1, v61
s_nop 1
s_cmp_lg_u64 vcc, 0
s_cbranch_scc1 L_again_75
s_branch L_pdone_76
L_again_75:
s_add_u32 s31, s31, 1
s_cmp_lt_u32 s31, 200000
s_cbranch_scc1 L_poll_74
L_pdone_76:
s_mov_b64 exec, -1
s_mov_b32 s55, 0x4000000
s_mov_b32 s57, 2
s_branch L_lka
L_disp:
s_and_b32 s32, s100, 15
s_bfe_u32 s27, s100, 0x40004
s_lshr_b64 s[100:101], s[100:101], 8
s_cmp_eq_u32 s32, 1
s_cbranch_scc1 L_att
s_cmp_eq_u32 s32, 2
s_cbranch_scc1 L_s1
s_cmp_eq_u32 s32, 3
s_cbranch_scc1 L_s2
s_cmp_eq_u32 s32, 4
s_cbranch_scc1 L_s3
s_cmp_eq_u32 s32, 5
s_cbranch_scc1 L_s4
s_cmp_eq_u32 s32, 6
s_cbranch_scc1 L_ring
s_cmp_eq_u32 s32, 7
s_cbranch_scc1 L_lk
L_fin:
L_end:
s_endpgm
.section .rodata,"a"
.p2align 6
.amdhsa_kernel interleave_layers__gqa_block_cached__dense_activation_silu__decode_kernel
  .amdhsa_next_free_vgpr 512
  .amdhsa_next_free_sgpr 102
  .amdhsa_accum_offset 256
  .amdhsa_group_segment_fixed_size 0
  .amdhsa_kernarg_size 88
  .amdhsa_user_sgpr_count 2
  .amdhsa_user_sgpr_kernarg_segment_ptr 1
  .amdhsa_system_sgpr_workgroup_id_x 1
.end_amdhsa_kernel
```
